```python
import torch

def _softmax(x, axis=-1):
    return torch.softmax(x, dim=axis)
def _gelu(x):
    return torch.nn.functional.gelu(x, approximate="tanh")
def _silu(x):
    return torch.nn.functional.silu(x)
def _sigmoid(x):
    return torch.sigmoid(x)
def _layernorm(x, axis=-1, eps=1e-5):
    m = x.mean(dim=axis, keepdim=True)
    v = x.var(dim=axis, keepdim=True, unbiased=False)
    return (x - m) / torch.sqrt(v + eps)
def _scatter_add(tgt, idx, src, axis=0):
    return tgt.clone().index_add_(axis, idx, src)
def _segment_sum(src, seg, n):
    out = torch.zeros((n,) + src.shape[1:], dtype=src.dtype)
    return out.index_add_(0, seg, src)
def _pad(x, pw):
    flat = tuple(v for pair in reversed(pw) for v in pair)
    return torch.nn.functional.pad(x, flat)

kernel_name = 'gated_mix__ssm_conv_h3__geglu_ffn__prompt'

def setup_inputs():

    _w = (lambda a: (lambda t: t.to(torch.bfloat16) if t.is_floating_point() else t)(torch.as_tensor(a)))
    def _A_setup():
        B, S, D = 1, 2048, 1024
        ks = 4
        return {
            "q": _w((lambda *s: torch.randn(*s, dtype=torch.bfloat16) * 0.05)(B, S, D)),
            "k": _w((lambda *s: torch.randn(*s, dtype=torch.bfloat16) * 0.4)(B, S, D)),
            "v": _w((lambda *s: torch.randn(*s, dtype=torch.bfloat16) * 0.4)(B, S, D)),
            "shift_k": _w((lambda *s: torch.randn(*s, dtype=torch.bfloat16) * 0.4)(D, ks) * 0.5),
            "ssm_k": _w((lambda *s: torch.randn(*s, dtype=torch.bfloat16) * 0.4)(D, S) * (1.0 / S ** 0.5)),
            "ssm_D": _w((lambda *s: torch.randn(*s, dtype=torch.bfloat16) * 0.4)(D)),
        }
    _A_in = _A_setup()

    def _B_setup():
        B, S, D, F = 1, 2048, 1024, 3584
        return {
            "x": _w((lambda *s: torch.randn(*s, dtype=torch.bfloat16) * 0.05)(B, S, D)),
            "w_gate": _w((lambda *s: torch.randn(*s, dtype=torch.bfloat16) * 0.05)(D, F)),
            "w_up": _w((lambda *s: torch.randn(*s, dtype=torch.bfloat16) * 0.05)(D, F)),
            "w_down": _w((lambda *s: torch.randn(*s, dtype=torch.bfloat16) * 0.05)(F, D)),
        }
    _B_in = _B_setup()

    return {
        "A_q": _A_in["q"],
        "A_k": _A_in["k"],
        "A_v": _A_in["v"],
        "A_shift_k": _A_in["shift_k"],
        "A_ssm_k": _A_in["ssm_k"],
        "A_ssm_D": _A_in["ssm_D"],
        "B_x": _B_in["x"],
        "B_w_gate": _B_in["w_gate"],
        "B_w_up": _B_in["w_up"],
        "B_w_down": _B_in["w_down"],
        "gate_w": _w((lambda *s: torch.randn(*s, dtype=torch.bfloat16) * 0.05)(1024) * 16.0),
    }

def reference(A_q, A_k, A_v, A_shift_k, A_ssm_k, A_ssm_D, B_x, B_w_gate, B_w_up, B_w_down, gate_w):
    def _A_ref(q, k, v, shift_k, ssm_k, ssm_D):
        B, S, D = q.shape
        ks = shift_k.shape[-1]
        k_pad = _pad(k, ((0, 0), (ks - 1, 0), (0, 0)))
        k_shift = torch.zeros_like(k)
        for t in range(ks):
            k_shift = k_shift + k_pad[:, t:t + S, :] * shift_k[:, ks - 1 - t][None, None, :]
        kv = k_shift * v
        L = 2 * S
        kv_pad = _pad(kv, ((0, 0), (0, S), (0, 0)))
        kf_pad = _pad(ssm_k, ((0, 0), (0, S)))
        kv_f = (lambda x, axes=(-2,-1): torch.fft.rfft2(x.float(), dim=axes))(kv_pad[:, None, :, :], axes=(1, 2))
        kf_f = (lambda x, axes=(-2,-1): torch.fft.rfft2(x.float(), dim=axes))(kf_pad[:, None, :], axes=(1, 2))
        kf_f = (lambda x, *d: x.permute(*d))(kf_f, 1, 2, 0)
        y_f = kv_f * kf_f[None, :, :, :]
        y = (lambda x, s, axes=(-2,-1): torch.fft.irfft2(x, s=s, dim=axes).to(torch.bfloat16))(y_f, (1, L), axes=(1, 2))[:, 0, :S, :]
        y = y + kv * ssm_D[None, None, :]
        return q * y

    def _B_ref(x, w_gate, w_up, w_down):
        return (_gelu(x @ w_gate) * (x @ w_up)) @ w_down

    x = A_q
    g = _sigmoid((x * gate_w).sum(-1, keepdims=True))
    a = _A_ref(x, A_k, A_v, A_shift_k, A_ssm_k, A_ssm_D)
    b = _B_ref(x, B_w_gate, B_w_up, B_w_down)
    return g * a + (1 - g) * b
```

```asm
; @launch grid=(256,1,1) block=(512,1,1) lds=163840
.amdgcn_target "amdgcn-amd-amdhsa--gfx950"
.text
.globl gated_mix__ssm_conv_h3__geglu_ffn__prompt_kernel
.p2align 12
.p2align 8
.type gated_mix__ssm_conv_h3__geglu_ffn__prompt_kernel,@function
gated_mix__ssm_conv_h3__geglu_ffn__prompt_kernel:
    s_cmp_ge_u32 s2, 256
    s_cbranch_scc1 K_end
    s_load_dwordx4 s[4:7], s[0:1], 0
    s_load_dwordx4 s[28:31], s[0:1], 16
    s_load_dwordx4 s[32:35], s[0:1], 56
    s_load_dwordx2 s[36:37], s[0:1], 80
    s_load_dwordx2 s[38:39], s[0:1], 104
    s_load_dwordx4 s[60:63], s[0:1], 32
    s_load_dwordx4 s[64:67], s[0:1], 88
    s_load_dwordx2 s[84:85], s[0:1], 72
    v_lshrrev_b32 v1, 6, v0
    v_and_b32 v2, 63, v0
    s_nop 0
    v_readfirstlane_b32 s40, v1
    s_cmp_ge_u32 s2, 224
    s_cbranch_scc1 G1_prep
    s_and_b32 s41, s2, 7
    s_lshr_b32 s42, s2, 3
    s_and_b32 s43, s41, 1
    s_lshl_b32 s43, s43, 2
    s_and_b32 s44, s42, 3
    s_add_u32 s43, s43, s44
    s_lshr_b32 s44, s41, 1
    s_mul_i32 s44, s44, 7
    s_lshr_b32 s45, s42, 2
    s_add_u32 s44, s44, s45
    s_bfe_u32 s41, s40, 0x10001
    s_lshr_b32 s42, s40, 2
    s_lshl_b32 s42, s42, 1
    s_and_b32 s45, s40, 1
    s_add_u32 s42, s42, s45
    s_waitcnt lgkmcnt(0)
    s_mov_b64 s[36:37], s[84:85]
    s_mov_b32 s8, s4
    s_mov_b32 s9, s5
    s_mov_b32 s10, 4194304
    s_mov_b32 s11, 0x00020000
    s_mov_b32 s12, s32
    s_mov_b32 s13, s33
    s_mov_b32 s14, 7340032
    s_mov_b32 s15, 0x00020000
    s_mov_b32 s16, s34
    s_mov_b32 s17, s35
    s_mov_b32 s18, 7340032
    s_mov_b32 s19, 0x00020000
    s_add_u32 s20, s38, 100663296
    s_addc_u32 s21, s39, 0
    s_mov_b32 s22, 18350080
    s_mov_b32 s23, 0x00020000
    v_lshrrev_b32 v4, 3, v2
    v_and_b32 v5, 7, v2
    v_xor_b32 v5, v5, v4
    v_lshlrev_b32 v5, 4, v5
    s_lshl_b32 s45, s43, 8
    s_lshl_b32 s46, s40, 4
    s_add_u32 s46, s45, s46
    v_add_u32 v4, s46, v4
    v_lshlrev_b32 v4, 11, v4
    v_add_u32 v240, v4, v5
    v_add_u32 v241, 15360, v240
    v_lshrrev_b32 v5, 4, v0
    v_and_b32 v6, 7, v5
    v_lshlrev_b32 v6, 1, v6
    v_and_b32 v7, 15, v2
    v_xor_b32 v6, v6, v7
    v_lshlrev_b32 v6, 4, v6
    v_and_b32 v7, 19, v5
    v_lshrrev_b32 v8, 1, v5
    v_and_b32 v8, 4, v8
    v_lshlrev_b32 v9, 1, v5
    v_and_b32 v9, 8, v9
    v_or3_b32 v7, v7, v8, v9
    v_mul_u32_u24 v7, 7168, v7
    s_lshl_b32 s46, s44, 8
    v_add3_u32 v242, v7, v6, s46
    s_lshl_b32 s24, s40, 11
    s_lshl_b32 s25, s40, 10
    s_add_u32 s25, s25, 98304
    s_mov_b32 s26, 0
    s_mov_b32 s27, 0
    s_mov_b32 s85, 0
    s_mov_b32 s86, 0
    s_add_u32 s87, s24, s26
    s_add_u32 m0, s87, 0
    s_mov_b32 s88, s27
    buffer_load_dwordx4 v240, s[8:11], s88 offen lds
    buffer_load_dwordx4 v241, s[8:11], s88 offen offset:1024 lds
    s_add_u32 m0, s25, s86
    s_add_u32 s87, s25, s86
    buffer_load_dwordx4 v242, s[12:15], s85 offen lds
    s_add_u32 m0, s87, 8192
    s_add_u32 s86, s86, 16384
    buffer_load_dwordx4 v242, s[16:19], s85 offen lds
    s_add_u32 s85, s85, 229376
    s_and_b32 s86, s86, 65535
    s_add_u32 s87, s24, s26
    s_add_u32 m0, s87, 16384
    s_add_u32 s88, s27, 262144
    buffer_load_dwordx4 v240, s[8:11], s88 offen lds
    buffer_load_dwordx4 v241, s[8:11], s88 offen offset:1024 lds
    s_add_u32 s27, s27, 128
    s_add_u32 s26, s26, 32768
    s_cmp_eq_u32 s26, 98304
    s_cselect_b32 s26, 0, s26
    v_and_b32 v4, 15, v2
    v_and_b32 v5, 7, v2
    v_lshrrev_b32 v6, 4, v2
    v_xor_b32 v5, v5, v6
    v_lshlrev_b32 v5, 4, v5
    v_lshlrev_b32 v4, 7, v4
    s_lshl_b32 s46, s41, 14
    v_add3_u32 v243, v4, v5, s46
    v_xor_b32 v244, 64, v243
    v_bfe_u32 v4, v2, 2, 3
    v_lshrrev_b32 v5, 5, v2
    v_lshlrev_b32 v5, 4, v5
    v_or_b32 v5, v4, v5
    v_lshlrev_b32 v5, 8, v5
    s_lshl_b32 s46, s42, 1
    v_xor_b32 v4, s46, v4
    v_lshlrev_b32 v4, 5, v4
    v_and_b32 v6, 3, v2
    v_lshlrev_b32 v6, 3, v6
    v_add3_u32 v4, v4, v5, v6
    v_add_u32 v245, 98304, v4
    v_xor_b32 v246, 32, v245
    v_mov_b32 v16, 0
    v_mov_b32 v17, 0
    v_mov_b32 v18, 0
    v_mov_b32 v19, 0
    v_mov_b32 v20, 0
    v_mov_b32 v21, 0
    v_mov_b32 v22, 0
    v_mov_b32 v23, 0
    v_mov_b32 v24, 0
    v_mov_b32 v25, 0
    v_mov_b32 v26, 0
    v_mov_b32 v27, 0
    v_mov_b32 v28, 0
    v_mov_b32 v29, 0
    v_mov_b32 v30, 0
    v_mov_b32 v31, 0
    v_mov_b32 v32, 0
    v_mov_b32 v33, 0
    v_mov_b32 v34, 0
    v_mov_b32 v35, 0
    v_mov_b32 v36, 0
    v_mov_b32 v37, 0
    v_mov_b32 v38, 0
    v_mov_b32 v39, 0
    v_mov_b32 v40, 0
    v_mov_b32 v41, 0
    v_mov_b32 v42, 0
    v_mov_b32 v43, 0
    v_mov_b32 v44, 0
    v_mov_b32 v45, 0
    v_mov_b32 v46, 0
    v_mov_b32 v47, 0
    v_mov_b32 v48, 0
    v_mov_b32 v49, 0
    v_mov_b32 v50, 0
    v_mov_b32 v51, 0
    v_mov_b32 v52, 0
    v_mov_b32 v53, 0
    v_mov_b32 v54, 0
    v_mov_b32 v55, 0
    v_mov_b32 v56, 0
    v_mov_b32 v57, 0
    v_mov_b32 v58, 0
    v_mov_b32 v59, 0
    v_mov_b32 v60, 0
    v_mov_b32 v61, 0
    v_mov_b32 v62, 0
    v_mov_b32 v63, 0
    v_mov_b32 v64, 0
    v_mov_b32 v65, 0
    v_mov_b32 v66, 0
    v_mov_b32 v67, 0
    v_mov_b32 v68, 0
    v_mov_b32 v69, 0
    v_mov_b32 v70, 0
    v_mov_b32 v71, 0
    v_mov_b32 v72, 0
    v_mov_b32 v73, 0
    v_mov_b32 v74, 0
    v_mov_b32 v75, 0
    v_mov_b32 v76, 0
    v_mov_b32 v77, 0
    v_mov_b32 v78, 0
    v_mov_b32 v79, 0
    v_mov_b32 v80, 0
    v_mov_b32 v81, 0
    v_mov_b32 v82, 0
    v_mov_b32 v83, 0
    v_mov_b32 v84, 0
    v_mov_b32 v85, 0
    v_mov_b32 v86, 0
    v_mov_b32 v87, 0
    v_mov_b32 v88, 0
    v_mov_b32 v89, 0
    v_mov_b32 v90, 0
    v_mov_b32 v91, 0
    v_mov_b32 v92, 0
    v_mov_b32 v93, 0
    v_mov_b32 v94, 0
    v_mov_b32 v95, 0
    v_mov_b32 v96, 0
    v_mov_b32 v97, 0
    v_mov_b32 v98, 0
    v_mov_b32 v99, 0
    v_mov_b32 v100, 0
    v_mov_b32 v101, 0
    v_mov_b32 v102, 0
    v_mov_b32 v103, 0
    v_mov_b32 v104, 0
    v_mov_b32 v105, 0
    v_mov_b32 v106, 0
    v_mov_b32 v107, 0
    v_mov_b32 v108, 0
    v_mov_b32 v109, 0
    v_mov_b32 v110, 0
    v_mov_b32 v111, 0
    v_mov_b32 v112, 0
    v_mov_b32 v113, 0
    v_mov_b32 v114, 0
    v_mov_b32 v115, 0
    v_mov_b32 v116, 0
    v_mov_b32 v117, 0
    v_mov_b32 v118, 0
    v_mov_b32 v119, 0
    v_mov_b32 v120, 0
    v_mov_b32 v121, 0
    v_mov_b32 v122, 0
    v_mov_b32 v123, 0
    v_mov_b32 v124, 0
    v_mov_b32 v125, 0
    v_mov_b32 v126, 0
    v_mov_b32 v127, 0
    v_mov_b32 v128, 0
    v_mov_b32 v129, 0
    v_mov_b32 v130, 0
    v_mov_b32 v131, 0
    v_mov_b32 v132, 0
    v_mov_b32 v133, 0
    v_mov_b32 v134, 0
    v_mov_b32 v135, 0
    v_mov_b32 v136, 0
    v_mov_b32 v137, 0
    v_mov_b32 v138, 0
    v_mov_b32 v139, 0
    v_mov_b32 v140, 0
    v_mov_b32 v141, 0
    v_mov_b32 v142, 0
    v_mov_b32 v143, 0
    s_and_b32 s75, s2, 7
    s_lshr_b32 s76, s2, 3
    s_and_b32 s68, s75, 1
    s_lshl_b32 s68, s68, 3
    s_and_b32 s69, s75, 2
    s_lshl_b32 s69, s69, 1
    s_add_u32 s68, s68, s69
    s_lshr_b32 s83, s75, 2
    s_and_b32 s70, s76, 3
    s_add_u32 s68, s68, s70
    s_lshr_b32 s69, s76, 2
    s_lshl_b32 s69, s69, 1
    s_add_u32 s69, s69, s83
    s_and_b32 s70, s40, 3
    s_lshr_b32 s75, s70, 1
    s_and_b32 s76, s70, 1
    s_lshl_b32 s71, s68, 2
    s_lshl_b32 s72, s69, 6
    s_add_u32 s71, s71, s72
    s_add_u32 s71, s71, s70
    s_lshl_b32 s72, s71, 12
    s_mul_i32 s73, s70, 17728
    s_add_u32 s73, s73, 40960
    s_lshr_b32 s74, s71, 1
    s_lshl_b32 s74, s74, 2
    s_load_dword s74, s[62:63], s74
    s_lshl_b32 s77, s69, 18
    s_and_b32 s78, s71, 63
    s_lshl_b32 s78, s78, 8
    s_add_u32 s77, s77, s78
    s_add_u32 s48, s38, 16777216
    s_addc_u32 s49, s39, 0
    s_mov_b32 s50, 4194368
    s_mov_b32 s51, 0x00020000
    s_mov_b32 s52, s60
    s_mov_b32 s53, s61
    s_mov_b32 s54, 4194304
    s_mov_b32 s55, 0x00020000
    s_mov_b32 s56, s66
    s_mov_b32 s57, s67
    s_mov_b32 s58, 256
    s_mov_b32 s59, 0x00020000
    v_lshlrev_b32 v4, 4, v2
    v_add_u32 v5, 12, v4
    v_add_u32 v6, 2, v4
    v_mov_b32 v7, 0x7ff00000
    v_lshlrev_b32 v8, 2, v2
    v_cmp_eq_u32 vcc, 0, v2
    v_mov_b32 v9, 4094
    v_cndmask_b32 v9, v7, v9, vcc
    v_and_b32 v12, 1, v2
    v_mul_u32_u24 v12, 4224, v12
    v_bfe_u32 v11, v2, 1, 3
    v_lshlrev_b32 v11, 3, v11
    v_lshrrev_b32 v13, 4, v2
    v_lshlrev_b32 v13, 4, v13
    v_sub_u32 v11, v13, v11
    v_add3_u32 v3, v12, v11, s73
    v_add_u32 v3, 56, v3
    v_bfe_u32 v11, v2, 1, 3
    v_lshlrev_b32 v11, 6, v11
    v_add_u32 v15, v11, v13
    v_sub_u32 v15, 4720, v15
    v_add_u32 v15, s73, v15
    v_and_b32 v12, 1, v2
    v_mul_u32_u24 v12, 4640, v12
    v_sub_u32 v12, 13088, v12
    v_add3_u32 v11, v11, v13, v12
    v_add_u32 v14, s73, v11
    v_and_b32 v12, 1, v2
    v_bfe_u32 v11, v2, 3, 1
    v_lshl_add_u32 v11, v12, 1, v11
    v_lshlrev_b32 v11, 14, v11
    v_bfe_u32 v250, v2, 1, 2
    v_lshlrev_b32 v250, 6, v250
    v_add3_u32 v250, v250, v11, v13
    v_cmp_eq_u32 s[80:81], 1, v12
    s_lshl_b32 s78, s75, 12
    v_add_u32 v251, s78, v4
    v_bfe_u32 v11, v2, 2, 3
    v_lshrrev_b32 v12, 5, v2
    v_lshlrev_b32 v12, 4, v12
    v_or_b32 v12, v11, v12
    v_lshlrev_b32 v12, 7, v12
    v_lshrrev_b32 v11, 1, v11
    s_lshl_b32 s78, s76, 1
    v_xor_b32 v11, s78, v11
    v_lshlrev_b32 v11, 5, v11
    v_and_b32 v13, 3, v2
    v_lshlrev_b32 v13, 3, v13
    v_add3_u32 v11, v11, v12, v13
    v_add_u32 v252, 155648, v11
    v_xor_b32 v253, 32, v252
    v_and_b32 v11, 31, v2
    v_lshlrev_b32 v255, 2, v11
    v_lshrrev_b32 v11, 4, v2
    v_and_b32 v12, 1, v11
    v_lshlrev_b32 v12, 1, v12
    v_lshrrev_b32 v13, 1, v11
    v_add_u32 v12, v12, v13
    v_lshlrev_b32 v12, 8, v12
    v_and_b32 v10, 15, v2
    v_lshlrev_b32 v10, 4, v10
    s_lshl_b32 s46, s43, 1
    s_add_u32 s46, s46, s41
    s_lshl_b32 s79, s46, 9
    s_mul_i32 s46, s46, 112
    s_lshr_b32 s47, s42, 1
    s_cmp_ge_u32 s44, 14
    s_addc_u32 s47, s47, 0
    s_mul_i32 s47, s47, 28
    s_lshl_b32 s84, s44, 1
    s_add_u32 s47, s47, s84
    s_and_b32 s84, s42, 1
    s_add_u32 s47, s47, s84
    s_add_u32 s46, s46, s47
    s_mul_i32 s46, s46, 10240
    v_add_u32 v10, v10, v12
    v_lshrrev_b32 v11, 7, v10
    v_cmp_eq_u32 vcc, 3, v11
    v_mov_b32 v11, 7808
    v_mov_b32 v12, -768
    v_mov_b32 v13, 0
    v_cndmask_b32 v1, v13, v12, vcc
    v_cndmask_b32 v12, v13, v11, vcc
    v_add3_u32 v10, v10, v12, s46
    s_lshl_b32 s47, s47, 2
    s_add_u32 s79, s79, s47
    s_add_u32 s79, s79, 1024
    s_lshl_b32 s79, s79, 5
    s_add_u32 s44, s38, 100663296
    s_addc_u32 s45, s39, 0
    s_mov_b32 s46, 18350080
    s_mov_b32 s47, 0x00020000
    s_add_u32 s28, s38, 67108864
    s_addc_u32 s29, s39, 0
    s_mov_b32 s30, 430080
    s_mov_b32 s31, 0x00020000
    v_mov_b32 v11, 1
    v_mov_b32 v12, 0
    s_add_u32 m0, s25, s86
    s_add_u32 s87, s25, s86
    buffer_load_dwordx4 v242, s[12:15], s85 offen lds
    s_add_u32 m0, s87, 8192
    s_add_u32 s86, s86, 16384
    buffer_load_dwordx4 v242, s[16:19], s85 offen lds
    s_add_u32 s85, s85, 229376
    s_and_b32 s86, s86, 65535
    s_add_u32 s87, s24, s26
    s_add_u32 m0, s87, 0
    s_mov_b32 s88, s27
    buffer_load_dwordx4 v240, s[8:11], s88 offen lds
    buffer_load_dwordx4 v241, s[8:11], s88 offen offset:1024 lds
    s_add_u32 m0, s25, s86
    s_add_u32 s87, s25, s86
    buffer_load_dwordx4 v242, s[12:15], s85 offen lds
    s_add_u32 m0, s87, 8192
    s_add_u32 s86, s86, 16384
    buffer_load_dwordx4 v242, s[16:19], s85 offen lds
    s_add_u32 s85, s85, 229376
    s_and_b32 s86, s86, 65535
    s_add_u32 s87, s24, s26
    s_add_u32 m0, s87, 16384
    s_add_u32 s88, s27, 262144
    buffer_load_dwordx4 v240, s[8:11], s88 offen lds
    buffer_load_dwordx4 v241, s[8:11], s88 offen offset:1024 lds
    s_add_u32 s27, s27, 128
    s_add_u32 s26, s26, 32768
    s_cmp_eq_u32 s26, 98304
    s_cselect_b32 s26, 0, s26
    s_add_u32 m0, s25, s86
    s_add_u32 s87, s25, s86
    buffer_load_dwordx4 v242, s[12:15], s85 offen lds
    s_add_u32 m0, s87, 8192
    s_add_u32 s86, s86, 16384
    buffer_load_dwordx4 v242, s[16:19], s85 offen lds
    s_add_u32 s85, s85, 229376
    s_and_b32 s86, s86, 65535
    s_add_u32 s87, s24, s26
    s_add_u32 m0, s87, 0
    s_mov_b32 s88, s27
    buffer_load_dwordx4 v240, s[8:11], s88 offen lds
    buffer_load_dwordx4 v241, s[8:11], s88 offen offset:1024 lds
    s_cmp_lt_u32 s40, 4
    s_cbranch_scc1 G1_grpA
    s_waitcnt vmcnt(12)
    s_barrier
    s_mov_b32 s90, 0
    s_mov_b32 s91, 0
    v_add_u32 v247, s90, v243
    v_add_u32 v248, s91, v245
    v_add_u32 v249, s91, v246
    ds_read_b64_tr_b16 v[208:209], v248 offset:0
    ds_read_b64_tr_b16 v[210:211], v248 offset:2048
    ds_read_b128 v[144:147], v247 offset:0
    ds_read_b128 v[148:151], v247 offset:2048
    ds_read_b128 v[152:155], v247 offset:4096
    ds_read_b128 v[156:159], v247 offset:6144
    ds_read_b128 v[160:163], v247 offset:8192
    ds_read_b128 v[164:167], v247 offset:10240
    ds_read_b128 v[168:171], v247 offset:12288
    ds_read_b128 v[172:175], v247 offset:14336
    ds_read_b64_tr_b16 v[212:213], v249 offset:0
    ds_read_b64_tr_b16 v[214:215], v249 offset:2048
    ds_read_b64_tr_b16 v[216:217], v248 offset:8192
    ds_read_b64_tr_b16 v[218:219], v248 offset:10240
    ds_read_b64_tr_b16 v[220:221], v249 offset:8192
    ds_read_b64_tr_b16 v[222:223], v249 offset:10240
    s_add_u32 s91, s91, 16384
    s_and_b32 s91, s91, 65535
    s_mov_b32 s89, 0
G1_loopB:
    s_waitcnt vmcnt(8) lgkmcnt(0)
    s_barrier
    v_mfma_f32_16x16x32_bf16 v[16:19], v[208:211], v[144:147], v[16:19]
    v_mfma_f32_16x16x32_bf16 v[20:23], v[212:215], v[144:147], v[20:23]
    v_add_u32 v247, s90, v244
    v_add_u32 v248, s91, v245
    v_add_u32 v249, s91, v246
    v_mfma_f32_16x16x32_bf16 v[24:27], v[216:219], v[144:147], v[24:27]
    ds_read_b64_tr_b16 v[224:225], v248 offset:0
    v_mfma_f32_16x16x32_bf16 v[28:31], v[220:223], v[144:147], v[28:31]
    ds_read_b64_tr_b16 v[226:227], v248 offset:2048
    v_mfma_f32_16x16x32_bf16 v[44:47], v[220:223], v[148:151], v[44:47]
    ds_read_b128 v[176:179], v247 offset:0
    v_mfma_f32_16x16x32_bf16 v[40:43], v[216:219], v[148:151], v[40:43]
    s_add_u32 m0, s25, s86
    s_add_u32 s87, s25, s86
    buffer_load_dwordx4 v242, s[12:15], s85 offen lds
    v_mfma_f32_16x16x32_bf16 v[36:39], v[212:215], v[148:151], v[36:39]
    ds_read_b128 v[180:183], v247 offset:2048
    v_mfma_f32_16x16x32_bf16 v[32:35], v[208:211], v[148:151], v[32:35]
    ds_read_b128 v[184:187], v247 offset:4096
    v_mfma_f32_16x16x32_bf16 v[48:51], v[208:211], v[152:155], v[48:51]
    ds_read_b128 v[188:191], v247 offset:6144
    v_mfma_f32_16x16x32_bf16 v[52:55], v[212:215], v[152:155], v[52:55]
    ds_read_b128 v[192:195], v247 offset:8192
    v_mfma_f32_16x16x32_bf16 v[56:59], v[216:219], v[152:155], v[56:59]
    ds_read_b128 v[196:199], v247 offset:10240
    v_mfma_f32_16x16x32_bf16 v[60:63], v[220:223], v[152:155], v[60:63]
    ds_read_b128 v[200:203], v247 offset:12288
    v_mfma_f32_16x16x32_bf16 v[76:79], v[220:223], v[156:159], v[76:79]
    ds_read_b128 v[204:207], v247 offset:14336
    v_mfma_f32_16x16x32_bf16 v[72:75], v[216:219], v[156:159], v[72:75]
    s_add_u32 m0, s87, 8192
    s_add_u32 s86, s86, 16384
    buffer_load_dwordx4 v242, s[16:19], s85 offen lds
    s_add_u32 s85, s85, 229376
    s_and_b32 s86, s86, 65535
    v_mfma_f32_16x16x32_bf16 v[68:71], v[212:215], v[156:159], v[68:71]
    ds_read_b64_tr_b16 v[228:229], v249 offset:0
    v_mfma_f32_16x16x32_bf16 v[64:67], v[208:211], v[156:159], v[64:67]
    ds_read_b64_tr_b16 v[230:231], v249 offset:2048
    v_mfma_f32_16x16x32_bf16 v[80:83], v[208:211], v[160:163], v[80:83]
    ds_read_b64_tr_b16 v[232:233], v248 offset:8192
    v_mfma_f32_16x16x32_bf16 v[84:87], v[212:215], v[160:163], v[84:87]
    ds_read_b64_tr_b16 v[234:235], v248 offset:10240
    v_mfma_f32_16x16x32_bf16 v[88:91], v[216:219], v[160:163], v[88:91]
    ds_read_b64_tr_b16 v[236:237], v249 offset:8192
    v_mfma_f32_16x16x32_bf16 v[92:95], v[220:223], v[160:163], v[92:95]
    ds_read_b64_tr_b16 v[238:239], v249 offset:10240
    v_mfma_f32_16x16x32_bf16 v[108:111], v[220:223], v[164:167], v[108:111]
    s_add_u32 s91, s91, 16384
    s_and_b32 s91, s91, 65535
    s_add_u32 s90, s90, 32768
    s_cmp_eq_u32 s90, 98304
    s_cselect_b32 s90, 0, s90
    v_mfma_f32_16x16x32_bf16 v[104:107], v[216:219], v[164:167], v[104:107]
    s_add_u32 s87, s24, s26
    s_add_u32 m0, s87, 16384
    s_add_u32 s88, s27, 262144
    buffer_load_dwordx4 v240, s[8:11], s88 offen lds
    v_mfma_f32_16x16x32_bf16 v[100:103], v[212:215], v[164:167], v[100:103]
    v_mfma_f32_16x16x32_bf16 v[96:99], v[208:211], v[164:167], v[96:99]
    v_mfma_f32_16x16x32_bf16 v[112:115], v[208:211], v[168:171], v[112:115]
    v_mfma_f32_16x16x32_bf16 v[116:119], v[212:215], v[168:171], v[116:119]
    v_mfma_f32_16x16x32_bf16 v[120:123], v[216:219], v[168:171], v[120:123]
    v_mfma_f32_16x16x32_bf16 v[124:127], v[220:223], v[168:171], v[124:127]
    v_mfma_f32_16x16x32_bf16 v[140:143], v[220:223], v[172:175], v[140:143]
    v_mfma_f32_16x16x32_bf16 v[136:139], v[216:219], v[172:175], v[136:139]
    buffer_load_dwordx4 v241, s[8:11], s88 offen offset:1024 lds
    s_add_u32 s27, s27, 128
    s_add_u32 s26, s26, 32768
    s_cmp_eq_u32 s26, 98304
    s_cselect_b32 s26, 0, s26
    v_mfma_f32_16x16x32_bf16 v[132:135], v[212:215], v[172:175], v[132:135]
    v_mfma_f32_16x16x32_bf16 v[128:131], v[208:211], v[172:175], v[128:131]
    s_waitcnt vmcnt(8) lgkmcnt(0)
    s_barrier
    v_mfma_f32_16x16x32_bf16 v[16:19], v[224:227], v[176:179], v[16:19]
    v_mfma_f32_16x16x32_bf16 v[20:23], v[228:231], v[176:179], v[20:23]
    v_add_u32 v247, s90, v243
    v_add_u32 v248, s91, v245
    v_add_u32 v249, s91, v246
    v_mfma_f32_16x16x32_bf16 v[24:27], v[232:235], v[176:179], v[24:27]
    ds_read_b64_tr_b16 v[208:209], v248 offset:0
    v_mfma_f32_16x16x32_bf16 v[28:31], v[236:239], v[176:179], v[28:31]
    ds_read_b64_tr_b16 v[210:211], v248 offset:2048
    v_mfma_f32_16x16x32_bf16 v[44:47], v[236:239], v[180:183], v[44:47]
    ds_read_b128 v[144:147], v247 offset:0
    v_mfma_f32_16x16x32_bf16 v[40:43], v[232:235], v[180:183], v[40:43]
    s_add_u32 m0, s25, s86
    s_add_u32 s87, s25, s86
    buffer_load_dwordx4 v242, s[12:15], s85 offen lds
    v_mfma_f32_16x16x32_bf16 v[36:39], v[228:231], v[180:183], v[36:39]
    ds_read_b128 v[148:151], v247 offset:2048
    v_mfma_f32_16x16x32_bf16 v[32:35], v[224:227], v[180:183], v[32:35]
    ds_read_b128 v[152:155], v247 offset:4096
    v_mfma_f32_16x16x32_bf16 v[48:51], v[224:227], v[184:187], v[48:51]
    ds_read_b128 v[156:159], v247 offset:6144
    v_mfma_f32_16x16x32_bf16 v[52:55], v[228:231], v[184:187], v[52:55]
    ds_read_b128 v[160:163], v247 offset:8192
    v_mfma_f32_16x16x32_bf16 v[56:59], v[232:235], v[184:187], v[56:59]
    ds_read_b128 v[164:167], v247 offset:10240
    v_mfma_f32_16x16x32_bf16 v[60:63], v[236:239], v[184:187], v[60:63]
    ds_read_b128 v[168:171], v247 offset:12288
    v_mfma_f32_16x16x32_bf16 v[76:79], v[236:239], v[188:191], v[76:79]
    ds_read_b128 v[172:175], v247 offset:14336
    v_mfma_f32_16x16x32_bf16 v[72:75], v[232:235], v[188:191], v[72:75]
    s_add_u32 m0, s87, 8192
    s_add_u32 s86, s86, 16384
    buffer_load_dwordx4 v242, s[16:19], s85 offen lds
    s_add_u32 s85, s85, 229376
    s_and_b32 s86, s86, 65535
    v_mfma_f32_16x16x32_bf16 v[68:71], v[228:231], v[188:191], v[68:71]
    ds_read_b64_tr_b16 v[212:213], v249 offset:0
    v_mfma_f32_16x16x32_bf16 v[64:67], v[224:227], v[188:191], v[64:67]
    ds_read_b64_tr_b16 v[214:215], v249 offset:2048
    v_mfma_f32_16x16x32_bf16 v[80:83], v[224:227], v[192:195], v[80:83]
    ds_read_b64_tr_b16 v[216:217], v248 offset:8192
    v_mfma_f32_16x16x32_bf16 v[84:87], v[228:231], v[192:195], v[84:87]
    ds_read_b64_tr_b16 v[218:219], v248 offset:10240
    v_mfma_f32_16x16x32_bf16 v[88:91], v[232:235], v[192:195], v[88:91]
    ds_read_b64_tr_b16 v[220:221], v249 offset:8192
    v_mfma_f32_16x16x32_bf16 v[92:95], v[236:239], v[192:195], v[92:95]
    ds_read_b64_tr_b16 v[222:223], v249 offset:10240
    v_mfma_f32_16x16x32_bf16 v[108:111], v[236:239], v[196:199], v[108:111]
    s_add_u32 s91, s91, 16384
    s_and_b32 s91, s91, 65535
    v_mfma_f32_16x16x32_bf16 v[104:107], v[232:235], v[196:199], v[104:107]
    s_add_u32 s87, s24, s26
    s_add_u32 m0, s87, 0
    s_mov_b32 s88, s27
    buffer_load_dwordx4 v240, s[8:11], s88 offen lds
    v_mfma_f32_16x16x32_bf16 v[100:103], v[228:231], v[196:199], v[100:103]
    v_mfma_f32_16x16x32_bf16 v[96:99], v[224:227], v[196:199], v[96:99]
    v_mfma_f32_16x16x32_bf16 v[112:115], v[224:227], v[200:203], v[112:115]
    v_mfma_f32_16x16x32_bf16 v[116:119], v[228:231], v[200:203], v[116:119]
    v_mfma_f32_16x16x32_bf16 v[120:123], v[232:235], v[200:203], v[120:123]
    v_mfma_f32_16x16x32_bf16 v[124:127], v[236:239], v[200:203], v[124:127]
    v_mfma_f32_16x16x32_bf16 v[140:143], v[236:239], v[204:207], v[140:143]
    v_mfma_f32_16x16x32_bf16 v[136:139], v[232:235], v[204:207], v[136:139]
    buffer_load_dwordx4 v241, s[8:11], s88 offen offset:1024 lds
    v_mfma_f32_16x16x32_bf16 v[132:135], v[228:231], v[204:207], v[132:135]
    v_mfma_f32_16x16x32_bf16 v[128:131], v[224:227], v[204:207], v[128:131]
    s_add_u32 s89, s89, 2
    s_cmp_lt_u32 s89, 26
    s_cbranch_scc1 G1_loopB
G1_tailB:
    s_waitcnt vmcnt(8) lgkmcnt(0)
    s_barrier
    v_mfma_f32_16x16x32_bf16 v[16:19], v[208:211], v[144:147], v[16:19]
    v_mfma_f32_16x16x32_bf16 v[20:23], v[212:215], v[144:147], v[20:23]
    v_add_u32 v247, s90, v244
    v_add_u32 v248, s91, v245
    v_add_u32 v249, s91, v246
    v_mfma_f32_16x16x32_bf16 v[24:27], v[216:219], v[144:147], v[24:27]
    ds_read_b64_tr_b16 v[224:225], v248 offset:0
    v_mfma_f32_16x16x32_bf16 v[28:31], v[220:223], v[144:147], v[28:31]
    ds_read_b64_tr_b16 v[226:227], v248 offset:2048
    v_mfma_f32_16x16x32_bf16 v[44:47], v[220:223], v[148:151], v[44:47]
    ds_read_b128 v[176:179], v247 offset:0
    v_mfma_f32_16x16x32_bf16 v[40:43], v[216:219], v[148:151], v[40:43]
    s_add_u32 m0, s25, s86
    s_add_u32 s87, s25, s86
    buffer_load_dwordx4 v242, s[12:15], s85 offen lds
    v_mfma_f32_16x16x32_bf16 v[36:39], v[212:215], v[148:151], v[36:39]
    ds_read_b128 v[180:183], v247 offset:2048
    v_mfma_f32_16x16x32_bf16 v[32:35], v[208:211], v[148:151], v[32:35]
    ds_read_b128 v[184:187], v247 offset:4096
    v_mfma_f32_16x16x32_bf16 v[48:51], v[208:211], v[152:155], v[48:51]
    ds_read_b128 v[188:191], v247 offset:6144
    v_mfma_f32_16x16x32_bf16 v[52:55], v[212:215], v[152:155], v[52:55]
    ds_read_b128 v[192:195], v247 offset:8192
    v_mfma_f32_16x16x32_bf16 v[56:59], v[216:219], v[152:155], v[56:59]
    ds_read_b128 v[196:199], v247 offset:10240
    v_mfma_f32_16x16x32_bf16 v[60:63], v[220:223], v[152:155], v[60:63]
    ds_read_b128 v[200:203], v247 offset:12288
    v_mfma_f32_16x16x32_bf16 v[76:79], v[220:223], v[156:159], v[76:79]
    ds_read_b128 v[204:207], v247 offset:14336
    v_mfma_f32_16x16x32_bf16 v[72:75], v[216:219], v[156:159], v[72:75]
    s_add_u32 m0, s87, 8192
    s_add_u32 s86, s86, 16384
    buffer_load_dwordx4 v242, s[16:19], s85 offen lds
    s_add_u32 s85, s85, 229376
    s_and_b32 s86, s86, 65535
    v_mfma_f32_16x16x32_bf16 v[68:71], v[212:215], v[156:159], v[68:71]
    ds_read_b64_tr_b16 v[228:229], v249 offset:0
    v_mfma_f32_16x16x32_bf16 v[64:67], v[208:211], v[156:159], v[64:67]
    ds_read_b64_tr_b16 v[230:231], v249 offset:2048
    v_mfma_f32_16x16x32_bf16 v[80:83], v[208:211], v[160:163], v[80:83]
    ds_read_b64_tr_b16 v[232:233], v248 offset:8192
    v_mfma_f32_16x16x32_bf16 v[84:87], v[212:215], v[160:163], v[84:87]
    ds_read_b64_tr_b16 v[234:235], v248 offset:10240
    v_mfma_f32_16x16x32_bf16 v[88:91], v[216:219], v[160:163], v[88:91]
    ds_read_b64_tr_b16 v[236:237], v249 offset:8192
    v_mfma_f32_16x16x32_bf16 v[92:95], v[220:223], v[160:163], v[92:95]
    ds_read_b64_tr_b16 v[238:239], v249 offset:10240
    v_mfma_f32_16x16x32_bf16 v[108:111], v[220:223], v[164:167], v[108:111]
    s_add_u32 s91, s91, 16384
    s_and_b32 s91, s91, 65535
    s_add_u32 s90, s90, 32768
    s_cmp_eq_u32 s90, 98304
    s_cselect_b32 s90, 0, s90
    v_mfma_f32_16x16x32_bf16 v[104:107], v[216:219], v[164:167], v[104:107]
    s_add_u32 s87, s24, s26
    s_add_u32 m0, s87, 16384
    s_add_u32 s88, s27, 262144
    buffer_load_dwordx4 v240, s[8:11], s88 offen lds
    v_mfma_f32_16x16x32_bf16 v[100:103], v[212:215], v[164:167], v[100:103]
    v_mfma_f32_16x16x32_bf16 v[96:99], v[208:211], v[164:167], v[96:99]
    v_mfma_f32_16x16x32_bf16 v[112:115], v[208:211], v[168:171], v[112:115]
    v_mfma_f32_16x16x32_bf16 v[116:119], v[212:215], v[168:171], v[116:119]
    v_mfma_f32_16x16x32_bf16 v[120:123], v[216:219], v[168:171], v[120:123]
    v_mfma_f32_16x16x32_bf16 v[124:127], v[220:223], v[168:171], v[124:127]
    v_mfma_f32_16x16x32_bf16 v[140:143], v[220:223], v[172:175], v[140:143]
    v_mfma_f32_16x16x32_bf16 v[136:139], v[216:219], v[172:175], v[136:139]
    buffer_load_dwordx4 v241, s[8:11], s88 offen offset:1024 lds
    s_add_u32 s27, s27, 128
    s_add_u32 s26, s26, 32768
    s_cmp_eq_u32 s26, 98304
    s_cselect_b32 s26, 0, s26
    v_mfma_f32_16x16x32_bf16 v[132:135], v[212:215], v[172:175], v[132:135]
    v_mfma_f32_16x16x32_bf16 v[128:131], v[208:211], v[172:175], v[128:131]
    s_waitcnt vmcnt(8) lgkmcnt(0)
    s_barrier
    v_mfma_f32_16x16x32_bf16 v[16:19], v[224:227], v[176:179], v[16:19]
    v_mfma_f32_16x16x32_bf16 v[20:23], v[228:231], v[176:179], v[20:23]
    v_add_u32 v247, s90, v243
    v_add_u32 v248, s91, v245
    v_add_u32 v249, s91, v246
    v_mfma_f32_16x16x32_bf16 v[24:27], v[232:235], v[176:179], v[24:27]
    ds_read_b64_tr_b16 v[208:209], v248 offset:0
    v_mfma_f32_16x16x32_bf16 v[28:31], v[236:239], v[176:179], v[28:31]
    ds_read_b64_tr_b16 v[210:211], v248 offset:2048
    v_mfma_f32_16x16x32_bf16 v[44:47], v[236:239], v[180:183], v[44:47]
    ds_read_b128 v[144:147], v247 offset:0
    v_mfma_f32_16x16x32_bf16 v[40:43], v[232:235], v[180:183], v[40:43]
    s_add_u32 m0, s25, s86
    s_add_u32 s87, s25, s86
    buffer_load_dwordx4 v242, s[12:15], s85 offen lds
    v_mfma_f32_16x16x32_bf16 v[36:39], v[228:231], v[180:183], v[36:39]
    ds_read_b128 v[148:151], v247 offset:2048
    v_mfma_f32_16x16x32_bf16 v[32:35], v[224:227], v[180:183], v[32:35]
    ds_read_b128 v[152:155], v247 offset:4096
    v_mfma_f32_16x16x32_bf16 v[48:51], v[224:227], v[184:187], v[48:51]
    ds_read_b128 v[156:159], v247 offset:6144
    v_mfma_f32_16x16x32_bf16 v[52:55], v[228:231], v[184:187], v[52:55]
    ds_read_b128 v[160:163], v247 offset:8192
    v_mfma_f32_16x16x32_bf16 v[56:59], v[232:235], v[184:187], v[56:59]
    ds_read_b128 v[164:167], v247 offset:10240
    v_mfma_f32_16x16x32_bf16 v[60:63], v[236:239], v[184:187], v[60:63]
    ds_read_b128 v[168:171], v247 offset:12288
    v_mfma_f32_16x16x32_bf16 v[76:79], v[236:239], v[188:191], v[76:79]
    ds_read_b128 v[172:175], v247 offset:14336
    v_mfma_f32_16x16x32_bf16 v[72:75], v[232:235], v[188:191], v[72:75]
    s_add_u32 m0, s87, 8192
    s_add_u32 s86, s86, 16384
    buffer_load_dwordx4 v242, s[16:19], s85 offen lds
    s_add_u32 s85, s85, 229376
    s_and_b32 s86, s86, 65535
    v_mfma_f32_16x16x32_bf16 v[68:71], v[228:231], v[188:191], v[68:71]
    ds_read_b64_tr_b16 v[212:213], v249 offset:0
    v_mfma_f32_16x16x32_bf16 v[64:67], v[224:227], v[188:191], v[64:67]
    ds_read_b64_tr_b16 v[214:215], v249 offset:2048
    v_mfma_f32_16x16x32_bf16 v[80:83], v[224:227], v[192:195], v[80:83]
    ds_read_b64_tr_b16 v[216:217], v248 offset:8192
    v_mfma_f32_16x16x32_bf16 v[84:87], v[228:231], v[192:195], v[84:87]
    ds_read_b64_tr_b16 v[218:219], v248 offset:10240
    v_mfma_f32_16x16x32_bf16 v[88:91], v[232:235], v[192:195], v[88:91]
    ds_read_b64_tr_b16 v[220:221], v249 offset:8192
    v_mfma_f32_16x16x32_bf16 v[92:95], v[236:239], v[192:195], v[92:95]
    ds_read_b64_tr_b16 v[222:223], v249 offset:10240
    v_mfma_f32_16x16x32_bf16 v[108:111], v[236:239], v[196:199], v[108:111]
    s_add_u32 s91, s91, 16384
    s_and_b32 s91, s91, 65535
    v_mfma_f32_16x16x32_bf16 v[104:107], v[232:235], v[196:199], v[104:107]
    v_mfma_f32_16x16x32_bf16 v[100:103], v[228:231], v[196:199], v[100:103]
    v_mfma_f32_16x16x32_bf16 v[96:99], v[224:227], v[196:199], v[96:99]
    v_mfma_f32_16x16x32_bf16 v[112:115], v[224:227], v[200:203], v[112:115]
    v_mfma_f32_16x16x32_bf16 v[116:119], v[228:231], v[200:203], v[116:119]
    v_mfma_f32_16x16x32_bf16 v[120:123], v[232:235], v[200:203], v[120:123]
    v_mfma_f32_16x16x32_bf16 v[124:127], v[236:239], v[200:203], v[124:127]
    v_mfma_f32_16x16x32_bf16 v[140:143], v[236:239], v[204:207], v[140:143]
    v_mfma_f32_16x16x32_bf16 v[136:139], v[232:235], v[204:207], v[136:139]
    v_mfma_f32_16x16x32_bf16 v[132:135], v[228:231], v[204:207], v[132:135]
    v_mfma_f32_16x16x32_bf16 v[128:131], v[224:227], v[204:207], v[128:131]
    s_waitcnt vmcnt(6) lgkmcnt(0)
    s_barrier
    v_mfma_f32_16x16x32_bf16 v[16:19], v[208:211], v[144:147], v[16:19]
    v_mfma_f32_16x16x32_bf16 v[20:23], v[212:215], v[144:147], v[20:23]
    v_add_u32 v247, s90, v244
    v_add_u32 v248, s91, v245
    v_add_u32 v249, s91, v246
    v_mfma_f32_16x16x32_bf16 v[24:27], v[216:219], v[144:147], v[24:27]
    ds_read_b64_tr_b16 v[224:225], v248 offset:0
    v_mfma_f32_16x16x32_bf16 v[28:31], v[220:223], v[144:147], v[28:31]
    ds_read_b64_tr_b16 v[226:227], v248 offset:2048
    v_mfma_f32_16x16x32_bf16 v[44:47], v[220:223], v[148:151], v[44:47]
    ds_read_b128 v[176:179], v247 offset:0
    v_mfma_f32_16x16x32_bf16 v[40:43], v[216:219], v[148:151], v[40:43]
    ds_read_b128 v[180:183], v247 offset:2048
    v_mfma_f32_16x16x32_bf16 v[36:39], v[212:215], v[148:151], v[36:39]
    ds_read_b128 v[184:187], v247 offset:4096
    v_mfma_f32_16x16x32_bf16 v[32:35], v[208:211], v[148:151], v[32:35]
    ds_read_b128 v[188:191], v247 offset:6144
    v_mfma_f32_16x16x32_bf16 v[48:51], v[208:211], v[152:155], v[48:51]
    ds_read_b128 v[192:195], v247 offset:8192
    v_mfma_f32_16x16x32_bf16 v[52:55], v[212:215], v[152:155], v[52:55]
    ds_read_b128 v[196:199], v247 offset:10240
    v_mfma_f32_16x16x32_bf16 v[56:59], v[216:219], v[152:155], v[56:59]
    ds_read_b128 v[200:203], v247 offset:12288
    v_mfma_f32_16x16x32_bf16 v[60:63], v[220:223], v[152:155], v[60:63]
    ds_read_b128 v[204:207], v247 offset:14336
    v_mfma_f32_16x16x32_bf16 v[76:79], v[220:223], v[156:159], v[76:79]
    ds_read_b64_tr_b16 v[228:229], v249 offset:0
    v_mfma_f32_16x16x32_bf16 v[72:75], v[216:219], v[156:159], v[72:75]
    ds_read_b64_tr_b16 v[230:231], v249 offset:2048
    v_mfma_f32_16x16x32_bf16 v[68:71], v[212:215], v[156:159], v[68:71]
    ds_read_b64_tr_b16 v[232:233], v248 offset:8192
    v_mfma_f32_16x16x32_bf16 v[64:67], v[208:211], v[156:159], v[64:67]
    ds_read_b64_tr_b16 v[234:235], v248 offset:10240
    v_mfma_f32_16x16x32_bf16 v[80:83], v[208:211], v[160:163], v[80:83]
    ds_read_b64_tr_b16 v[236:237], v249 offset:8192
    v_mfma_f32_16x16x32_bf16 v[84:87], v[212:215], v[160:163], v[84:87]
    ds_read_b64_tr_b16 v[238:239], v249 offset:10240
    v_mfma_f32_16x16x32_bf16 v[88:91], v[216:219], v[160:163], v[88:91]
    s_add_u32 s91, s91, 16384
    s_and_b32 s91, s91, 65535
    s_add_u32 s90, s90, 32768
    s_cmp_eq_u32 s90, 98304
    s_cselect_b32 s90, 0, s90
    v_mfma_f32_16x16x32_bf16 v[92:95], v[220:223], v[160:163], v[92:95]
    v_mfma_f32_16x16x32_bf16 v[108:111], v[220:223], v[164:167], v[108:111]
    v_mfma_f32_16x16x32_bf16 v[104:107], v[216:219], v[164:167], v[104:107]
    v_mfma_f32_16x16x32_bf16 v[100:103], v[212:215], v[164:167], v[100:103]
    v_mfma_f32_16x16x32_bf16 v[96:99], v[208:211], v[164:167], v[96:99]
    v_mfma_f32_16x16x32_bf16 v[112:115], v[208:211], v[168:171], v[112:115]
    v_mfma_f32_16x16x32_bf16 v[116:119], v[212:215], v[168:171], v[116:119]
    v_mfma_f32_16x16x32_bf16 v[120:123], v[216:219], v[168:171], v[120:123]
    v_mfma_f32_16x16x32_bf16 v[124:127], v[220:223], v[168:171], v[124:127]
    v_mfma_f32_16x16x32_bf16 v[140:143], v[220:223], v[172:175], v[140:143]
    v_mfma_f32_16x16x32_bf16 v[136:139], v[216:219], v[172:175], v[136:139]
    v_mfma_f32_16x16x32_bf16 v[132:135], v[212:215], v[172:175], v[132:135]
    v_mfma_f32_16x16x32_bf16 v[128:131], v[208:211], v[172:175], v[128:131]
    s_waitcnt vmcnt(0) lgkmcnt(0)
    s_barrier
    s_setprio 1
    v_mfma_f32_16x16x32_bf16 v[16:19], v[224:227], v[176:179], v[16:19]
    v_mfma_f32_16x16x32_bf16 v[20:23], v[228:231], v[176:179], v[20:23]
    v_add_u32 v247, s90, v243
    v_add_u32 v248, s91, v245
    v_add_u32 v249, s91, v246
    v_mfma_f32_16x16x32_bf16 v[24:27], v[232:235], v[176:179], v[24:27]
    ds_read_b64_tr_b16 v[208:209], v248 offset:0
    v_mfma_f32_16x16x32_bf16 v[28:31], v[236:239], v[176:179], v[28:31]
    ds_read_b64_tr_b16 v[210:211], v248 offset:2048
    v_mfma_f32_16x16x32_bf16 v[44:47], v[236:239], v[180:183], v[44:47]
    ds_read_b128 v[144:147], v247 offset:0
    v_mfma_f32_16x16x32_bf16 v[40:43], v[232:235], v[180:183], v[40:43]
    ds_read_b128 v[148:151], v247 offset:2048
    v_mfma_f32_16x16x32_bf16 v[36:39], v[228:231], v[180:183], v[36:39]
    ds_read_b128 v[152:155], v247 offset:4096
    v_mfma_f32_16x16x32_bf16 v[32:35], v[224:227], v[180:183], v[32:35]
    ds_read_b128 v[156:159], v247 offset:6144
    v_mfma_f32_16x16x32_bf16 v[48:51], v[224:227], v[184:187], v[48:51]
    ds_read_b128 v[160:163], v247 offset:8192
    v_mfma_f32_16x16x32_bf16 v[52:55], v[228:231], v[184:187], v[52:55]
    ds_read_b128 v[164:167], v247 offset:10240
    v_mfma_f32_16x16x32_bf16 v[56:59], v[232:235], v[184:187], v[56:59]
    ds_read_b128 v[168:171], v247 offset:12288
    v_mfma_f32_16x16x32_bf16 v[60:63], v[236:239], v[184:187], v[60:63]
    ds_read_b128 v[172:175], v247 offset:14336
    v_mfma_f32_16x16x32_bf16 v[76:79], v[236:239], v[188:191], v[76:79]
    ds_read_b64_tr_b16 v[212:213], v249 offset:0
    v_mfma_f32_16x16x32_bf16 v[72:75], v[232:235], v[188:191], v[72:75]
    ds_read_b64_tr_b16 v[214:215], v249 offset:2048
    v_mfma_f32_16x16x32_bf16 v[68:71], v[228:231], v[188:191], v[68:71]
    ds_read_b64_tr_b16 v[216:217], v248 offset:8192
    v_mfma_f32_16x16x32_bf16 v[64:67], v[224:227], v[188:191], v[64:67]
    ds_read_b64_tr_b16 v[218:219], v248 offset:10240
    v_mfma_f32_16x16x32_bf16 v[80:83], v[224:227], v[192:195], v[80:83]
    ds_read_b64_tr_b16 v[220:221], v249 offset:8192
    v_mfma_f32_16x16x32_bf16 v[84:87], v[228:231], v[192:195], v[84:87]
    ds_read_b64_tr_b16 v[222:223], v249 offset:10240
    v_mfma_f32_16x16x32_bf16 v[88:91], v[232:235], v[192:195], v[88:91]
    s_add_u32 s91, s91, 16384
    s_and_b32 s91, s91, 65535
    v_mfma_f32_16x16x32_bf16 v[92:95], v[236:239], v[192:195], v[92:95]
    v_mfma_f32_16x16x32_bf16 v[108:111], v[236:239], v[196:199], v[108:111]
    v_mfma_f32_16x16x32_bf16 v[104:107], v[232:235], v[196:199], v[104:107]
    v_mfma_f32_16x16x32_bf16 v[100:103], v[228:231], v[196:199], v[100:103]
    v_mfma_f32_16x16x32_bf16 v[96:99], v[224:227], v[196:199], v[96:99]
    v_mfma_f32_16x16x32_bf16 v[112:115], v[224:227], v[200:203], v[112:115]
    v_mfma_f32_16x16x32_bf16 v[116:119], v[228:231], v[200:203], v[116:119]
    v_mfma_f32_16x16x32_bf16 v[120:123], v[232:235], v[200:203], v[120:123]
    v_mfma_f32_16x16x32_bf16 v[124:127], v[236:239], v[200:203], v[124:127]
    v_mfma_f32_16x16x32_bf16 v[140:143], v[236:239], v[204:207], v[140:143]
    v_mfma_f32_16x16x32_bf16 v[136:139], v[232:235], v[204:207], v[136:139]
    v_mfma_f32_16x16x32_bf16 v[132:135], v[228:231], v[204:207], v[132:135]
    v_mfma_f32_16x16x32_bf16 v[128:131], v[224:227], v[204:207], v[128:131]
    s_waitcnt lgkmcnt(0)
    v_mfma_f32_16x16x32_bf16 v[16:19], v[208:211], v[144:147], v[16:19]
    v_mfma_f32_16x16x32_bf16 v[20:23], v[212:215], v[144:147], v[20:23]
    v_add_u32 v247, s90, v244
    v_add_u32 v248, s91, v245
    v_add_u32 v249, s91, v246
    v_mfma_f32_16x16x32_bf16 v[24:27], v[216:219], v[144:147], v[24:27]
    ds_read_b64_tr_b16 v[224:225], v248 offset:0
    v_mfma_f32_16x16x32_bf16 v[28:31], v[220:223], v[144:147], v[28:31]
    ds_read_b64_tr_b16 v[226:227], v248 offset:2048
    v_mfma_f32_16x16x32_bf16 v[44:47], v[220:223], v[148:151], v[44:47]
    ds_read_b128 v[176:179], v247 offset:0
    v_mfma_f32_16x16x32_bf16 v[40:43], v[216:219], v[148:151], v[40:43]
    ds_read_b128 v[180:183], v247 offset:2048
    v_mfma_f32_16x16x32_bf16 v[36:39], v[212:215], v[148:151], v[36:39]
    ds_read_b128 v[184:187], v247 offset:4096
    v_mfma_f32_16x16x32_bf16 v[32:35], v[208:211], v[148:151], v[32:35]
    ds_read_b128 v[188:191], v247 offset:6144
    v_mfma_f32_16x16x32_bf16 v[48:51], v[208:211], v[152:155], v[48:51]
    ds_read_b128 v[192:195], v247 offset:8192
    v_mfma_f32_16x16x32_bf16 v[52:55], v[212:215], v[152:155], v[52:55]
    ds_read_b128 v[196:199], v247 offset:10240
    v_mfma_f32_16x16x32_bf16 v[56:59], v[216:219], v[152:155], v[56:59]
    ds_read_b128 v[200:203], v247 offset:12288
    v_mfma_f32_16x16x32_bf16 v[60:63], v[220:223], v[152:155], v[60:63]
    ds_read_b128 v[204:207], v247 offset:14336
    v_mfma_f32_16x16x32_bf16 v[76:79], v[220:223], v[156:159], v[76:79]
    ds_read_b64_tr_b16 v[228:229], v249 offset:0
    v_mfma_f32_16x16x32_bf16 v[72:75], v[216:219], v[156:159], v[72:75]
    ds_read_b64_tr_b16 v[230:231], v249 offset:2048
    v_mfma_f32_16x16x32_bf16 v[68:71], v[212:215], v[156:159], v[68:71]
    ds_read_b64_tr_b16 v[232:233], v248 offset:8192
    v_mfma_f32_16x16x32_bf16 v[64:67], v[208:211], v[156:159], v[64:67]
    ds_read_b64_tr_b16 v[234:235], v248 offset:10240
    v_mfma_f32_16x16x32_bf16 v[80:83], v[208:211], v[160:163], v[80:83]
    ds_read_b64_tr_b16 v[236:237], v249 offset:8192
    v_mfma_f32_16x16x32_bf16 v[84:87], v[212:215], v[160:163], v[84:87]
    ds_read_b64_tr_b16 v[238:239], v249 offset:10240
    v_mfma_f32_16x16x32_bf16 v[88:91], v[216:219], v[160:163], v[88:91]
    s_add_u32 s91, s91, 16384
    s_and_b32 s91, s91, 65535
    s_add_u32 s90, s90, 32768
    s_cmp_eq_u32 s90, 98304
    s_cselect_b32 s90, 0, s90
    v_mfma_f32_16x16x32_bf16 v[92:95], v[220:223], v[160:163], v[92:95]
    v_mfma_f32_16x16x32_bf16 v[108:111], v[220:223], v[164:167], v[108:111]
    v_mfma_f32_16x16x32_bf16 v[104:107], v[216:219], v[164:167], v[104:107]
    v_mfma_f32_16x16x32_bf16 v[100:103], v[212:215], v[164:167], v[100:103]
    v_mfma_f32_16x16x32_bf16 v[96:99], v[208:211], v[164:167], v[96:99]
    v_mfma_f32_16x16x32_bf16 v[112:115], v[208:211], v[168:171], v[112:115]
    v_mfma_f32_16x16x32_bf16 v[116:119], v[212:215], v[168:171], v[116:119]
    v_mfma_f32_16x16x32_bf16 v[120:123], v[216:219], v[168:171], v[120:123]
    v_mfma_f32_16x16x32_bf16 v[124:127], v[220:223], v[168:171], v[124:127]
    v_mfma_f32_16x16x32_bf16 v[140:143], v[220:223], v[172:175], v[140:143]
    v_mfma_f32_16x16x32_bf16 v[136:139], v[216:219], v[172:175], v[136:139]
    v_mfma_f32_16x16x32_bf16 v[132:135], v[212:215], v[172:175], v[132:135]
    v_mfma_f32_16x16x32_bf16 v[128:131], v[208:211], v[172:175], v[128:131]
    s_waitcnt lgkmcnt(0)
    v_mfma_f32_16x16x32_bf16 v[16:19], v[224:227], v[176:179], v[16:19]
    v_mfma_f32_16x16x32_bf16 v[32:35], v[224:227], v[180:183], v[32:35]
    v_mfma_f32_16x16x32_bf16 v[48:51], v[224:227], v[184:187], v[48:51]
    v_mfma_f32_16x16x32_bf16 v[64:67], v[224:227], v[188:191], v[64:67]
    v_mfma_f32_16x16x32_bf16 v[80:83], v[224:227], v[192:195], v[80:83]
    v_mfma_f32_16x16x32_bf16 v[96:99], v[224:227], v[196:199], v[96:99]
    v_mfma_f32_16x16x32_bf16 v[112:115], v[224:227], v[200:203], v[112:115]
    v_mfma_f32_16x16x32_bf16 v[128:131], v[224:227], v[204:207], v[128:131]
    v_mfma_f32_16x16x32_bf16 v[20:23], v[228:231], v[176:179], v[20:23]
    v_mfma_f32_16x16x32_bf16 v[36:39], v[228:231], v[180:183], v[36:39]
    v_mfma_f32_16x16x32_bf16 v[52:55], v[228:231], v[184:187], v[52:55]
    v_mfma_f32_16x16x32_bf16 v[68:71], v[228:231], v[188:191], v[68:71]
    v_mfma_f32_16x16x32_bf16 v[84:87], v[228:231], v[192:195], v[84:87]
    v_mfma_f32_16x16x32_bf16 v[100:103], v[228:231], v[196:199], v[100:103]
    v_mfma_f32_16x16x32_bf16 v[116:119], v[228:231], v[200:203], v[116:119]
    v_mfma_f32_16x16x32_bf16 v[132:135], v[228:231], v[204:207], v[132:135]
    v_mfma_f32_16x16x32_bf16 v[24:27], v[232:235], v[176:179], v[24:27]
    v_mfma_f32_16x16x32_bf16 v[40:43], v[232:235], v[180:183], v[40:43]
    v_mfma_f32_16x16x32_bf16 v[56:59], v[232:235], v[184:187], v[56:59]
    v_mfma_f32_16x16x32_bf16 v[72:75], v[232:235], v[188:191], v[72:75]
    v_mfma_f32_16x16x32_bf16 v[88:91], v[232:235], v[192:195], v[88:91]
    v_mfma_f32_16x16x32_bf16 v[104:107], v[232:235], v[196:199], v[104:107]
    v_mfma_f32_16x16x32_bf16 v[120:123], v[232:235], v[200:203], v[120:123]
    v_mfma_f32_16x16x32_bf16 v[136:139], v[232:235], v[204:207], v[136:139]
    v_mfma_f32_16x16x32_bf16 v[28:31], v[236:239], v[176:179], v[28:31]
    v_mfma_f32_16x16x32_bf16 v[44:47], v[236:239], v[180:183], v[44:47]
    v_mfma_f32_16x16x32_bf16 v[60:63], v[236:239], v[184:187], v[60:63]
    v_mfma_f32_16x16x32_bf16 v[76:79], v[236:239], v[188:191], v[76:79]
    v_mfma_f32_16x16x32_bf16 v[92:95], v[236:239], v[192:195], v[92:95]
    v_mfma_f32_16x16x32_bf16 v[108:111], v[236:239], v[196:199], v[108:111]
    v_mfma_f32_16x16x32_bf16 v[124:127], v[236:239], v[200:203], v[124:127]
    v_mfma_f32_16x16x32_bf16 v[140:143], v[236:239], v[204:207], v[140:143]
    s_setprio 1
    s_branch P_epi
.fill (7676 - (. - gated_mix__ssm_conv_h3__geglu_ffn__prompt_kernel)) / 4, 4, 0xbf810000
P_epi:
P_pre:
    s_mov_b32 s12, s36
    s_mov_b32 s13, s37
    s_mov_b32 s14, 7340032
    s_mov_b32 s15, 0x00020000
    v_lshlrev_b32 v3, 2, v2
    s_lshl_b32 s43, s68, 9
    s_add_u32 s43, s43, 1024
    s_mul_i32 s42, s83, 224
    s_add_u32 s42, s42, s43
    v_add_u32 v243, s42, v3
    v_cmp_le_u32 vcc, 28, v2
    v_mov_b32 v14, 112
    v_mov_b32 v15, 224
    v_cndmask_b32 v14, v14, v15, vcc
    v_add3_u32 v248, v3, v14, s43
    v_add_u32 v14, 13184, v3
    v_cndmask_b32 v243, v243, v14, vcc
    v_lshlrev_b32 v243, 5, v243
    v_lshlrev_b32 v248, 5, v248
    v_lshlrev_b32 v249, 4, v2
    s_mul_i32 s43, s68, 1146880
    s_lshl_b32 s50, s70, 11
    s_add_u32 s43, s43, s50
    v_add_u32 v240, s43, v249
    s_mul_i32 s42, s70, 1536
    s_sub_u32 s42, 7808, s42
    v_mov_b32 v253, v240
    s_mov_b32 exec_lo, 0xff000000
    s_mov_b32 exec_hi, 0
    v_add_u32 v240, s42, v240
    v_subrev_u32 v253, 768, v240
    s_mov_b64 exec, -1
    s_lshl_b32 s52, s70, 10
    s_mul_i32 s53, s83, 573440
    s_sub_u32 s48, 1044480, s53
    v_lshrrev_b32 v3, 5, v2
    v_lshlrev_b32 v3, 3, v3
    v_bfe_u32 v14, v2, 3, 2
    v_add_u32 v3, v3, v14
    v_bfe_u32 v14, v2, 4, 2
    v_lshlrev_b32 v14, 1, v14
    v_and_b32 v15, 7, v2
    v_xor_b32 v14, v14, v15
    v_lshlrev_b32 v14, 4, v14
    s_xor_b32 s43, s69, s75
    s_and_b32 s42, s43, 7
    s_cmp_eq_u32 s42, 3
    s_cbranch_scc1 P_sp
    v_lshl_add_u32 v3, v3, 11, v14
    s_lshl_b32 s43, s43, 7
    s_lshl_b32 s42, s76, 15
    s_add_u32 s43, s43, s42
    v_add_u32 v241, s43, v3
    v_add_u32 v250, 7168, v241
    s_mov_b32 s85, 65536
    s_branch P_spd
P_sp:
    s_add_u32 s12, s38, 58720256
    s_addc_u32 s13, s39, 0
    s_mov_b32 s14, 1147904
    s_mov_b32 s15, 0x00020000
    s_lshr_b32 s43, s43, 3
    s_mul_i32 s43, s43, 5120
    s_add_u32 s43, s43, 1024
    s_lshl_b32 s42, s76, 4
    v_add_u32 v241, s42, v3
    v_add_u32 v15, 4, v241
    v_mul_u32_u24 v15, 37, v15
    v_lshrrev_b32 v15, 8, v15
    v_add_u32 v241, v241, v15
    v_lshlrev_b32 v241, 7, v241
    v_add3_u32 v241, v241, v14, s43
    s_add_u32 s42, s42, 4
    s_sub_u32 s43, s43, 1024
    v_add_u32 v250, s42, v3
    v_add_u32 v15, 4, v250
    v_mul_u32_u24 v15, 37, v15
    v_lshrrev_b32 v15, 8, v15
    v_add_u32 v250, v250, v15
    v_lshlrev_b32 v250, 7, v250
    v_add3_u32 v250, v250, v14, s43
    s_mov_b32 s85, 10240
P_spd:
    s_mul_i32 s86, s85, 3
    s_mul_i32 s54, s83, 56
    s_mul_i32 s54, s54, s85
    s_mul_i32 s55, s85, 2
    s_add_u32 s55, s55, s54
    s_mov_b32 s90, 0
    s_add_u32 s91, s50, 155648
    s_cmp_ge_u32 s2, 224
    s_cbranch_scc1 P_nox
    s_barrier
P_nox:
    s_cmp_eq_u32 s85, 10240
    s_cbranch_scc1 P_nopf
    s_add_u32 m0, s50, 155648
    s_nop 0
    buffer_load_dwordx4 v241, s[12:15], s54 offen offset:0 sc1 lds
    buffer_load_dwordx4 v250, s[12:15], s54 offen offset:1024 sc1 lds
    s_add_u32 m0, s50, 147456
    s_add_u32 s54, s54, s85
    buffer_load_dwordx4 v241, s[12:15], s54 offen offset:0 sc1 lds
    buffer_load_dwordx4 v250, s[12:15], s54 offen offset:1024 sc1 lds
    s_add_u32 m0, s50, 139264
    s_add_u32 s54, s54, s86
    buffer_load_dwordx4 v241, s[12:15], s54 offen offset:0 sc1 lds
    buffer_load_dwordx4 v250, s[12:15], s54 offen offset:1024 sc1 lds
    s_add_u32 m0, s50, 131072
    s_add_u32 s54, s54, s85
    buffer_load_dwordx4 v241, s[12:15], s54 offen offset:0 sc1 lds
    buffer_load_dwordx4 v250, s[12:15], s54 offen offset:1024 sc1 lds
    s_add_u32 m0, s50, 122880
    s_add_u32 s54, s54, s86
    buffer_load_dwordx4 v241, s[12:15], s54 offen offset:0 sc1 lds
    buffer_load_dwordx4 v250, s[12:15], s54 offen offset:1024 sc1 lds
P_nopf:
    v_and_b32 v177, 15, v2
    s_lshl_b32 s42, s75, 6
    s_lshl_b32 s43, s68, 7
    s_add_u32 s42, s42, s43
    v_add_u32 v177, s42, v177
    v_lshlrev_b32 v219, 2, v177
    v_lshlrev_b32 v177, 11, v177
    s_lshl_b32 s42, s76, 5
    s_lshl_b32 s43, s69, 6
    s_add_u32 s42, s42, s43
    s_lshl_b32 s42, s42, 1
    v_add_u32 v177, s42, v177
    v_lshrrev_b32 v179, 4, v2
    v_and_b32 v178, 1, v179
    v_lshlrev_b32 v178, 5, v178
    v_lshrrev_b32 v180, 1, v179
    v_lshlrev_b32 v180, 4, v180
    v_add3_u32 v176, v177, v178, v180
    s_mov_b32 s42, 0
    buffer_load_dwordx4 v[224:227], v176, s[8:11], s42 offen
    s_mov_b32 s42, 32768
    buffer_load_dwordx4 v[228:231], v176, s[8:11], s42 offen
    s_mov_b32 s42, 65536
    buffer_load_dwordx4 v[232:235], v176, s[8:11], s42 offen
    s_mov_b32 s42, 98304
    buffer_load_dwordx4 v[236:239], v176, s[8:11], s42 offen
    s_cmp_ge_u32 s2, 224
    s_cbranch_scc1 P_duty
    v_mov_b32 v4, 0xc0135761
    v_mov_b32 v5, 0xc0135761
    v_mov_b32 v6, 0xbdd2d3e8
    v_mov_b32 v7, 0xbdd2d3e8
    v_mov_b32 v8, 1.0
    v_mov_b32 v9, 1.0
    v_mul_f32 v144, v16, v16
    v_mul_f32 v145, v17, v17
    v_mul_f32 v146, v18, v18
    v_mul_f32 v147, v19, v19
    v_mul_f32 v152, v20, v20
    v_mul_f32 v153, v21, v21
    v_mul_f32 v154, v22, v22
    v_mul_f32 v155, v23, v23
    v_fma_f32 v144, v144, v6, v4
    v_fma_f32 v145, v145, v6, v4
    v_fma_f32 v146, v146, v6, v4
    v_fma_f32 v147, v147, v6, v4
    v_fma_f32 v152, v152, v6, v4
    v_fma_f32 v153, v153, v6, v4
    v_fma_f32 v154, v154, v6, v4
    v_fma_f32 v155, v155, v6, v4
    v_mul_f32 v144, v144, v16
    v_mul_f32 v145, v145, v17
    v_mul_f32 v146, v146, v18
    v_mul_f32 v147, v147, v19
    v_mul_f32 v152, v152, v20
    v_mul_f32 v153, v153, v21
    v_mul_f32 v154, v154, v22
    v_mul_f32 v155, v155, v23
    v_exp_f32 v144, v144
    v_mul_f32 v148, v16, v24
    v_exp_f32 v145, v145
    v_mul_f32 v149, v17, v25
    v_exp_f32 v146, v146
    v_mul_f32 v150, v18, v26
    v_exp_f32 v147, v147
    v_mul_f32 v151, v19, v27
    v_exp_f32 v152, v152
    v_mul_f32 v156, v20, v28
    v_exp_f32 v153, v153
    v_mul_f32 v157, v21, v29
    v_exp_f32 v154, v154
    v_mul_f32 v158, v22, v30
    v_exp_f32 v155, v155
    v_mul_f32 v159, v23, v31
    v_add_f32 v144, 1.0, v144
    v_add_f32 v145, 1.0, v145
    v_add_f32 v146, 1.0, v146
    v_add_f32 v147, 1.0, v147
    v_add_f32 v152, 1.0, v152
    v_add_f32 v153, 1.0, v153
    v_add_f32 v154, 1.0, v154
    v_add_f32 v155, 1.0, v155
    v_rcp_f32 v144, v144
    v_rcp_f32 v145, v145
    v_rcp_f32 v146, v146
    v_rcp_f32 v147, v147
    v_rcp_f32 v152, v152
    v_rcp_f32 v153, v153
    v_rcp_f32 v154, v154
    v_rcp_f32 v155, v155
    v_mul_f32 v144, v144, v148
    v_mul_f32 v145, v145, v149
    v_mul_f32 v146, v146, v150
    v_mul_f32 v147, v147, v151
    v_mul_f32 v152, v152, v156
    v_mul_f32 v153, v153, v157
    v_mul_f32 v154, v154, v158
    v_mul_f32 v155, v155, v159
    v_cvt_pk_bf16_f32 v208, v144, v145
    v_cvt_pk_bf16_f32 v209, v146, v147
    v_cvt_pk_bf16_f32 v210, v152, v153
    v_cvt_pk_bf16_f32 v211, v154, v155
    s_mov_b32 s84, 0
    s_nop 0
    v_permlane16_swap_b32 v208, v210
    v_permlane16_swap_b32 v209, v211
    buffer_store_dwordx4 v[208:211], v10, s[44:47], s84 offen sc1
    v_add_u32 v10, v1, v10
    v_mul_f32 v160, v32, v32
    v_mul_f32 v161, v33, v33
    v_mul_f32 v162, v34, v34
    v_mul_f32 v163, v35, v35
    v_mul_f32 v168, v36, v36
    v_mul_f32 v169, v37, v37
    v_mul_f32 v170, v38, v38
    v_mul_f32 v171, v39, v39
    v_fma_f32 v160, v160, v6, v4
    v_fma_f32 v161, v161, v6, v4
    v_fma_f32 v162, v162, v6, v4
    v_fma_f32 v163, v163, v6, v4
    v_fma_f32 v168, v168, v6, v4
    v_fma_f32 v169, v169, v6, v4
    v_fma_f32 v170, v170, v6, v4
    v_fma_f32 v171, v171, v6, v4
    v_mul_f32 v160, v160, v32
    v_mul_f32 v161, v161, v33
    v_mul_f32 v162, v162, v34
    v_mul_f32 v163, v163, v35
    v_mul_f32 v168, v168, v36
    v_mul_f32 v169, v169, v37
    v_mul_f32 v170, v170, v38
    v_mul_f32 v171, v171, v39
    v_exp_f32 v160, v160
    v_mul_f32 v164, v32, v40
    v_exp_f32 v161, v161
    v_mul_f32 v165, v33, v41
    v_exp_f32 v162, v162
    v_mul_f32 v166, v34, v42
    v_exp_f32 v163, v163
    v_mul_f32 v167, v35, v43
    v_exp_f32 v168, v168
    v_mul_f32 v172, v36, v44
    v_exp_f32 v169, v169
    v_mul_f32 v173, v37, v45
    v_exp_f32 v170, v170
    v_mul_f32 v174, v38, v46
    v_exp_f32 v171, v171
    v_mul_f32 v175, v39, v47
    v_add_f32 v160, 1.0, v160
    v_add_f32 v161, 1.0, v161
    v_add_f32 v162, 1.0, v162
    v_add_f32 v163, 1.0, v163
    v_add_f32 v168, 1.0, v168
    v_add_f32 v169, 1.0, v169
    v_add_f32 v170, 1.0, v170
    v_add_f32 v171, 1.0, v171
    v_rcp_f32 v160, v160
    v_rcp_f32 v161, v161
    v_rcp_f32 v162, v162
    v_rcp_f32 v163, v163
    v_rcp_f32 v168, v168
    v_rcp_f32 v169, v169
    v_rcp_f32 v170, v170
    v_rcp_f32 v171, v171
    v_mul_f32 v160, v160, v164
    v_mul_f32 v161, v161, v165
    v_mul_f32 v162, v162, v166
    v_mul_f32 v163, v163, v167
    v_mul_f32 v168, v168, v172
    v_mul_f32 v169, v169, v173
    v_mul_f32 v170, v170, v174
    v_mul_f32 v171, v171, v175
    v_cvt_pk_bf16_f32 v212, v160, v161
    v_cvt_pk_bf16_f32 v213, v162, v163
    v_cvt_pk_bf16_f32 v214, v168, v169
    v_cvt_pk_bf16_f32 v215, v170, v171
    s_mov_b32 s84, 1024
    s_nop 0
    v_permlane16_swap_b32 v212, v214
    v_permlane16_swap_b32 v213, v215
    buffer_store_dwordx4 v[212:215], v10, s[44:47], s84 offen sc1
    v_add_u32 v10, v1, v10
    v_mul_f32 v144, v48, v48
    v_mul_f32 v145, v49, v49
    v_mul_f32 v146, v50, v50
    v_mul_f32 v147, v51, v51
    v_mul_f32 v152, v52, v52
    v_mul_f32 v153, v53, v53
    v_mul_f32 v154, v54, v54
    v_mul_f32 v155, v55, v55
    v_fma_f32 v144, v144, v6, v4
    v_fma_f32 v145, v145, v6, v4
    v_fma_f32 v146, v146, v6, v4
    v_fma_f32 v147, v147, v6, v4
    v_fma_f32 v152, v152, v6, v4
    v_fma_f32 v153, v153, v6, v4
    v_fma_f32 v154, v154, v6, v4
    v_fma_f32 v155, v155, v6, v4
    v_mul_f32 v144, v144, v48
    v_mul_f32 v145, v145, v49
    v_mul_f32 v146, v146, v50
    v_mul_f32 v147, v147, v51
    v_mul_f32 v152, v152, v52
    v_mul_f32 v153, v153, v53
    v_mul_f32 v154, v154, v54
    v_mul_f32 v155, v155, v55
    v_exp_f32 v144, v144
    v_mul_f32 v148, v48, v56
    v_exp_f32 v145, v145
    v_mul_f32 v149, v49, v57
    v_exp_f32 v146, v146
    v_mul_f32 v150, v50, v58
    v_exp_f32 v147, v147
    v_mul_f32 v151, v51, v59
    v_exp_f32 v152, v152
    v_mul_f32 v156, v52, v60
    v_exp_f32 v153, v153
    v_mul_f32 v157, v53, v61
    v_exp_f32 v154, v154
    v_mul_f32 v158, v54, v62
    v_exp_f32 v155, v155
    v_mul_f32 v159, v55, v63
    v_add_f32 v144, 1.0, v144
    v_add_f32 v145, 1.0, v145
    v_add_f32 v146, 1.0, v146
    v_add_f32 v147, 1.0, v147
    v_add_f32 v152, 1.0, v152
    v_add_f32 v153, 1.0, v153
    v_add_f32 v154, 1.0, v154
    v_add_f32 v155, 1.0, v155
    v_rcp_f32 v144, v144
    v_rcp_f32 v145, v145
    v_rcp_f32 v146, v146
    v_rcp_f32 v147, v147
    v_rcp_f32 v152, v152
    v_rcp_f32 v153, v153
    v_rcp_f32 v154, v154
    v_rcp_f32 v155, v155
    v_mul_f32 v144, v144, v148
    v_mul_f32 v145, v145, v149
    v_mul_f32 v146, v146, v150
    v_mul_f32 v147, v147, v151
    v_mul_f32 v152, v152, v156
    v_mul_f32 v153, v153, v157
    v_mul_f32 v154, v154, v158
    v_mul_f32 v155, v155, v159
    v_cvt_pk_bf16_f32 v208, v144, v145
    v_cvt_pk_bf16_f32 v209, v146, v147
    v_cvt_pk_bf16_f32 v210, v152, v153
    v_cvt_pk_bf16_f32 v211, v154, v155
    s_mov_b32 s84, 2048
    s_nop 0
    v_permlane16_swap_b32 v208, v210
    v_permlane16_swap_b32 v209, v211
    buffer_store_dwordx4 v[208:211], v10, s[44:47], s84 offen sc1
    s_setprio 0
    v_add_u32 v10, v1, v10
    v_mul_f32 v160, v64, v64
    v_mul_f32 v161, v65, v65
    v_mul_f32 v162, v66, v66
    v_mul_f32 v163, v67, v67
    v_mul_f32 v168, v68, v68
    v_mul_f32 v169, v69, v69
    v_mul_f32 v170, v70, v70
    v_mul_f32 v171, v71, v71
    v_fma_f32 v160, v160, v6, v4
    v_fma_f32 v161, v161, v6, v4
    v_fma_f32 v162, v162, v6, v4
    v_fma_f32 v163, v163, v6, v4
    v_fma_f32 v168, v168, v6, v4
    v_fma_f32 v169, v169, v6, v4
    v_fma_f32 v170, v170, v6, v4
    v_fma_f32 v171, v171, v6, v4
    v_mul_f32 v160, v160, v64
    v_mul_f32 v161, v161, v65
    v_mul_f32 v162, v162, v66
    v_mul_f32 v163, v163, v67
    v_mul_f32 v168, v168, v68
    v_mul_f32 v169, v169, v69
    v_mul_f32 v170, v170, v70
    v_mul_f32 v171, v171, v71
    v_exp_f32 v160, v160
    v_mul_f32 v164, v64, v72
    v_exp_f32 v161, v161
    v_mul_f32 v165, v65, v73
    v_exp_f32 v162, v162
    v_mul_f32 v166, v66, v74
    v_exp_f32 v163, v163
    v_mul_f32 v167, v67, v75
    v_exp_f32 v168, v168
    v_mul_f32 v172, v68, v76
    v_exp_f32 v169, v169
    v_mul_f32 v173, v69, v77
    v_exp_f32 v170, v170
    v_mul_f32 v174, v70, v78
    v_exp_f32 v171, v171
    v_mul_f32 v175, v71, v79
    v_add_f32 v160, 1.0, v160
    v_add_f32 v161, 1.0, v161
    v_add_f32 v162, 1.0, v162
    v_add_f32 v163, 1.0, v163
    v_add_f32 v168, 1.0, v168
    v_add_f32 v169, 1.0, v169
    v_add_f32 v170, 1.0, v170
    v_add_f32 v171, 1.0, v171
    v_rcp_f32 v160, v160
    v_rcp_f32 v161, v161
    v_rcp_f32 v162, v162
    v_rcp_f32 v163, v163
    v_rcp_f32 v168, v168
    v_rcp_f32 v169, v169
    v_rcp_f32 v170, v170
    v_rcp_f32 v171, v171
    v_mul_f32 v160, v160, v164
    v_mul_f32 v161, v161, v165
    v_mul_f32 v162, v162, v166
    v_mul_f32 v163, v163, v167
    v_mul_f32 v168, v168, v172
    v_mul_f32 v169, v169, v173
    v_mul_f32 v170, v170, v174
    v_mul_f32 v171, v171, v175
    v_cvt_pk_bf16_f32 v212, v160, v161
    v_cvt_pk_bf16_f32 v213, v162, v163
    v_cvt_pk_bf16_f32 v214, v168, v169
    v_cvt_pk_bf16_f32 v215, v170, v171
    s_mov_b32 s84, 3072
    s_nop 0
    v_permlane16_swap_b32 v212, v214
    v_permlane16_swap_b32 v213, v215
    buffer_store_dwordx4 v[212:215], v10, s[44:47], s84 offen sc1
    v_add_u32 v10, v1, v10
    v_mul_f32 v144, v80, v80
    v_mul_f32 v145, v81, v81
    v_mul_f32 v146, v82, v82
    v_mul_f32 v147, v83, v83
    v_mul_f32 v152, v84, v84
    v_mul_f32 v153, v85, v85
    v_mul_f32 v154, v86, v86
    v_mul_f32 v155, v87, v87
    v_fma_f32 v144, v144, v6, v4
    v_fma_f32 v145, v145, v6, v4
    v_fma_f32 v146, v146, v6, v4
    v_fma_f32 v147, v147, v6, v4
    v_fma_f32 v152, v152, v6, v4
    v_fma_f32 v153, v153, v6, v4
    v_fma_f32 v154, v154, v6, v4
    v_fma_f32 v155, v155, v6, v4
    v_mul_f32 v144, v144, v80
    v_mul_f32 v145, v145, v81
    v_mul_f32 v146, v146, v82
    v_mul_f32 v147, v147, v83
    v_mul_f32 v152, v152, v84
    v_mul_f32 v153, v153, v85
    v_mul_f32 v154, v154, v86
    v_mul_f32 v155, v155, v87
    v_exp_f32 v144, v144
    v_mul_f32 v148, v80, v88
    v_exp_f32 v145, v145
    v_mul_f32 v149, v81, v89
    v_exp_f32 v146, v146
    v_mul_f32 v150, v82, v90
    v_exp_f32 v147, v147
    v_mul_f32 v151, v83, v91
    v_exp_f32 v152, v152
    v_mul_f32 v156, v84, v92
    v_exp_f32 v153, v153
    v_mul_f32 v157, v85, v93
    v_exp_f32 v154, v154
    v_mul_f32 v158, v86, v94
    v_exp_f32 v155, v155
    v_mul_f32 v159, v87, v95
    v_add_f32 v144, 1.0, v144
    v_add_f32 v145, 1.0, v145
    v_add_f32 v146, 1.0, v146
    v_add_f32 v147, 1.0, v147
    v_add_f32 v152, 1.0, v152
    v_add_f32 v153, 1.0, v153
    v_add_f32 v154, 1.0, v154
    v_add_f32 v155, 1.0, v155
    v_rcp_f32 v144, v144
    v_rcp_f32 v145, v145
    v_rcp_f32 v146, v146
    v_rcp_f32 v147, v147
    v_rcp_f32 v152, v152
    v_rcp_f32 v153, v153
    v_rcp_f32 v154, v154
    v_rcp_f32 v155, v155
    v_mul_f32 v144, v144, v148
    v_mul_f32 v145, v145, v149
    v_mul_f32 v146, v146, v150
    v_mul_f32 v147, v147, v151
    v_mul_f32 v152, v152, v156
    v_mul_f32 v153, v153, v157
    v_mul_f32 v154, v154, v158
    v_mul_f32 v155, v155, v159
    v_cvt_pk_bf16_f32 v208, v144, v145
    v_cvt_pk_bf16_f32 v209, v146, v147
    v_cvt_pk_bf16_f32 v210, v152, v153
    v_cvt_pk_bf16_f32 v211, v154, v155
    s_mov_b32 s84, 4096
    s_nop 0
    v_permlane16_swap_b32 v208, v210
    v_permlane16_swap_b32 v209, v211
    buffer_store_dwordx4 v[208:211], v10, s[44:47], s84 offen sc1
    s_setprio 1
    v_add_u32 v10, v1, v10
    v_mul_f32 v160, v96, v96
    v_mul_f32 v161, v97, v97
    v_mul_f32 v162, v98, v98
    v_mul_f32 v163, v99, v99
    v_mul_f32 v168, v100, v100
    v_mul_f32 v169, v101, v101
    v_mul_f32 v170, v102, v102
    v_mul_f32 v171, v103, v103
    v_fma_f32 v160, v160, v6, v4
    v_fma_f32 v161, v161, v6, v4
    v_fma_f32 v162, v162, v6, v4
    v_fma_f32 v163, v163, v6, v4
    v_fma_f32 v168, v168, v6, v4
    v_fma_f32 v169, v169, v6, v4
    v_fma_f32 v170, v170, v6, v4
    v_fma_f32 v171, v171, v6, v4
    v_mul_f32 v160, v160, v96
    v_mul_f32 v161, v161, v97
    v_mul_f32 v162, v162, v98
    v_mul_f32 v163, v163, v99
    v_mul_f32 v168, v168, v100
    v_mul_f32 v169, v169, v101
    v_mul_f32 v170, v170, v102
    v_mul_f32 v171, v171, v103
    v_exp_f32 v160, v160
    v_mul_f32 v164, v96, v104
    v_exp_f32 v161, v161
    v_mul_f32 v165, v97, v105
    v_exp_f32 v162, v162
    v_mul_f32 v166, v98, v106
    v_exp_f32 v163, v163
    v_mul_f32 v167, v99, v107
    v_exp_f32 v168, v168
    v_mul_f32 v172, v100, v108
    v_exp_f32 v169, v169
    v_mul_f32 v173, v101, v109
    v_exp_f32 v170, v170
    v_mul_f32 v174, v102, v110
    v_exp_f32 v171, v171
    v_mul_f32 v175, v103, v111
    v_add_f32 v160, 1.0, v160
    v_add_f32 v161, 1.0, v161
    v_add_f32 v162, 1.0, v162
    v_add_f32 v163, 1.0, v163
    v_add_f32 v168, 1.0, v168
    v_add_f32 v169, 1.0, v169
    v_add_f32 v170, 1.0, v170
    v_add_f32 v171, 1.0, v171
    v_rcp_f32 v160, v160
    v_rcp_f32 v161, v161
    v_rcp_f32 v162, v162
    v_rcp_f32 v163, v163
    v_rcp_f32 v168, v168
    v_rcp_f32 v169, v169
    v_rcp_f32 v170, v170
    v_rcp_f32 v171, v171
    v_mul_f32 v160, v160, v164
    v_mul_f32 v161, v161, v165
    v_mul_f32 v162, v162, v166
    v_mul_f32 v163, v163, v167
    v_mul_f32 v168, v168, v172
    v_mul_f32 v169, v169, v173
    v_mul_f32 v170, v170, v174
    v_mul_f32 v171, v171, v175
    v_cvt_pk_bf16_f32 v212, v160, v161
    v_cvt_pk_bf16_f32 v213, v162, v163
    v_cvt_pk_bf16_f32 v214, v168, v169
    v_cvt_pk_bf16_f32 v215, v170, v171
    s_mov_b32 s84, 5120
    s_nop 0
    v_permlane16_swap_b32 v212, v214
    v_permlane16_swap_b32 v213, v215
    buffer_store_dwordx4 v[212:215], v10, s[44:47], s84 offen sc1
    v_add_u32 v10, v1, v10
    v_mul_f32 v144, v112, v112
    v_mul_f32 v145, v113, v113
    v_mul_f32 v146, v114, v114
    v_mul_f32 v147, v115, v115
    v_mul_f32 v152, v116, v116
    v_mul_f32 v153, v117, v117
    v_mul_f32 v154, v118, v118
    v_mul_f32 v155, v119, v119
    v_fma_f32 v144, v144, v6, v4
    v_fma_f32 v145, v145, v6, v4
    v_fma_f32 v146, v146, v6, v4
    v_fma_f32 v147, v147, v6, v4
    v_fma_f32 v152, v152, v6, v4
    v_fma_f32 v153, v153, v6, v4
    v_fma_f32 v154, v154, v6, v4
    v_fma_f32 v155, v155, v6, v4
    v_mul_f32 v144, v144, v112
    v_mul_f32 v145, v145, v113
    v_mul_f32 v146, v146, v114
    v_mul_f32 v147, v147, v115
    v_mul_f32 v152, v152, v116
    v_mul_f32 v153, v153, v117
    v_mul_f32 v154, v154, v118
    v_mul_f32 v155, v155, v119
    v_exp_f32 v144, v144
    v_mul_f32 v148, v112, v120
    v_exp_f32 v145, v145
    v_mul_f32 v149, v113, v121
    v_exp_f32 v146, v146
    v_mul_f32 v150, v114, v122
    v_exp_f32 v147, v147
    v_mul_f32 v151, v115, v123
    v_exp_f32 v152, v152
    v_mul_f32 v156, v116, v124
    v_exp_f32 v153, v153
    v_mul_f32 v157, v117, v125
    v_exp_f32 v154, v154
    v_mul_f32 v158, v118, v126
    v_exp_f32 v155, v155
    v_mul_f32 v159, v119, v127
    v_add_f32 v144, 1.0, v144
    v_add_f32 v145, 1.0, v145
    v_add_f32 v146, 1.0, v146
    v_add_f32 v147, 1.0, v147
    v_add_f32 v152, 1.0, v152
    v_add_f32 v153, 1.0, v153
    v_add_f32 v154, 1.0, v154
    v_add_f32 v155, 1.0, v155
    v_rcp_f32 v144, v144
    v_rcp_f32 v145, v145
    v_rcp_f32 v146, v146
    v_rcp_f32 v147, v147
    v_rcp_f32 v152, v152
    v_rcp_f32 v153, v153
    v_rcp_f32 v154, v154
    v_rcp_f32 v155, v155
    v_mul_f32 v144, v144, v148
    v_mul_f32 v145, v145, v149
    v_mul_f32 v146, v146, v150
    v_mul_f32 v147, v147, v151
    v_mul_f32 v152, v152, v156
    v_mul_f32 v153, v153, v157
    v_mul_f32 v154, v154, v158
    v_mul_f32 v155, v155, v159
    v_cvt_pk_bf16_f32 v208, v144, v145
    v_cvt_pk_bf16_f32 v209, v146, v147
    v_cvt_pk_bf16_f32 v210, v152, v153
    v_cvt_pk_bf16_f32 v211, v154, v155
    s_mov_b32 s84, 6144
    s_nop 0
    v_permlane16_swap_b32 v208, v210
    v_permlane16_swap_b32 v209, v211
    buffer_store_dwordx4 v[208:211], v10, s[44:47], s84 offen sc1
    v_add_u32 v10, v1, v10
    v_mul_f32 v160, v128, v128
    v_mul_f32 v161, v129, v129
    v_mul_f32 v162, v130, v130
    v_mul_f32 v163, v131, v131
    v_mul_f32 v168, v132, v132
    v_mul_f32 v169, v133, v133
    v_mul_f32 v170, v134, v134
    v_mul_f32 v171, v135, v135
    v_fma_f32 v160, v160, v6, v4
    v_fma_f32 v161, v161, v6, v4
    v_fma_f32 v162, v162, v6, v4
    v_fma_f32 v163, v163, v6, v4
    v_fma_f32 v168, v168, v6, v4
    v_fma_f32 v169, v169, v6, v4
    v_fma_f32 v170, v170, v6, v4
    v_fma_f32 v171, v171, v6, v4
    v_mul_f32 v160, v160, v128
    v_mul_f32 v161, v161, v129
    v_mul_f32 v162, v162, v130
    v_mul_f32 v163, v163, v131
    v_mul_f32 v168, v168, v132
    v_mul_f32 v169, v169, v133
    v_mul_f32 v170, v170, v134
    v_mul_f32 v171, v171, v135
    v_exp_f32 v160, v160
    v_mul_f32 v164, v128, v136
    v_exp_f32 v161, v161
    v_mul_f32 v165, v129, v137
    v_exp_f32 v162, v162
    v_mul_f32 v166, v130, v138
    v_exp_f32 v163, v163
    v_mul_f32 v167, v131, v139
    v_exp_f32 v168, v168
    v_mul_f32 v172, v132, v140
    v_exp_f32 v169, v169
    v_mul_f32 v173, v133, v141
    v_exp_f32 v170, v170
    v_mul_f32 v174, v134, v142
    v_exp_f32 v171, v171
    v_mul_f32 v175, v135, v143
    v_add_f32 v160, 1.0, v160
    v_add_f32 v161, 1.0, v161
    v_add_f32 v162, 1.0, v162
    v_add_f32 v163, 1.0, v163
    v_add_f32 v168, 1.0, v168
    v_add_f32 v169, 1.0, v169
    v_add_f32 v170, 1.0, v170
    v_add_f32 v171, 1.0, v171
    v_rcp_f32 v160, v160
    v_rcp_f32 v161, v161
    v_rcp_f32 v162, v162
    v_rcp_f32 v163, v163
    v_rcp_f32 v168, v168
    v_rcp_f32 v169, v169
    v_rcp_f32 v170, v170
    v_rcp_f32 v171, v171
    v_mul_f32 v160, v160, v164
    v_mul_f32 v161, v161, v165
    v_mul_f32 v162, v162, v166
    v_mul_f32 v163, v163, v167
    v_mul_f32 v168, v168, v172
    v_mul_f32 v169, v169, v173
    v_mul_f32 v170, v170, v174
    v_mul_f32 v171, v171, v175
    v_cvt_pk_bf16_f32 v212, v160, v161
    v_cvt_pk_bf16_f32 v213, v162, v163
    v_cvt_pk_bf16_f32 v214, v168, v169
    v_cvt_pk_bf16_f32 v215, v170, v171
    s_mov_b32 s84, 7168
    s_nop 0
    v_permlane16_swap_b32 v212, v214
    v_permlane16_swap_b32 v213, v215
    buffer_store_dwordx4 v[212:215], v10, s[44:47], s84 offen sc1
P_duty:
    s_setprio 3
    s_add_u32 s16, s38, 33554432
    s_addc_u32 s17, s39, 0
    s_mov_b32 s18, 4194304
    s_mov_b32 s19, 0x00020000
    s_add_u32 s24, s38, 41943040
    s_addc_u32 s25, s39, 0
    s_mov_b32 s26, 8192
    s_mov_b32 s27, 0x00020000
    s_mov_b32 exec_lo, 0x0fffffff
    buffer_load_dword v247, v243, s[28:31], 0 offen sc1
    s_waitcnt vmcnt(0)
    s_cmp_ge_u32 s2, 224
    s_cbranch_scc1 FH_nopubP
    s_mov_b64 exec, 1
    buffer_store_dword v11, v12, s[28:31], s79 offen sc1
    s_mov_b64 exec, -1
FH_nopubP:
    s_mov_b32 exec_lo, 0x0fffffff
FH_chk:
    v_cmp_ne_u32 vcc, 1, v247
    s_nop 3
    s_cbranch_vccz FH_ok
    s_sleep 3
    buffer_load_dword v247, v243, s[28:31], 0 offen sc1
    s_waitcnt vmcnt(0)
    s_branch FH_chk
FH_ok:
    s_mov_b64 exec, -1
    s_cmp_lg_u32 s85, 10240
    s_cbranch_scc1 P_pfd
    s_add_u32 m0, s50, 155648
    s_nop 0
    buffer_load_dwordx4 v241, s[12:15], s54 offen offset:0 sc1 lds
    buffer_load_dwordx4 v250, s[12:15], s54 offen offset:1024 sc1 lds
    s_add_u32 m0, s50, 147456
    s_add_u32 s54, s54, s85
    buffer_load_dwordx4 v241, s[12:15], s54 offen offset:0 sc1 lds
    buffer_load_dwordx4 v250, s[12:15], s54 offen offset:1024 sc1 lds
    s_add_u32 m0, s50, 139264
    s_add_u32 s54, s54, s86
    buffer_load_dwordx4 v241, s[12:15], s54 offen offset:0 sc1 lds
    buffer_load_dwordx4 v250, s[12:15], s54 offen offset:1024 sc1 lds
    s_add_u32 m0, s50, 131072
    s_add_u32 s54, s54, s85
    buffer_load_dwordx4 v241, s[12:15], s54 offen offset:0 sc1 lds
    buffer_load_dwordx4 v250, s[12:15], s54 offen offset:1024 sc1 lds
    s_add_u32 m0, s50, 122880
    s_add_u32 s54, s54, s86
    buffer_load_dwordx4 v241, s[12:15], s54 offen offset:0 sc1 lds
    buffer_load_dwordx4 v250, s[12:15], s54 offen offset:1024 sc1 lds
P_pfd:
    s_add_u32 m0, s50, 0
    s_nop 0
    buffer_load_dwordx4 v240, s[20:23], s53 offen offset:0 sc1 lds
    buffer_load_dwordx4 v253, s[20:23], s53 offen offset:1024 sc1 lds
    s_add_u32 m0, s50, 8192
    s_add_u32 s53, s53, 10240
    buffer_load_dwordx4 v240, s[20:23], s53 offen offset:0 sc1 lds
    buffer_load_dwordx4 v253, s[20:23], s53 offen offset:1024 sc1 lds
    s_add_u32 m0, s50, 16384
    s_add_u32 s53, s53, 10240
    buffer_load_dwordx4 v240, s[20:23], s53 offen offset:0 sc1 lds
    buffer_load_dwordx4 v253, s[20:23], s53 offen offset:1024 sc1 lds
    s_add_u32 m0, s50, 24576
    s_add_u32 s53, s53, 10240
    buffer_load_dwordx4 v240, s[20:23], s53 offen offset:0 sc1 lds
    buffer_load_dwordx4 v253, s[20:23], s53 offen offset:1024 sc1 lds
    s_add_u32 m0, s50, 32768
    s_add_u32 s53, s53, 10240
    buffer_load_dwordx4 v240, s[20:23], s53 offen offset:0 sc1 lds
    buffer_load_dwordx4 v253, s[20:23], s53 offen offset:1024 sc1 lds
    buffer_load_dword v220, v219, s[24:27], 0 offen offset:0 sc1
    buffer_load_dword v221, v219, s[24:27], 0 offen offset:64 sc1
    buffer_load_dword v222, v219, s[24:27], 0 offen offset:128 sc1
    buffer_load_dword v223, v219, s[24:27], 0 offen offset:192 sc1
    v_lshrrev_b32 v105, 5, v2
    v_lshlrev_b32 v105, 3, v105
    v_bfe_u32 v106, v2, 3, 2
    v_add_u32 v105, v105, v106
    v_bfe_u32 v106, v2, 4, 2
    v_lshlrev_b32 v106, 1, v106
    v_and_b32 v107, 7, v2
    v_xor_b32 v106, v106, v107
    v_lshlrev_b32 v106, 4, v106
    s_lshl_b32 s42, s75, 4
    s_lshl_b32 s43, s76, 2
    s_add_u32 s42, s42, s43
    s_and_b32 s43, s69, 7
    s_cmp_eq_u32 s43, 3
    s_cbranch_scc1 P_sq
    s_mov_b32 s56, s36
    s_mov_b32 s57, s37
    s_mov_b32 s58, 7340032
    s_mov_b32 s59, 0x00020000
    v_add_u32 v105, s42, v105
    v_lshl_add_u32 v105, v105, 11, v106
    s_lshl_b32 s43, s69, 7
    v_add_u32 v242, s43, v105
    s_mov_b32 s87, 65536
    s_branch P_sqd
P_sq:
    s_add_u32 s56, s38, 58720256
    s_addc_u32 s57, s39, 0
    s_mov_b32 s58, 1147904
    s_mov_b32 s59, 0x00020000
    s_lshr_b32 s43, s69, 3
    s_mul_i32 s43, s43, 5120
    s_add_u32 s43, s43, 1024
    v_add_u32 v242, s42, v105
    v_add_u32 v107, 4, v242
    v_mul_u32_u24 v107, 37, v107
    v_lshrrev_b32 v107, 8, v107
    v_add_u32 v242, v242, v107
    v_lshlrev_b32 v242, 7, v242
    v_add3_u32 v242, v242, v106, s43
    s_mov_b32 s87, 10240
P_sqd:
    s_mul_i32 s42, s83, 56
    s_add_u32 s51, s42, 38
    s_mul_i32 s51, s51, s87
    s_sub_u32 s49, 94, s42
    s_mul_i32 s49, s49, s87
    v_and_b32 v3, 15, v2
    v_lshlrev_b32 v246, 7, v3
    v_lshrrev_b32 v245, 4, v2
    v_lshlrev_b32 v244, 1, v245
    v_xor_b32 v244, v244, v3
    v_lshlrev_b32 v244, 4, v244
    v_lshl_add_u32 v244, v245, 8, v244
    s_lshl_b32 s43, s69, 4
    s_add_u32 s43, s43, s68
    s_lshl_b32 s43, s43, 14
    s_lshl_b32 s42, s70, 12
    s_add_u32 s43, s43, s42
    v_add_u32 v244, s43, v244
    v_xor_b32 v245, 128, v244
    s_add_u32 s33, s42, 57344
    s_lshl_b32 s35, s69, 11
    s_add_u32 s60, s38, 75497472
    s_addc_u32 s61, s39, 0
    s_mov_b32 s62, 8388608
    s_mov_b32 s63, 0x00020000
    s_lshl_b32 s43, s2, 2
    s_add_u32 s43, s43, s70
    s_xor_b32 s43, s43, 16
    s_lshl_b32 s36, s43, 7
    s_add_u32 s36, s36, 294912
    s_lshl_b32 s37, s43, 12
    v_bfe_u32 v105, v2, 2, 3
    s_lshl_b32 s42, s75, 2
    v_xor_b32 v105, s42, v105
    v_lshlrev_b32 v105, 5, v105
    v_lshrrev_b32 v106, 2, v2
    v_lshl_add_u32 v105, v106, 8, v105
    v_and_b32 v106, 3, v2
    v_lshlrev_b32 v106, 3, v106
    s_lshl_b32 s43, s76, 13
    s_add_u32 s43, s43, 57344
    v_add3_u32 v102, v106, v105, s43
    s_lshl_b32 s43, s70, 13
    s_add_u32 s43, s43, 73728
    v_add_u32 v104, s43, v249
    v_permlane16_swap_b32 v224, v226
    v_permlane16_swap_b32 v225, v227
    v_permlane16_swap_b32 v228, v230
    v_permlane16_swap_b32 v229, v231
    v_permlane16_swap_b32 v232, v234
    v_permlane16_swap_b32 v233, v235
    v_permlane16_swap_b32 v236, v238
    v_permlane16_swap_b32 v237, v239
    v_lshlrev_b32 v176, 16, v224
    v_and_b32 v177, 0xffff0000, v224
    v_lshlrev_b32 v178, 16, v225
    v_and_b32 v179, 0xffff0000, v225
    v_lshlrev_b32 v180, 16, v226
    v_and_b32 v181, 0xffff0000, v226
    v_lshlrev_b32 v182, 16, v227
    v_and_b32 v183, 0xffff0000, v227
    v_lshlrev_b32 v184, 16, v228
    v_and_b32 v185, 0xffff0000, v228
    v_lshlrev_b32 v186, 16, v229
    v_and_b32 v187, 0xffff0000, v229
    v_lshlrev_b32 v188, 16, v230
    v_and_b32 v189, 0xffff0000, v230
    v_lshlrev_b32 v190, 16, v231
    v_and_b32 v191, 0xffff0000, v231
    v_lshlrev_b32 v192, 16, v232
    v_and_b32 v193, 0xffff0000, v232
    v_lshlrev_b32 v194, 16, v233
    v_and_b32 v195, 0xffff0000, v233
    v_lshlrev_b32 v196, 16, v234
    v_and_b32 v197, 0xffff0000, v234
    v_lshlrev_b32 v198, 16, v235
    v_and_b32 v199, 0xffff0000, v235
    v_lshlrev_b32 v200, 16, v236
    v_and_b32 v201, 0xffff0000, v236
    v_lshlrev_b32 v202, 16, v237
    v_and_b32 v203, 0xffff0000, v237
    v_lshlrev_b32 v204, 16, v238
    v_and_b32 v205, 0xffff0000, v238
    v_lshlrev_b32 v206, 16, v239
    v_and_b32 v207, 0xffff0000, v239
    s_waitcnt vmcnt(12)
    s_barrier
    s_add_u32 m0, s50, 114688
    s_add_u32 s54, s54, s85
    buffer_load_dwordx4 v241, s[12:15], s54 offen offset:0 sc1 lds
    buffer_load_dwordx4 v250, s[12:15], s54 offen offset:1024 sc1 lds
    s_add_u32 m0, s50, 40960
    s_add_u32 s53, s53, 10240
    buffer_load_dwordx4 v240, s[20:23], s53 offen offset:0 sc1 lds
    buffer_load_dwordx4 v253, s[20:23], s53 offen offset:1024 sc1 lds
    s_add_u32 m0, s50, 106496
    s_add_u32 s54, s54, s86
    buffer_load_dwordx4 v241, s[12:15], s54 offen offset:0 sc1 lds
    buffer_load_dwordx4 v250, s[12:15], s54 offen offset:1024 sc1 lds
    s_add_u32 m0, s50, 49152
    s_add_u32 s53, s53, 10240
    buffer_load_dwordx4 v240, s[20:23], s53 offen offset:0 sc1 lds
    buffer_load_dwordx4 v253, s[20:23], s53 offen offset:1024 sc1 lds
P_loop:
    s_waitcnt vmcnt(18)
    s_barrier
    s_sub_u32 m0, s91, s90
    s_add_u32 s54, s54, s85
    buffer_load_dwordx4 v241, s[12:15], s54 offen offset:0 sc1 lds
    buffer_load_dwordx4 v250, s[12:15], s54 offen offset:1024 sc1 lds
    s_add_u32 m0, s50, s90
    s_add_u32 s53, s53, 10240
    buffer_load_dwordx4 v240, s[20:23], s53 offen offset:0 sc1 lds
    buffer_load_dwordx4 v253, s[20:23], s53 offen offset:1024 sc1 lds
    s_add_u32 s90, s90, 8192
    s_cmp_eq_u32 s90, 57344
    s_cselect_b32 s90, 0, s90
    s_waitcnt vmcnt(20)
    s_barrier
    s_sub_u32 m0, s91, s90
    s_add_u32 s54, s54, s86
    buffer_load_dwordx4 v241, s[12:15], s54 offen offset:0 sc1 lds
    buffer_load_dwordx4 v250, s[12:15], s54 offen offset:1024 sc1 lds
    s_add_u32 m0, s50, s90
    s_add_u32 s53, s53, 10240
    buffer_load_dwordx4 v240, s[20:23], s53 offen offset:0 sc1 lds
    buffer_load_dwordx4 v253, s[20:23], s53 offen offset:1024 sc1 lds
    s_add_u32 s90, s90, 8192
    s_cmp_eq_u32 s90, 57344
    s_cselect_b32 s90, 0, s90
    s_waitcnt vmcnt(22)
    s_barrier
    s_sub_u32 m0, s91, s90
    s_add_u32 s54, s54, s85
    buffer_load_dwordx4 v241, s[12:15], s54 offen offset:0 sc1 lds
    buffer_load_dwordx4 v250, s[12:15], s54 offen offset:1024 sc1 lds
    s_add_u32 m0, s50, s90
    s_add_u32 s53, s53, 10240
    buffer_load_dwordx4 v240, s[20:23], s53 offen offset:0 sc1 lds
    buffer_load_dwordx4 v253, s[20:23], s53 offen offset:1024 sc1 lds
    s_add_u32 s90, s90, 8192
    s_cmp_eq_u32 s90, 57344
    s_cselect_b32 s90, 0, s90
    s_mov_b32 s88, 7
LOOP_76:
    s_waitcnt vmcnt(20)
    s_barrier
    s_sub_u32 m0, s91, s90
    s_add_u32 s54, s54, s86
    buffer_load_dwordx4 v241, s[12:15], s54 offen offset:0 sc1 lds
    buffer_load_dwordx4 v250, s[12:15], s54 offen offset:1024 sc1 lds
    s_add_u32 m0, s50, s90
    s_add_u32 s53, s53, 10240
    buffer_load_dwordx4 v240, s[20:23], s53 offen offset:0 sc1 lds
    buffer_load_dwordx4 v253, s[20:23], s53 offen offset:1024 sc1 lds
    s_add_u32 s90, s90, 8192
    s_cmp_eq_u32 s90, 57344
    s_cselect_b32 s90, 0, s90
    s_waitcnt vmcnt(20)
    s_barrier
    s_sub_u32 m0, s91, s90
    s_add_u32 s54, s54, s85
    buffer_load_dwordx4 v241, s[12:15], s54 offen offset:0 sc1 lds
    buffer_load_dwordx4 v250, s[12:15], s54 offen offset:1024 sc1 lds
    s_add_u32 m0, s50, s90
    s_add_u32 s53, s53, 10240
    buffer_load_dwordx4 v240, s[20:23], s53 offen offset:0 sc1 lds
    buffer_load_dwordx4 v253, s[20:23], s53 offen offset:1024 sc1 lds
    s_add_u32 s90, s90, 8192
    s_cmp_eq_u32 s90, 57344
    s_cselect_b32 s90, 0, s90
    s_sub_u32 s88, s88, 1
    s_cmp_lg_u32 s88, 0
    s_cbranch_scc1 LOOP_76
    s_waitcnt vmcnt(20)
    s_barrier
    buffer_load_dword v247, v248, s[28:31], 0 offen sc1
    s_sub_u32 m0, s91, s90
    s_add_u32 s54, s54, s86
    buffer_load_dwordx4 v241, s[12:15], s54 offen offset:0 sc1 lds
    buffer_load_dwordx4 v250, s[12:15], s54 offen offset:1024 sc1 lds
    s_add_u32 m0, s50, s90
    s_add_u32 s53, s53, 10240
    buffer_load_dwordx4 v240, s[20:23], s53 offen offset:0 sc1 lds
    buffer_load_dwordx4 v253, s[20:23], s53 offen offset:1024 sc1 lds
    s_add_u32 s90, s90, 8192
    s_cmp_eq_u32 s90, 57344
    s_cselect_b32 s90, 0, s90
    s_waitcnt vmcnt(20)
    s_barrier
    s_sub_u32 m0, s91, s90
    s_add_u32 s54, s54, s85
    buffer_load_dwordx4 v241, s[12:15], s54 offen offset:0 sc1 lds
    buffer_load_dwordx4 v250, s[12:15], s54 offen offset:1024 sc1 lds
    s_add_u32 m0, s50, s90
    s_add_u32 s53, s53, 10240
    buffer_load_dwordx4 v240, s[20:23], s53 offen offset:0 sc1 lds
    buffer_load_dwordx4 v253, s[20:23], s53 offen offset:1024 sc1 lds
    s_add_u32 s90, s90, 8192
    s_cmp_eq_u32 s90, 57344
    s_cselect_b32 s90, 0, s90
    s_waitcnt vmcnt(20)
    s_barrier
    s_sub_u32 m0, s91, s90
    s_add_u32 s54, s54, s86
    buffer_load_dwordx4 v241, s[12:15], s54 offen offset:0 sc1 lds
    buffer_load_dwordx4 v250, s[12:15], s54 offen offset:1024 sc1 lds
    s_add_u32 m0, s50, s90
    s_add_u32 s53, s53, 10240
    buffer_load_dwordx4 v240, s[20:23], s53 offen offset:0 sc1 lds
    buffer_load_dwordx4 v253, s[20:23], s53 offen offset:1024 sc1 lds
    s_add_u32 s90, s90, 8192
    s_cmp_eq_u32 s90, 57344
    s_cselect_b32 s90, 0, s90
    s_waitcnt vmcnt(20)
    s_barrier
    s_sub_u32 m0, s91, s90
    s_add_u32 s54, s54, s85
    buffer_load_dwordx4 v241, s[12:15], s54 offen offset:0 sc1 lds
    buffer_load_dwordx4 v250, s[12:15], s54 offen offset:1024 sc1 lds
    s_add_u32 m0, s50, s90
    s_add_u32 s53, s53, 10240
    buffer_load_dwordx4 v240, s[20:23], s53 offen offset:0 sc1 lds
    buffer_load_dwordx4 v253, s[20:23], s53 offen offset:1024 sc1 lds
    s_add_u32 s90, s90, 8192
    s_cmp_eq_u32 s90, 57344
    s_cselect_b32 s90, 0, s90
    s_waitcnt vmcnt(20)
    s_barrier
    s_waitcnt vmcnt(16)
    s_bfm_b64 exec, 56, 0
FH2_chk:
    v_cmp_ne_u32 vcc, 1, v247
    s_nop 3
    s_cbranch_vccz FH2_ok
    s_sleep 2
    buffer_load_dword v247, v248, s[28:31], 0 offen sc1
    s_waitcnt vmcnt(0)
    s_branch FH2_chk
FH2_ok:
    s_mov_b64 exec, -1
    s_sub_u32 m0, s91, s90
    s_mov_b32 s54, s55
    buffer_load_dwordx4 v241, s[12:15], s54 offen offset:0 sc1 lds
    buffer_load_dwordx4 v250, s[12:15], s54 offen offset:1024 sc1 lds
    s_add_u32 m0, s50, s90
    s_add_u32 s53, s53, 10240
    buffer_load_dwordx4 v240, s[20:23], s53 offen offset:0 sc1 lds
    buffer_load_dwordx4 v253, s[20:23], s53 offen offset:1024 sc1 lds
    s_add_u32 s90, s90, 8192
    s_cmp_eq_u32 s90, 57344
    s_cselect_b32 s90, 0, s90
    s_mov_b32 s88, 5
LOOP_84:
    s_waitcnt vmcnt(20)
    s_barrier
    s_sub_u32 m0, s91, s90
    s_add_u32 s54, s54, s85
    buffer_load_dwordx4 v241, s[12:15], s54 offen offset:0 sc1 lds
    buffer_load_dwordx4 v250, s[12:15], s54 offen offset:1024 sc1 lds
    s_add_u32 m0, s50, s90
    s_add_u32 s53, s53, 10240
    buffer_load_dwordx4 v240, s[20:23], s53 offen offset:0 sc1 lds
    buffer_load_dwordx4 v253, s[20:23], s53 offen offset:1024 sc1 lds
    s_add_u32 s90, s90, 8192
    s_cmp_eq_u32 s90, 57344
    s_cselect_b32 s90, 0, s90
    s_waitcnt vmcnt(20)
    s_barrier
    s_sub_u32 m0, s91, s90
    s_add_u32 s54, s54, s86
    buffer_load_dwordx4 v241, s[12:15], s54 offen offset:0 sc1 lds
    buffer_load_dwordx4 v250, s[12:15], s54 offen offset:1024 sc1 lds
    s_add_u32 m0, s50, s90
    s_add_u32 s53, s53, 10240
    buffer_load_dwordx4 v240, s[20:23], s53 offen offset:0 sc1 lds
    buffer_load_dwordx4 v253, s[20:23], s53 offen offset:1024 sc1 lds
    s_add_u32 s90, s90, 8192
    s_cmp_eq_u32 s90, 57344
    s_cselect_b32 s90, 0, s90
    s_sub_u32 s88, s88, 1
    s_cmp_lg_u32 s88, 0
    s_cbranch_scc1 LOOP_84
    s_waitcnt vmcnt(20)
    s_barrier
    buffer_load_dword v247, v246, s[28:31], s35 offen sc1
    s_sub_u32 m0, s91, s90
    s_add_u32 s54, s54, s85
    buffer_load_dwordx4 v241, s[12:15], s54 offen offset:0 sc1 lds
    buffer_load_dwordx4 v250, s[12:15], s54 offen offset:1024 sc1 lds
    s_add_u32 m0, s50, s90
    s_add_u32 s53, s53, 10240
    buffer_load_dwordx4 v240, s[20:23], s53 offen offset:0 sc1 lds
    buffer_load_dwordx4 v253, s[20:23], s53 offen offset:1024 sc1 lds
    s_add_u32 s90, s90, 8192
    s_cmp_eq_u32 s90, 57344
    s_cselect_b32 s90, 0, s90
    s_waitcnt vmcnt(20)
    s_barrier
    s_sub_u32 m0, s91, s90
    s_add_u32 s54, s54, s86
    buffer_load_dwordx4 v241, s[12:15], s54 offen offset:0 sc1 lds
    v_mul_f32 v176, v176, v220
    buffer_load_dwordx4 v250, s[12:15], s54 offen offset:1024 sc1 lds
    v_mul_f32 v177, v177, v220
    s_add_u32 m0, s50, s90
    s_add_u32 s53, s53, 10240
    buffer_load_dwordx4 v240, s[20:23], s53 offen offset:0 sc1 lds
    v_mul_f32 v178, v178, v220
    buffer_load_dwordx4 v253, s[20:23], s53 offen offset:1024 sc1 lds
    v_mul_f32 v179, v179, v220
    s_add_u32 s90, s90, 8192
    s_cmp_eq_u32 s90, 57344
    s_cselect_b32 s90, 0, s90
    s_waitcnt vmcnt(20)
    s_barrier
    s_sub_u32 m0, s91, s90
    s_add_u32 s54, s54, s85
    buffer_load_dwordx4 v241, s[12:15], s54 offen offset:0 sc1 lds
    v_mul_f32 v180, v180, v220
    buffer_load_dwordx4 v250, s[12:15], s54 offen offset:1024 sc1 lds
    v_mul_f32 v181, v181, v220
    s_add_u32 m0, s50, s90
    s_add_u32 s53, s53, 10240
    buffer_load_dwordx4 v240, s[20:23], s53 offen offset:0 sc1 lds
    v_mul_f32 v182, v182, v220
    buffer_load_dwordx4 v253, s[20:23], s53 offen offset:1024 sc1 lds
    v_mul_f32 v183, v183, v220
    s_add_u32 s90, s90, 8192
    s_cmp_eq_u32 s90, 57344
    s_cselect_b32 s90, 0, s90
    s_waitcnt vmcnt(20)
    s_barrier
    s_sub_u32 m0, s91, s90
    s_add_u32 s54, s54, s86
    buffer_load_dwordx4 v241, s[12:15], s54 offen offset:0 sc1 lds
    v_mul_f32 v184, v184, v221
    buffer_load_dwordx4 v250, s[12:15], s54 offen offset:1024 sc1 lds
    v_mul_f32 v185, v185, v221
    s_add_u32 m0, s50, s90
    s_add_u32 s53, s53, 10240
    buffer_load_dwordx4 v240, s[20:23], s53 offen offset:0 sc1 lds
    v_mul_f32 v186, v186, v221
    buffer_load_dwordx4 v253, s[20:23], s53 offen offset:1024 sc1 lds
    v_mul_f32 v187, v187, v221
    s_add_u32 s90, s90, 8192
    s_cmp_eq_u32 s90, 57344
    s_cselect_b32 s90, 0, s90
    s_waitcnt vmcnt(20)
    s_barrier
    s_waitcnt vmcnt(16)
FZ_chk:
    v_cmp_ne_u32 vcc, 1, v247
    s_nop 3
    s_cbranch_vccz FZ_ok
    s_sleep 2
    buffer_load_dword v247, v246, s[28:31], s35 offen sc1
    s_waitcnt vmcnt(0)
    s_branch FZ_chk
FZ_ok:
    s_mov_b32 m0, s33
    s_nop 0
    buffer_load_dwordx4 v244, s[16:19], 0 offen offset:0 sc1 lds
    s_sub_u32 m0, s91, s90
    s_add_u32 s54, s54, s85
    buffer_load_dwordx4 v241, s[12:15], s54 offen offset:0 sc1 lds
    v_mul_f32 v188, v188, v221
    buffer_load_dwordx4 v250, s[12:15], s54 offen offset:1024 sc1 lds
    v_mul_f32 v189, v189, v221
    s_add_u32 m0, s50, s90
    s_add_u32 s53, s53, 10240
    buffer_load_dwordx4 v240, s[20:23], s53 offen offset:0 sc1 lds
    v_mul_f32 v190, v190, v221
    buffer_load_dwordx4 v253, s[20:23], s53 offen offset:1024 sc1 lds
    v_mul_f32 v191, v191, v221
    s_add_u32 s90, s90, 8192
    s_cmp_eq_u32 s90, 57344
    s_cselect_b32 s90, 0, s90
    s_waitcnt vmcnt(20)
    s_barrier
    s_sub_u32 m0, s91, s90
    s_add_u32 s54, s54, s86
    buffer_load_dwordx4 v241, s[12:15], s54 offen offset:0 sc1 lds
    v_mul_f32 v192, v192, v222
    buffer_load_dwordx4 v250, s[12:15], s54 offen offset:1024 sc1 lds
    v_mul_f32 v193, v193, v222
    s_add_u32 m0, s50, s90
    s_add_u32 s53, s53, 10240
    buffer_load_dwordx4 v240, s[20:23], s53 offen offset:0 sc1 lds
    v_mul_f32 v194, v194, v222
    buffer_load_dwordx4 v253, s[20:23], s53 offen offset:1024 sc1 lds
    v_mul_f32 v195, v195, v222
    s_add_u32 s90, s90, 8192
    s_cmp_eq_u32 s90, 57344
    s_cselect_b32 s90, 0, s90
    s_waitcnt vmcnt(20)
    s_barrier
    s_mov_b32 m0, s33
    s_nop 0
    buffer_load_dwordx4 v245, s[16:19], 0 offen offset:1024 sc1 lds
    s_sub_u32 m0, s91, s90
    s_add_u32 s54, s54, s85
    buffer_load_dwordx4 v241, s[12:15], s54 offen offset:0 sc1 lds
    v_mul_f32 v196, v196, v222
    buffer_load_dwordx4 v250, s[12:15], s54 offen offset:1024 sc1 lds
    v_mul_f32 v197, v197, v222
    s_add_u32 m0, s50, s90
    s_add_u32 s53, s53, 10240
    buffer_load_dwordx4 v240, s[20:23], s53 offen offset:0 sc1 lds
    v_mul_f32 v198, v198, v222
    buffer_load_dwordx4 v253, s[20:23], s53 offen offset:1024 sc1 lds
    v_mul_f32 v199, v199, v222
    s_add_u32 s90, s90, 8192
    s_cmp_eq_u32 s90, 57344
    s_cselect_b32 s90, 0, s90
    s_waitcnt vmcnt(20)
    s_barrier
    s_add_u32 s91, s52, 155648
    s_sub_u32 m0, s91, s90
    s_mov_b32 s54, s51
    s_mov_b32 s85, s87
    s_mul_i32 s86, s87, 3
    buffer_load_dwordx4 v242, s[56:59], s54 offen sc1 lds
    v_mul_f32 v200, v200, v223
    v_mul_f32 v201, v201, v223
    s_add_u32 m0, s50, s90
    s_add_u32 s53, s53, 10240
    buffer_load_dwordx4 v240, s[20:23], s53 offen offset:0 sc1 lds
    v_mul_f32 v202, v202, v223
    v_mul_f32 v203, v203, v223
    buffer_load_dwordx4 v253, s[20:23], s53 offen offset:1024 sc1 lds
    s_add_u32 s90, s90, 8192
    s_cmp_eq_u32 s90, 57344
    s_cselect_b32 s90, 0, s90
    s_waitcnt vmcnt(19)
    s_barrier
    s_mov_b32 m0, s33
    s_nop 0
    buffer_load_dwordx4 v244, s[16:19], 0 offen offset:2048 sc1 lds
    s_sub_u32 m0, s91, s90
    s_add_u32 s54, s54, s85
    buffer_load_dwordx4 v242, s[56:59], s54 offen sc1 lds
    v_mul_f32 v204, v204, v223
    v_mul_f32 v205, v205, v223
    s_add_u32 m0, s50, s90
    s_add_u32 s53, s53, 10240
    buffer_load_dwordx4 v240, s[20:23], s53 offen offset:0 sc1 lds
    v_mul_f32 v206, v206, v223
    v_mul_f32 v207, v207, v223
    buffer_load_dwordx4 v253, s[20:23], s53 offen offset:1024 sc1 lds
    s_add_u32 s90, s90, 8192
    s_cmp_eq_u32 s90, 57344
    s_cselect_b32 s90, 0, s90
    s_waitcnt vmcnt(18)
    s_barrier
    s_sub_u32 m0, s91, s90
    s_add_u32 s54, s54, s86
    buffer_load_dwordx4 v242, s[56:59], s54 offen sc1 lds
    s_add_u32 m0, s50, s90
    s_add_u32 s53, s53, 10240
    buffer_load_dwordx4 v240, s[20:23], s53 offen offset:0 sc1 lds
    buffer_load_dwordx4 v253, s[20:23], s53 offen offset:1024 sc1 lds
    s_add_u32 s90, s90, 8192
    s_cmp_eq_u32 s90, 57344
    s_cselect_b32 s90, 0, s90
    s_waitcnt vmcnt(17)
    s_barrier
    s_mov_b32 m0, s33
    s_nop 0
    buffer_load_dwordx4 v245, s[16:19], 0 offen offset:3072 sc1 lds
    s_sub_u32 m0, s91, s90
    s_add_u32 s54, s54, s85
    buffer_load_dwordx4 v242, s[56:59], s54 offen sc1 lds
    s_add_u32 m0, s50, s90
    s_add_u32 s53, s53, 10240
    buffer_load_dwordx4 v240, s[20:23], s53 offen offset:0 sc1 lds
    buffer_load_dwordx4 v253, s[20:23], s53 offen offset:1024 sc1 lds
    s_add_u32 s90, s90, 8192
    s_cmp_eq_u32 s90, 57344
    s_cselect_b32 s90, 0, s90
    s_waitcnt vmcnt(16)
    s_barrier
    s_sub_u32 m0, s91, s90
    s_add_u32 s54, s54, s86
    buffer_load_dwordx4 v242, s[56:59], s54 offen sc1 lds
    s_add_u32 m0, s50, s90
    s_add_u32 s53, s53, 10240
    buffer_load_dwordx4 v240, s[20:23], s53 offen offset:0 sc1 lds
    buffer_load_dwordx4 v253, s[20:23], s53 offen offset:1024 sc1 lds
    s_add_u32 s90, s90, 8192
    s_cmp_eq_u32 s90, 57344
    s_cselect_b32 s90, 0, s90
    s_mov_b32 s88, 2
LOOP_99:
    s_waitcnt vmcnt(15)
    s_barrier
    s_sub_u32 m0, s91, s90
    s_add_u32 s54, s54, s85
    buffer_load_dwordx4 v242, s[56:59], s54 offen sc1 lds
    s_add_u32 m0, s50, s90
    s_add_u32 s53, s53, 10240
    buffer_load_dwordx4 v240, s[20:23], s53 offen offset:0 sc1 lds
    buffer_load_dwordx4 v253, s[20:23], s53 offen offset:1024 sc1 lds
    s_add_u32 s90, s90, 8192
    s_cmp_eq_u32 s90, 57344
    s_cselect_b32 s90, 0, s90
    s_waitcnt vmcnt(15)
    s_barrier
    s_sub_u32 m0, s91, s90
    s_add_u32 s54, s54, s86
    buffer_load_dwordx4 v242, s[56:59], s54 offen sc1 lds
    s_add_u32 m0, s50, s90
    s_add_u32 s53, s53, 10240
    buffer_load_dwordx4 v240, s[20:23], s53 offen offset:0 sc1 lds
    buffer_load_dwordx4 v253, s[20:23], s53 offen offset:1024 sc1 lds
    s_add_u32 s90, s90, 8192
    s_cmp_eq_u32 s90, 57344
    s_cselect_b32 s90, 0, s90
    s_sub_u32 s88, s88, 1
    s_cmp_lg_u32 s88, 0
    s_cbranch_scc1 LOOP_99
    s_waitcnt vmcnt(15)
    s_barrier
    s_sub_u32 m0, s91, s90
    s_add_u32 s54, s54, s85
    buffer_load_dwordx4 v242, s[56:59], s54 offen sc1 lds
    ds_read_b64_tr_b16 v[208:209], v102 offset:0
    ds_read_b64_tr_b16 v[210:211], v102 offset:4096
    v_xor_b32 v103, 32, v102
    ds_read_b64_tr_b16 v[212:213], v103 offset:0
    s_add_u32 m0, s50, s90
    s_add_u32 s53, s53, 10240
    buffer_load_dwordx4 v240, s[20:23], s53 offen offset:0 sc1 lds
    ds_read_b64_tr_b16 v[214:215], v103 offset:4096
    v_xor_b32 v103, 64, v102
    ds_read_b64_tr_b16 v[216:217], v103 offset:0
    ds_read_b64_tr_b16 v[218:219], v103 offset:4096
    buffer_load_dwordx4 v253, s[20:23], s53 offen offset:1024 sc1 lds
    v_xor_b32 v103, 96, v102
    ds_read_b64_tr_b16 v[220:221], v103 offset:0
    ds_read_b64_tr_b16 v[222:223], v103 offset:4096
    s_add_u32 s90, s90, 8192
    s_cmp_eq_u32 s90, 57344
    s_cselect_b32 s90, 0, s90
    s_waitcnt vmcnt(15) lgkmcnt(0)
    s_barrier
    s_sub_u32 m0, s91, s90
    s_mov_b32 s54, s49
    buffer_load_dwordx4 v242, s[56:59], s54 offen sc1 lds
    v_lshlrev_b32 v20, 16, v208
    v_and_b32 v21, 0xffff0000, v208
    v_lshlrev_b32 v22, 16, v209
    s_add_u32 m0, s50, s90
    s_mov_b32 s53, s48
    buffer_load_dwordx4 v240, s[20:23], s53 offen offset:0 sc1 lds
    v_and_b32 v23, 0xffff0000, v209
    v_mul_f32 v176, v176, v20
    v_mul_f32 v177, v177, v21
    buffer_load_dwordx4 v253, s[20:23], s53 offen offset:1024 sc1 lds
    v_mul_f32 v178, v178, v22
    v_mul_f32 v179, v179, v23
    s_add_u32 s90, s90, 8192
    s_cmp_eq_u32 s90, 57344
    s_cselect_b32 s90, 0, s90
    s_waitcnt vmcnt(15)
    s_barrier
    s_sub_u32 m0, s91, s90
    s_add_u32 s54, s54, s85
    buffer_load_dwordx4 v242, s[56:59], s54 offen sc1 lds
    v_lshlrev_b32 v16, 16, v210
    v_and_b32 v17, 0xffff0000, v210
    v_lshlrev_b32 v18, 16, v211
    s_add_u32 m0, s50, s90
    s_add_u32 s53, s53, 10240
    buffer_load_dwordx4 v240, s[20:23], s53 offen offset:0 sc1 lds
    v_and_b32 v19, 0xffff0000, v211
    v_mul_f32 v180, v180, v16
    v_mul_f32 v181, v181, v17
    buffer_load_dwordx4 v253, s[20:23], s53 offen offset:1024 sc1 lds
    v_mul_f32 v182, v182, v18
    v_mul_f32 v183, v183, v19
    s_add_u32 s90, s90, 8192
    s_cmp_eq_u32 s90, 57344
    s_cselect_b32 s90, 0, s90
    s_waitcnt vmcnt(15)
    s_barrier
    s_sub_u32 m0, s91, s90
    s_add_u32 s54, s54, s86
    buffer_load_dwordx4 v242, s[56:59], s54 offen sc1 lds
    v_lshlrev_b32 v20, 16, v212
    v_and_b32 v21, 0xffff0000, v212
    v_lshlrev_b32 v22, 16, v213
    s_add_u32 m0, s50, s90
    s_add_u32 s53, s53, 10240
    buffer_load_dwordx4 v240, s[20:23], s53 offen offset:0 sc1 lds
    v_and_b32 v23, 0xffff0000, v213
    v_mul_f32 v184, v184, v20
    v_mul_f32 v185, v185, v21
    buffer_load_dwordx4 v253, s[20:23], s53 offen offset:1024 sc1 lds
    v_mul_f32 v186, v186, v22
    v_mul_f32 v187, v187, v23
    s_add_u32 s90, s90, 8192
    s_cmp_eq_u32 s90, 57344
    s_cselect_b32 s90, 0, s90
    s_waitcnt vmcnt(15)
    s_barrier
    s_sub_u32 m0, s91, s90
    s_add_u32 s54, s54, s85
    buffer_load_dwordx4 v242, s[56:59], s54 offen sc1 lds
    v_lshlrev_b32 v16, 16, v214
    v_and_b32 v17, 0xffff0000, v214
    v_lshlrev_b32 v18, 16, v215
    s_add_u32 m0, s50, s90
    s_add_u32 s53, s53, 10240
    buffer_load_dwordx4 v240, s[20:23], s53 offen offset:0 sc1 lds
    v_and_b32 v19, 0xffff0000, v215
    v_mul_f32 v188, v188, v16
    v_mul_f32 v189, v189, v17
    buffer_load_dwordx4 v253, s[20:23], s53 offen offset:1024 sc1 lds
    v_mul_f32 v190, v190, v18
    v_mul_f32 v191, v191, v19
    s_add_u32 s90, s90, 8192
    s_cmp_eq_u32 s90, 57344
    s_cselect_b32 s90, 0, s90
    s_waitcnt vmcnt(15)
    s_barrier
    s_sub_u32 m0, s91, s90
    s_add_u32 s54, s54, s86
    buffer_load_dwordx4 v242, s[56:59], s54 offen sc1 lds
    v_lshlrev_b32 v20, 16, v216
    v_and_b32 v21, 0xffff0000, v216
    v_lshlrev_b32 v22, 16, v217
    s_add_u32 m0, s50, s90
    s_add_u32 s53, s53, 10240
    buffer_load_dwordx4 v240, s[20:23], s53 offen offset:0 sc1 lds
    v_and_b32 v23, 0xffff0000, v217
    v_mul_f32 v192, v192, v20
    v_mul_f32 v193, v193, v21
    buffer_load_dwordx4 v253, s[20:23], s53 offen offset:1024 sc1 lds
    v_mul_f32 v194, v194, v22
    v_mul_f32 v195, v195, v23
    s_add_u32 s90, s90, 8192
    s_cmp_eq_u32 s90, 57344
    s_cselect_b32 s90, 0, s90
    s_waitcnt vmcnt(15)
    s_barrier
    s_sub_u32 m0, s91, s90
    s_add_u32 s54, s54, s85
    buffer_load_dwordx4 v242, s[56:59], s54 offen sc1 lds
    v_lshlrev_b32 v16, 16, v218
    v_and_b32 v17, 0xffff0000, v218
    v_lshlrev_b32 v18, 16, v219
    s_add_u32 m0, s50, s90
    s_add_u32 s53, s53, 10240
    buffer_load_dwordx4 v240, s[20:23], s53 offen offset:0 sc1 lds
    v_and_b32 v19, 0xffff0000, v219
    v_mul_f32 v196, v196, v16
    v_mul_f32 v197, v197, v17
    buffer_load_dwordx4 v253, s[20:23], s53 offen offset:1024 sc1 lds
    v_mul_f32 v198, v198, v18
    v_mul_f32 v199, v199, v19
    s_add_u32 s90, s90, 8192
    s_cmp_eq_u32 s90, 57344
    s_cselect_b32 s90, 0, s90
    s_waitcnt vmcnt(15)
    s_barrier
    buffer_load_dword v247, v12, s[28:31], s36 offen sc1
    s_sub_u32 m0, s91, s90
    s_add_u32 s54, s54, s86
    buffer_load_dwordx4 v242, s[56:59], s54 offen sc1 lds
    v_lshlrev_b32 v20, 16, v220
    v_and_b32 v21, 0xffff0000, v220
    v_lshlrev_b32 v22, 16, v221
    s_add_u32 m0, s50, s90
    s_add_u32 s53, s53, 10240
    buffer_load_dwordx4 v240, s[20:23], s53 offen offset:0 sc1 lds
    v_and_b32 v23, 0xffff0000, v221
    v_mul_f32 v200, v200, v20
    v_mul_f32 v201, v201, v21
    buffer_load_dwordx4 v253, s[20:23], s53 offen offset:1024 sc1 lds
    v_mul_f32 v202, v202, v22
    v_mul_f32 v203, v203, v23
    s_add_u32 s90, s90, 8192
    s_cmp_eq_u32 s90, 57344
    s_cselect_b32 s90, 0, s90
    s_waitcnt vmcnt(15)
    s_barrier
    s_sub_u32 m0, s91, s90
    s_add_u32 s54, s54, s85
    buffer_load_dwordx4 v242, s[56:59], s54 offen sc1 lds
    v_lshlrev_b32 v16, 16, v222
    v_and_b32 v17, 0xffff0000, v222
    v_lshlrev_b32 v18, 16, v223
    s_add_u32 m0, s50, s90
    s_add_u32 s53, s53, 10240
    buffer_load_dwordx4 v240, s[20:23], s53 offen offset:0 sc1 lds
    v_and_b32 v19, 0xffff0000, v223
    v_mul_f32 v204, v204, v16
    v_mul_f32 v205, v205, v17
    buffer_load_dwordx4 v253, s[20:23], s53 offen offset:1024 sc1 lds
    v_mul_f32 v206, v206, v18
    v_mul_f32 v207, v207, v19
    s_add_u32 s90, s90, 8192
    s_cmp_eq_u32 s90, 57344
    s_cselect_b32 s90, 0, s90
    s_waitcnt vmcnt(15)
    s_barrier
    s_sub_u32 m0, s91, s90
    s_add_u32 s54, s54, s86
    buffer_load_dwordx4 v242, s[56:59], s54 offen sc1 lds
    s_add_u32 m0, s50, s90
    s_add_u32 s53, s53, 10240
    buffer_load_dwordx4 v240, s[20:23], s53 offen offset:0 sc1 lds
    buffer_load_dwordx4 v253, s[20:23], s53 offen offset:1024 sc1 lds
    s_add_u32 s90, s90, 8192
    s_cmp_eq_u32 s90, 57344
    s_cselect_b32 s90, 0, s90
    s_waitcnt vmcnt(15)
    s_barrier
    s_sub_u32 m0, s91, s90
    s_add_u32 s54, s54, s85
    buffer_load_dwordx4 v242, s[56:59], s54 offen sc1 lds
    s_add_u32 m0, s50, s90
    s_add_u32 s53, s53, 10240
    buffer_load_dwordx4 v240, s[20:23], s53 offen offset:0 sc1 lds
    buffer_load_dwordx4 v253, s[20:23], s53 offen offset:1024 sc1 lds
    s_add_u32 s90, s90, 8192
    s_cmp_eq_u32 s90, 57344
    s_cselect_b32 s90, 0, s90
    s_waitcnt vmcnt(12)
FX_chk:
    v_cmp_ne_u32 vcc, 1, v247
    s_mov_b32 m0, s33
    s_nop 2
    s_cbranch_vccz FX_ok
    s_sleep 1
    buffer_load_dword v247, v12, s[28:31], s36 offen sc1
    s_waitcnt vmcnt(0)
    s_branch FX_chk
FX_ok:
    buffer_load_dwordx4 v249, s[60:63], s37 offen offset:0 sc1 lds
    buffer_load_dwordx4 v249, s[60:63], s37 offen offset:1024 sc1 lds
    buffer_load_dwordx4 v249, s[60:63], s37 offen offset:2048 sc1 lds
    buffer_load_dwordx4 v249, s[60:63], s37 offen offset:3072 sc1 lds
    s_waitcnt vmcnt(20)
    s_barrier
    s_waitcnt vmcnt(17)
    s_barrier
    s_waitcnt vmcnt(13)
    s_barrier
    s_waitcnt vmcnt(10)
    s_barrier
    s_waitcnt vmcnt(7)
    s_barrier
    s_waitcnt vmcnt(4)
    s_barrier
    ds_write_b128 v104, v[176:179] offset:0
    ds_write_b128 v104, v[180:183] offset:1024
    ds_write_b128 v104, v[184:187] offset:2048
    ds_write_b128 v104, v[188:191] offset:3072
    ds_write_b128 v104, v[192:195] offset:4096
    ds_write_b128 v104, v[196:199] offset:5120
    ds_write_b128 v104, v[200:203] offset:6144
    ds_write_b128 v104, v[204:207] offset:7168
    s_waitcnt vmcnt(0) lgkmcnt(0)
    s_barrier
P_end:
    s_endpgm
.p2align 12
.fill 352, 4, 0xbf810000
G1_grpA:
    s_waitcnt vmcnt(12)
    s_barrier
    s_mov_b32 s90, 0
    s_mov_b32 s91, 0
    v_add_u32 v247, s90, v243
    v_add_u32 v248, s91, v245
    v_add_u32 v249, s91, v246
    ds_read_b64_tr_b16 v[208:209], v248 offset:0
    ds_read_b64_tr_b16 v[210:211], v248 offset:2048
    ds_read_b128 v[144:147], v247 offset:0
    ds_read_b128 v[148:151], v247 offset:2048
    ds_read_b128 v[152:155], v247 offset:4096
    ds_read_b128 v[156:159], v247 offset:6144
    ds_read_b128 v[160:163], v247 offset:8192
    ds_read_b128 v[164:167], v247 offset:10240
    ds_read_b128 v[168:171], v247 offset:12288
    ds_read_b128 v[172:175], v247 offset:14336
    ds_read_b64_tr_b16 v[212:213], v249 offset:0
    ds_read_b64_tr_b16 v[214:215], v249 offset:2048
    ds_read_b64_tr_b16 v[216:217], v248 offset:8192
    ds_read_b64_tr_b16 v[218:219], v248 offset:10240
    ds_read_b64_tr_b16 v[220:221], v249 offset:8192
    ds_read_b64_tr_b16 v[222:223], v249 offset:10240
    s_add_u32 s91, s91, 16384
    s_and_b32 s91, s91, 65535
    s_mov_b32 s89, 0
G1_loopA:
    s_waitcnt vmcnt(8) lgkmcnt(0)
    s_barrier
    v_mfma_f32_16x16x32_bf16 v[16:19], v[208:211], v[144:147], v[16:19]
    v_mfma_f32_16x16x32_bf16 v[20:23], v[212:215], v[144:147], v[20:23]
    s_add_u32 m0, s25, s86
    s_add_u32 s87, s25, s86
    buffer_load_dwordx4 v242, s[12:15], s85 offen lds
    v_mfma_f32_16x16x32_bf16 v[24:27], v[216:219], v[144:147], v[24:27]
    v_add_u32 v247, s90, v244
    v_add_u32 v248, s91, v245
    v_add_u32 v249, s91, v246
    v_mfma_f32_16x16x32_bf16 v[28:31], v[220:223], v[144:147], v[28:31]
    ds_read_b64_tr_b16 v[224:225], v248 offset:0
    v_mfma_f32_16x16x32_bf16 v[44:47], v[220:223], v[148:151], v[44:47]
    ds_read_b64_tr_b16 v[226:227], v248 offset:2048
    v_mfma_f32_16x16x32_bf16 v[40:43], v[216:219], v[148:151], v[40:43]
    ds_read_b128 v[176:179], v247 offset:0
    v_mfma_f32_16x16x32_bf16 v[36:39], v[212:215], v[148:151], v[36:39]
    ds_read_b128 v[180:183], v247 offset:2048
    v_mfma_f32_16x16x32_bf16 v[32:35], v[208:211], v[148:151], v[32:35]
    ds_read_b128 v[184:187], v247 offset:4096
    v_mfma_f32_16x16x32_bf16 v[48:51], v[208:211], v[152:155], v[48:51]
    ds_read_b128 v[188:191], v247 offset:6144
    v_mfma_f32_16x16x32_bf16 v[52:55], v[212:215], v[152:155], v[52:55]
    s_add_u32 m0, s87, 8192
    s_add_u32 s86, s86, 16384
    buffer_load_dwordx4 v242, s[16:19], s85 offen lds
    s_add_u32 s85, s85, 229376
    s_and_b32 s86, s86, 65535
    v_mfma_f32_16x16x32_bf16 v[56:59], v[216:219], v[152:155], v[56:59]
    ds_read_b128 v[192:195], v247 offset:8192
    v_mfma_f32_16x16x32_bf16 v[60:63], v[220:223], v[152:155], v[60:63]
    ds_read_b128 v[196:199], v247 offset:10240
    v_mfma_f32_16x16x32_bf16 v[76:79], v[220:223], v[156:159], v[76:79]
    ds_read_b128 v[200:203], v247 offset:12288
    v_mfma_f32_16x16x32_bf16 v[72:75], v[216:219], v[156:159], v[72:75]
    ds_read_b128 v[204:207], v247 offset:14336
    v_mfma_f32_16x16x32_bf16 v[68:71], v[212:215], v[156:159], v[68:71]
    ds_read_b64_tr_b16 v[228:229], v249 offset:0
    v_mfma_f32_16x16x32_bf16 v[64:67], v[208:211], v[156:159], v[64:67]
    ds_read_b64_tr_b16 v[230:231], v249 offset:2048
    v_mfma_f32_16x16x32_bf16 v[80:83], v[208:211], v[160:163], v[80:83]
    ds_read_b64_tr_b16 v[232:233], v248 offset:8192
    v_mfma_f32_16x16x32_bf16 v[84:87], v[212:215], v[160:163], v[84:87]
    s_add_u32 s87, s24, s26
    s_add_u32 m0, s87, 16384
    s_add_u32 s88, s27, 262144
    buffer_load_dwordx4 v240, s[8:11], s88 offen lds
    v_mfma_f32_16x16x32_bf16 v[88:91], v[216:219], v[160:163], v[88:91]
    ds_read_b64_tr_b16 v[234:235], v248 offset:10240
    v_mfma_f32_16x16x32_bf16 v[92:95], v[220:223], v[160:163], v[92:95]
    ds_read_b64_tr_b16 v[236:237], v249 offset:8192
    v_mfma_f32_16x16x32_bf16 v[108:111], v[220:223], v[164:167], v[108:111]
    ds_read_b64_tr_b16 v[238:239], v249 offset:10240
    v_mfma_f32_16x16x32_bf16 v[104:107], v[216:219], v[164:167], v[104:107]
    s_add_u32 s91, s91, 16384
    s_and_b32 s91, s91, 65535
    s_add_u32 s90, s90, 32768
    s_cmp_eq_u32 s90, 98304
    s_cselect_b32 s90, 0, s90
    v_mfma_f32_16x16x32_bf16 v[100:103], v[212:215], v[164:167], v[100:103]
    v_mfma_f32_16x16x32_bf16 v[96:99], v[208:211], v[164:167], v[96:99]
    v_mfma_f32_16x16x32_bf16 v[112:115], v[208:211], v[168:171], v[112:115]
    v_mfma_f32_16x16x32_bf16 v[116:119], v[212:215], v[168:171], v[116:119]
    buffer_load_dwordx4 v241, s[8:11], s88 offen offset:1024 lds
    s_add_u32 s27, s27, 128
    s_add_u32 s26, s26, 32768
    s_cmp_eq_u32 s26, 98304
    s_cselect_b32 s26, 0, s26
    v_mfma_f32_16x16x32_bf16 v[120:123], v[216:219], v[168:171], v[120:123]
    v_mfma_f32_16x16x32_bf16 v[124:127], v[220:223], v[168:171], v[124:127]
    v_mfma_f32_16x16x32_bf16 v[140:143], v[220:223], v[172:175], v[140:143]
    v_mfma_f32_16x16x32_bf16 v[136:139], v[216:219], v[172:175], v[136:139]
    v_mfma_f32_16x16x32_bf16 v[132:135], v[212:215], v[172:175], v[132:135]
    v_mfma_f32_16x16x32_bf16 v[128:131], v[208:211], v[172:175], v[128:131]
    s_waitcnt vmcnt(8) lgkmcnt(0)
    s_barrier
    v_mfma_f32_16x16x32_bf16 v[16:19], v[224:227], v[176:179], v[16:19]
    v_mfma_f32_16x16x32_bf16 v[20:23], v[228:231], v[176:179], v[20:23]
    s_add_u32 m0, s25, s86
    s_add_u32 s87, s25, s86
    buffer_load_dwordx4 v242, s[12:15], s85 offen lds
    v_mfma_f32_16x16x32_bf16 v[24:27], v[232:235], v[176:179], v[24:27]
    v_add_u32 v247, s90, v243
    v_add_u32 v248, s91, v245
    v_add_u32 v249, s91, v246
    v_mfma_f32_16x16x32_bf16 v[28:31], v[236:239], v[176:179], v[28:31]
    ds_read_b64_tr_b16 v[208:209], v248 offset:0
    v_mfma_f32_16x16x32_bf16 v[44:47], v[236:239], v[180:183], v[44:47]
    ds_read_b64_tr_b16 v[210:211], v248 offset:2048
    v_mfma_f32_16x16x32_bf16 v[40:43], v[232:235], v[180:183], v[40:43]
    ds_read_b128 v[144:147], v247 offset:0
    v_mfma_f32_16x16x32_bf16 v[36:39], v[228:231], v[180:183], v[36:39]
    ds_read_b128 v[148:151], v247 offset:2048
    v_mfma_f32_16x16x32_bf16 v[32:35], v[224:227], v[180:183], v[32:35]
    ds_read_b128 v[152:155], v247 offset:4096
    v_mfma_f32_16x16x32_bf16 v[48:51], v[224:227], v[184:187], v[48:51]
    ds_read_b128 v[156:159], v247 offset:6144
    v_mfma_f32_16x16x32_bf16 v[52:55], v[228:231], v[184:187], v[52:55]
    s_add_u32 m0, s87, 8192
    s_add_u32 s86, s86, 16384
    buffer_load_dwordx4 v242, s[16:19], s85 offen lds
    s_add_u32 s85, s85, 229376
    s_and_b32 s86, s86, 65535
    v_mfma_f32_16x16x32_bf16 v[56:59], v[232:235], v[184:187], v[56:59]
    ds_read_b128 v[160:163], v247 offset:8192
    v_mfma_f32_16x16x32_bf16 v[60:63], v[236:239], v[184:187], v[60:63]
    ds_read_b128 v[164:167], v247 offset:10240
    v_mfma_f32_16x16x32_bf16 v[76:79], v[236:239], v[188:191], v[76:79]
    ds_read_b128 v[168:171], v247 offset:12288
    v_mfma_f32_16x16x32_bf16 v[72:75], v[232:235], v[188:191], v[72:75]
    ds_read_b128 v[172:175], v247 offset:14336
    v_mfma_f32_16x16x32_bf16 v[68:71], v[228:231], v[188:191], v[68:71]
    ds_read_b64_tr_b16 v[212:213], v249 offset:0
    v_mfma_f32_16x16x32_bf16 v[64:67], v[224:227], v[188:191], v[64:67]
    ds_read_b64_tr_b16 v[214:215], v249 offset:2048
    v_mfma_f32_16x16x32_bf16 v[80:83], v[224:227], v[192:195], v[80:83]
    ds_read_b64_tr_b16 v[216:217], v248 offset:8192
    v_mfma_f32_16x16x32_bf16 v[84:87], v[228:231], v[192:195], v[84:87]
    s_add_u32 s87, s24, s26
    s_add_u32 m0, s87, 0
    s_mov_b32 s88, s27
    buffer_load_dwordx4 v240, s[8:11], s88 offen lds
    v_mfma_f32_16x16x32_bf16 v[88:91], v[232:235], v[192:195], v[88:91]
    ds_read_b64_tr_b16 v[218:219], v248 offset:10240
    v_mfma_f32_16x16x32_bf16 v[92:95], v[236:239], v[192:195], v[92:95]
    ds_read_b64_tr_b16 v[220:221], v249 offset:8192
    v_mfma_f32_16x16x32_bf16 v[108:111], v[236:239], v[196:199], v[108:111]
    ds_read_b64_tr_b16 v[222:223], v249 offset:10240
    v_mfma_f32_16x16x32_bf16 v[104:107], v[232:235], v[196:199], v[104:107]
    s_add_u32 s91, s91, 16384
    s_and_b32 s91, s91, 65535
    v_mfma_f32_16x16x32_bf16 v[100:103], v[228:231], v[196:199], v[100:103]
    v_mfma_f32_16x16x32_bf16 v[96:99], v[224:227], v[196:199], v[96:99]
    v_mfma_f32_16x16x32_bf16 v[112:115], v[224:227], v[200:203], v[112:115]
    v_mfma_f32_16x16x32_bf16 v[116:119], v[228:231], v[200:203], v[116:119]
    buffer_load_dwordx4 v241, s[8:11], s88 offen offset:1024 lds
    v_mfma_f32_16x16x32_bf16 v[120:123], v[232:235], v[200:203], v[120:123]
    v_mfma_f32_16x16x32_bf16 v[124:127], v[236:239], v[200:203], v[124:127]
    v_mfma_f32_16x16x32_bf16 v[140:143], v[236:239], v[204:207], v[140:143]
    v_mfma_f32_16x16x32_bf16 v[136:139], v[232:235], v[204:207], v[136:139]
    v_mfma_f32_16x16x32_bf16 v[132:135], v[228:231], v[204:207], v[132:135]
    v_mfma_f32_16x16x32_bf16 v[128:131], v[224:227], v[204:207], v[128:131]
    s_add_u32 s89, s89, 2
    s_cmp_lt_u32 s89, 26
    s_cbranch_scc1 G1_loopA
G1_tailA:
    s_waitcnt vmcnt(8) lgkmcnt(0)
    s_barrier
    buffer_load_dword v254, v255, s[56:59], 0 offen sc1
    v_mfma_f32_16x16x32_bf16 v[16:19], v[208:211], v[144:147], v[16:19]
    v_mfma_f32_16x16x32_bf16 v[20:23], v[212:215], v[144:147], v[20:23]
    s_add_u32 m0, s25, s86
    s_add_u32 s87, s25, s86
    buffer_load_dwordx4 v242, s[12:15], s85 offen lds
    v_mfma_f32_16x16x32_bf16 v[24:27], v[216:219], v[144:147], v[24:27]
    v_add_u32 v247, s90, v244
    v_add_u32 v248, s91, v245
    v_add_u32 v249, s91, v246
    v_mfma_f32_16x16x32_bf16 v[28:31], v[220:223], v[144:147], v[28:31]
    ds_read_b64_tr_b16 v[224:225], v248 offset:0
    v_mfma_f32_16x16x32_bf16 v[44:47], v[220:223], v[148:151], v[44:47]
    ds_read_b64_tr_b16 v[226:227], v248 offset:2048
    v_mfma_f32_16x16x32_bf16 v[40:43], v[216:219], v[148:151], v[40:43]
    ds_read_b128 v[176:179], v247 offset:0
    v_mfma_f32_16x16x32_bf16 v[36:39], v[212:215], v[148:151], v[36:39]
    ds_read_b128 v[180:183], v247 offset:2048
    v_mfma_f32_16x16x32_bf16 v[32:35], v[208:211], v[148:151], v[32:35]
    ds_read_b128 v[184:187], v247 offset:4096
    v_mfma_f32_16x16x32_bf16 v[48:51], v[208:211], v[152:155], v[48:51]
    ds_read_b128 v[188:191], v247 offset:6144
    v_mfma_f32_16x16x32_bf16 v[52:55], v[212:215], v[152:155], v[52:55]
    s_add_u32 m0, s87, 8192
    s_add_u32 s86, s86, 16384
    buffer_load_dwordx4 v242, s[16:19], s85 offen lds
    s_add_u32 s85, s85, 229376
    s_and_b32 s86, s86, 65535
    v_mfma_f32_16x16x32_bf16 v[56:59], v[216:219], v[152:155], v[56:59]
    ds_read_b128 v[192:195], v247 offset:8192
    v_mfma_f32_16x16x32_bf16 v[60:63], v[220:223], v[152:155], v[60:63]
    ds_read_b128 v[196:199], v247 offset:10240
    v_mfma_f32_16x16x32_bf16 v[76:79], v[220:223], v[156:159], v[76:79]
    ds_read_b128 v[200:203], v247 offset:12288
    v_mfma_f32_16x16x32_bf16 v[72:75], v[216:219], v[156:159], v[72:75]
    ds_read_b128 v[204:207], v247 offset:14336
    v_mfma_f32_16x16x32_bf16 v[68:71], v[212:215], v[156:159], v[68:71]
    ds_read_b64_tr_b16 v[228:229], v249 offset:0
    v_mfma_f32_16x16x32_bf16 v[64:67], v[208:211], v[156:159], v[64:67]
    ds_read_b64_tr_b16 v[230:231], v249 offset:2048
    v_mfma_f32_16x16x32_bf16 v[80:83], v[208:211], v[160:163], v[80:83]
    ds_read_b64_tr_b16 v[232:233], v248 offset:8192
    v_mfma_f32_16x16x32_bf16 v[84:87], v[212:215], v[160:163], v[84:87]
    s_add_u32 s87, s24, s26
    s_add_u32 m0, s87, 16384
    s_add_u32 s88, s27, 262144
    buffer_load_dwordx4 v240, s[8:11], s88 offen lds
    v_mfma_f32_16x16x32_bf16 v[88:91], v[216:219], v[160:163], v[88:91]
    ds_read_b64_tr_b16 v[234:235], v248 offset:10240
    v_mfma_f32_16x16x32_bf16 v[92:95], v[220:223], v[160:163], v[92:95]
    ds_read_b64_tr_b16 v[236:237], v249 offset:8192
    v_mfma_f32_16x16x32_bf16 v[108:111], v[220:223], v[164:167], v[108:111]
    ds_read_b64_tr_b16 v[238:239], v249 offset:10240
    v_mfma_f32_16x16x32_bf16 v[104:107], v[216:219], v[164:167], v[104:107]
    s_add_u32 s91, s91, 16384
    s_and_b32 s91, s91, 65535
    s_add_u32 s90, s90, 32768
    s_cmp_eq_u32 s90, 98304
    s_cselect_b32 s90, 0, s90
    v_mfma_f32_16x16x32_bf16 v[100:103], v[212:215], v[164:167], v[100:103]
    v_mfma_f32_16x16x32_bf16 v[96:99], v[208:211], v[164:167], v[96:99]
    v_mfma_f32_16x16x32_bf16 v[112:115], v[208:211], v[168:171], v[112:115]
    v_mfma_f32_16x16x32_bf16 v[116:119], v[212:215], v[168:171], v[116:119]
    buffer_load_dwordx4 v241, s[8:11], s88 offen offset:1024 lds
    s_add_u32 s27, s27, 128
    s_add_u32 s26, s26, 32768
    s_cmp_eq_u32 s26, 98304
    s_cselect_b32 s26, 0, s26
    v_mfma_f32_16x16x32_bf16 v[120:123], v[216:219], v[168:171], v[120:123]
    v_mfma_f32_16x16x32_bf16 v[124:127], v[220:223], v[168:171], v[124:127]
    v_mfma_f32_16x16x32_bf16 v[140:143], v[220:223], v[172:175], v[140:143]
    v_mfma_f32_16x16x32_bf16 v[136:139], v[216:219], v[172:175], v[136:139]
    v_mfma_f32_16x16x32_bf16 v[132:135], v[212:215], v[172:175], v[132:135]
    v_mfma_f32_16x16x32_bf16 v[128:131], v[208:211], v[172:175], v[128:131]
    s_waitcnt vmcnt(9) lgkmcnt(0)
    s_barrier
    v_mfma_f32_16x16x32_bf16 v[16:19], v[224:227], v[176:179], v[16:19]
    v_mfma_f32_16x16x32_bf16 v[20:23], v[228:231], v[176:179], v[20:23]
    s_add_u32 m0, s25, s86
    s_add_u32 s87, s25, s86
    buffer_load_dwordx4 v242, s[12:15], s85 offen lds
    v_mfma_f32_16x16x32_bf16 v[24:27], v[232:235], v[176:179], v[24:27]
    v_add_u32 v247, s90, v243
    v_add_u32 v248, s91, v245
    v_add_u32 v249, s91, v246
    v_mfma_f32_16x16x32_bf16 v[28:31], v[236:239], v[176:179], v[28:31]
    ds_read_b64_tr_b16 v[208:209], v248 offset:0
    v_mfma_f32_16x16x32_bf16 v[44:47], v[236:239], v[180:183], v[44:47]
    ds_read_b64_tr_b16 v[210:211], v248 offset:2048
    v_mfma_f32_16x16x32_bf16 v[40:43], v[232:235], v[180:183], v[40:43]
    ds_read_b128 v[144:147], v247 offset:0
    v_mfma_f32_16x16x32_bf16 v[36:39], v[228:231], v[180:183], v[36:39]
    ds_read_b128 v[148:151], v247 offset:2048
    v_mfma_f32_16x16x32_bf16 v[32:35], v[224:227], v[180:183], v[32:35]
    ds_read_b128 v[152:155], v247 offset:4096
    v_mfma_f32_16x16x32_bf16 v[48:51], v[224:227], v[184:187], v[48:51]
    ds_read_b128 v[156:159], v247 offset:6144
    v_mfma_f32_16x16x32_bf16 v[52:55], v[228:231], v[184:187], v[52:55]
    s_add_u32 m0, s87, 8192
    s_add_u32 s86, s86, 16384
    buffer_load_dwordx4 v242, s[16:19], s85 offen lds
    s_add_u32 s85, s85, 229376
    s_and_b32 s86, s86, 65535
    v_mfma_f32_16x16x32_bf16 v[56:59], v[232:235], v[184:187], v[56:59]
    ds_read_b128 v[160:163], v247 offset:8192
    v_mfma_f32_16x16x32_bf16 v[60:63], v[236:239], v[184:187], v[60:63]
    ds_read_b128 v[164:167], v247 offset:10240
    v_mfma_f32_16x16x32_bf16 v[76:79], v[236:239], v[188:191], v[76:79]
    ds_read_b128 v[168:171], v247 offset:12288
    v_mfma_f32_16x16x32_bf16 v[72:75], v[232:235], v[188:191], v[72:75]
    ds_read_b128 v[172:175], v247 offset:14336
    v_mfma_f32_16x16x32_bf16 v[68:71], v[228:231], v[188:191], v[68:71]
    ds_read_b64_tr_b16 v[212:213], v249 offset:0
    v_mfma_f32_16x16x32_bf16 v[64:67], v[224:227], v[188:191], v[64:67]
    ds_read_b64_tr_b16 v[214:215], v249 offset:2048
    v_mfma_f32_16x16x32_bf16 v[80:83], v[224:227], v[192:195], v[80:83]
    ds_read_b64_tr_b16 v[216:217], v248 offset:8192
    v_mfma_f32_16x16x32_bf16 v[84:87], v[228:231], v[192:195], v[84:87]
    ds_read_b64_tr_b16 v[218:219], v248 offset:10240
    v_mfma_f32_16x16x32_bf16 v[88:91], v[232:235], v[192:195], v[88:91]
    ds_read_b64_tr_b16 v[220:221], v249 offset:8192
    v_mfma_f32_16x16x32_bf16 v[92:95], v[236:239], v[192:195], v[92:95]
    ds_read_b64_tr_b16 v[222:223], v249 offset:10240
    v_mfma_f32_16x16x32_bf16 v[108:111], v[236:239], v[196:199], v[108:111]
    s_add_u32 s91, s91, 16384
    s_and_b32 s91, s91, 65535
    v_mfma_f32_16x16x32_bf16 v[104:107], v[232:235], v[196:199], v[104:107]
    v_mfma_f32_16x16x32_bf16 v[100:103], v[228:231], v[196:199], v[100:103]
    v_mfma_f32_16x16x32_bf16 v[96:99], v[224:227], v[196:199], v[96:99]
    v_mfma_f32_16x16x32_bf16 v[112:115], v[224:227], v[200:203], v[112:115]
    v_mfma_f32_16x16x32_bf16 v[116:119], v[228:231], v[200:203], v[116:119]
    v_mfma_f32_16x16x32_bf16 v[120:123], v[232:235], v[200:203], v[120:123]
    v_mfma_f32_16x16x32_bf16 v[124:127], v[236:239], v[200:203], v[124:127]
    v_mfma_f32_16x16x32_bf16 v[140:143], v[236:239], v[204:207], v[140:143]
    v_mfma_f32_16x16x32_bf16 v[136:139], v[232:235], v[204:207], v[136:139]
    v_mfma_f32_16x16x32_bf16 v[132:135], v[228:231], v[204:207], v[132:135]
    v_mfma_f32_16x16x32_bf16 v[128:131], v[224:227], v[204:207], v[128:131]
    s_waitcnt vmcnt(7) lgkmcnt(0)
    s_barrier
    v_mfma_f32_16x16x32_bf16 v[16:19], v[208:211], v[144:147], v[16:19]
    v_mfma_f32_16x16x32_bf16 v[20:23], v[212:215], v[144:147], v[20:23]
    v_add_u32 v247, s90, v244
    v_add_u32 v248, s91, v245
    v_add_u32 v249, s91, v246
    v_mfma_f32_16x16x32_bf16 v[24:27], v[216:219], v[144:147], v[24:27]
    ds_read_b64_tr_b16 v[224:225], v248 offset:0
    v_mfma_f32_16x16x32_bf16 v[28:31], v[220:223], v[144:147], v[28:31]
    ds_read_b64_tr_b16 v[226:227], v248 offset:2048
    v_mfma_f32_16x16x32_bf16 v[44:47], v[220:223], v[148:151], v[44:47]
    ds_read_b128 v[176:179], v247 offset:0
    v_mfma_f32_16x16x32_bf16 v[40:43], v[216:219], v[148:151], v[40:43]
    ds_read_b128 v[180:183], v247 offset:2048
    v_mfma_f32_16x16x32_bf16 v[36:39], v[212:215], v[148:151], v[36:39]
    ds_read_b128 v[184:187], v247 offset:4096
    v_mfma_f32_16x16x32_bf16 v[32:35], v[208:211], v[148:151], v[32:35]
    ds_read_b128 v[188:191], v247 offset:6144
    v_mfma_f32_16x16x32_bf16 v[48:51], v[208:211], v[152:155], v[48:51]
    ds_read_b128 v[192:195], v247 offset:8192
    v_mfma_f32_16x16x32_bf16 v[52:55], v[212:215], v[152:155], v[52:55]
    ds_read_b128 v[196:199], v247 offset:10240
    v_mfma_f32_16x16x32_bf16 v[56:59], v[216:219], v[152:155], v[56:59]
    ds_read_b128 v[200:203], v247 offset:12288
    v_mfma_f32_16x16x32_bf16 v[60:63], v[220:223], v[152:155], v[60:63]
    ds_read_b128 v[204:207], v247 offset:14336
    v_mfma_f32_16x16x32_bf16 v[76:79], v[220:223], v[156:159], v[76:79]
    ds_read_b64_tr_b16 v[228:229], v249 offset:0
    v_mfma_f32_16x16x32_bf16 v[72:75], v[216:219], v[156:159], v[72:75]
    ds_read_b64_tr_b16 v[230:231], v249 offset:2048
    v_mfma_f32_16x16x32_bf16 v[68:71], v[212:215], v[156:159], v[68:71]
    ds_read_b64_tr_b16 v[232:233], v248 offset:8192
    v_mfma_f32_16x16x32_bf16 v[64:67], v[208:211], v[156:159], v[64:67]
    ds_read_b64_tr_b16 v[234:235], v248 offset:10240
    v_mfma_f32_16x16x32_bf16 v[80:83], v[208:211], v[160:163], v[80:83]
    ds_read_b64_tr_b16 v[236:237], v249 offset:8192
    v_mfma_f32_16x16x32_bf16 v[84:87], v[212:215], v[160:163], v[84:87]
    ds_read_b64_tr_b16 v[238:239], v249 offset:10240
    v_mfma_f32_16x16x32_bf16 v[88:91], v[216:219], v[160:163], v[88:91]
    s_add_u32 s91, s91, 16384
    s_and_b32 s91, s91, 65535
    s_add_u32 s90, s90, 32768
    s_cmp_eq_u32 s90, 98304
    s_cselect_b32 s90, 0, s90
    v_mfma_f32_16x16x32_bf16 v[92:95], v[220:223], v[160:163], v[92:95]
    v_mfma_f32_16x16x32_bf16 v[108:111], v[220:223], v[164:167], v[108:111]
    v_mfma_f32_16x16x32_bf16 v[104:107], v[216:219], v[164:167], v[104:107]
    v_mfma_f32_16x16x32_bf16 v[100:103], v[212:215], v[164:167], v[100:103]
    v_mfma_f32_16x16x32_bf16 v[96:99], v[208:211], v[164:167], v[96:99]
    v_mfma_f32_16x16x32_bf16 v[112:115], v[208:211], v[168:171], v[112:115]
    v_mfma_f32_16x16x32_bf16 v[116:119], v[212:215], v[168:171], v[116:119]
    v_mfma_f32_16x16x32_bf16 v[120:123], v[216:219], v[168:171], v[120:123]
    v_mfma_f32_16x16x32_bf16 v[124:127], v[220:223], v[168:171], v[124:127]
    v_mfma_f32_16x16x32_bf16 v[140:143], v[220:223], v[172:175], v[140:143]
    v_mfma_f32_16x16x32_bf16 v[136:139], v[216:219], v[172:175], v[136:139]
    v_mfma_f32_16x16x32_bf16 v[132:135], v[212:215], v[172:175], v[132:135]
    v_mfma_f32_16x16x32_bf16 v[128:131], v[208:211], v[172:175], v[128:131]
    s_waitcnt vmcnt(0) lgkmcnt(0)
    s_barrier
    s_setprio 2
FP_chkG:
    v_cmp_ne_u32 vcc, 1, v254
    s_nop 3
    s_cbranch_vccz FP_okG
    s_sleep 8
    buffer_load_dword v254, v255, s[56:59], 0 offen sc1
    s_waitcnt vmcnt(0)
    s_branch FP_chkG
FP_okG:
    v_mfma_f32_16x16x32_bf16 v[16:19], v[224:227], v[176:179], v[16:19]
    v_mfma_f32_16x16x32_bf16 v[20:23], v[228:231], v[176:179], v[20:23]
    v_add_u32 v247, s90, v243
    v_add_u32 v248, s91, v245
    v_add_u32 v249, s91, v246
    v_mfma_f32_16x16x32_bf16 v[24:27], v[232:235], v[176:179], v[24:27]
    ds_read_b64_tr_b16 v[208:209], v248 offset:0
    v_mfma_f32_16x16x32_bf16 v[28:31], v[236:239], v[176:179], v[28:31]
    ds_read_b64_tr_b16 v[210:211], v248 offset:2048
    v_mfma_f32_16x16x32_bf16 v[44:47], v[236:239], v[180:183], v[44:47]
    ds_read_b128 v[144:147], v247 offset:0
    v_mfma_f32_16x16x32_bf16 v[40:43], v[232:235], v[180:183], v[40:43]
    ds_read_b128 v[148:151], v247 offset:2048
    v_mfma_f32_16x16x32_bf16 v[36:39], v[228:231], v[180:183], v[36:39]
    ds_read_b128 v[152:155], v247 offset:4096
    v_mfma_f32_16x16x32_bf16 v[32:35], v[224:227], v[180:183], v[32:35]
    ds_read_b128 v[156:159], v247 offset:6144
    v_mfma_f32_16x16x32_bf16 v[48:51], v[224:227], v[184:187], v[48:51]
    ds_read_b128 v[160:163], v247 offset:8192
    v_mfma_f32_16x16x32_bf16 v[52:55], v[228:231], v[184:187], v[52:55]
    ds_read_b128 v[164:167], v247 offset:10240
    v_mfma_f32_16x16x32_bf16 v[56:59], v[232:235], v[184:187], v[56:59]
    ds_read_b128 v[168:171], v247 offset:12288
    v_mfma_f32_16x16x32_bf16 v[60:63], v[236:239], v[184:187], v[60:63]
    ds_read_b128 v[172:175], v247 offset:14336
    v_mfma_f32_16x16x32_bf16 v[76:79], v[236:239], v[188:191], v[76:79]
    ds_read_b64_tr_b16 v[212:213], v249 offset:0
    v_mfma_f32_16x16x32_bf16 v[72:75], v[232:235], v[188:191], v[72:75]
    ds_read_b64_tr_b16 v[214:215], v249 offset:2048
    v_mfma_f32_16x16x32_bf16 v[68:71], v[228:231], v[188:191], v[68:71]
    ds_read_b64_tr_b16 v[216:217], v248 offset:8192
    v_mfma_f32_16x16x32_bf16 v[64:67], v[224:227], v[188:191], v[64:67]
    ds_read_b64_tr_b16 v[218:219], v248 offset:10240
    v_mfma_f32_16x16x32_bf16 v[80:83], v[224:227], v[192:195], v[80:83]
    ds_read_b64_tr_b16 v[220:221], v249 offset:8192
    v_mfma_f32_16x16x32_bf16 v[84:87], v[228:231], v[192:195], v[84:87]
    ds_read_b64_tr_b16 v[222:223], v249 offset:10240
    v_mfma_f32_16x16x32_bf16 v[88:91], v[232:235], v[192:195], v[88:91]
    s_add_u32 s91, s91, 16384
    s_and_b32 s91, s91, 65535
    v_mfma_f32_16x16x32_bf16 v[92:95], v[236:239], v[192:195], v[92:95]
    s_add_u32 m0, s73, 8896
    s_nop 0
    buffer_load_dwordx4 v4, s[52:55], s72 offen offset:0 lds
    v_mfma_f32_16x16x32_bf16 v[108:111], v[236:239], v[196:199], v[108:111]
    v_mfma_f32_16x16x32_bf16 v[104:107], v[232:235], v[196:199], v[104:107]
    buffer_load_dwordx4 v4, s[52:55], s72 offen offset:1024 lds
    v_mfma_f32_16x16x32_bf16 v[100:103], v[228:231], v[196:199], v[100:103]
    v_mfma_f32_16x16x32_bf16 v[96:99], v[224:227], v[196:199], v[96:99]
    buffer_load_dwordx4 v4, s[52:55], s72 offen offset:2048 lds
    v_mfma_f32_16x16x32_bf16 v[112:115], v[224:227], v[200:203], v[112:115]
    v_mfma_f32_16x16x32_bf16 v[116:119], v[228:231], v[200:203], v[116:119]
    buffer_load_dwordx4 v4, s[52:55], s72 offen offset:3072 lds
    v_mfma_f32_16x16x32_bf16 v[120:123], v[232:235], v[200:203], v[120:123]
    v_mfma_f32_16x16x32_bf16 v[124:127], v[236:239], v[200:203], v[124:127]
    s_add_u32 m0, s73, 8320
    s_bfm_b64 exec, 36, 0
    buffer_load_dwordx4 v7, s[52:55], s72 offen lds
    s_mov_b64 exec, -1
    v_mfma_f32_16x16x32_bf16 v[140:143], v[236:239], v[204:207], v[140:143]
    v_mfma_f32_16x16x32_bf16 v[136:139], v[232:235], v[204:207], v[136:139]
    s_add_u32 m0, s73, 13088
    s_mov_b64 exec, 0x1fffffff
    buffer_load_dwordx4 v7, s[52:55], s72 offen lds
    s_mov_b64 exec, -1
    v_mfma_f32_16x16x32_bf16 v[132:135], v[228:231], v[204:207], v[132:135]
    v_mfma_f32_16x16x32_bf16 v[128:131], v[224:227], v[204:207], v[128:131]
    s_waitcnt lgkmcnt(0)
    v_mfma_f32_16x16x32_bf16 v[16:19], v[208:211], v[144:147], v[16:19]
    v_mfma_f32_16x16x32_bf16 v[20:23], v[212:215], v[144:147], v[20:23]
    v_add_u32 v247, s90, v244
    v_add_u32 v248, s91, v245
    v_add_u32 v249, s91, v246
    v_mfma_f32_16x16x32_bf16 v[24:27], v[216:219], v[144:147], v[24:27]
    ds_read_b64_tr_b16 v[224:225], v248 offset:0
    v_mfma_f32_16x16x32_bf16 v[28:31], v[220:223], v[144:147], v[28:31]
    ds_read_b64_tr_b16 v[226:227], v248 offset:2048
    v_mfma_f32_16x16x32_bf16 v[44:47], v[220:223], v[148:151], v[44:47]
    ds_read_b128 v[176:179], v247 offset:0
    v_mfma_f32_16x16x32_bf16 v[40:43], v[216:219], v[148:151], v[40:43]
    ds_read_b128 v[180:183], v247 offset:2048
    v_mfma_f32_16x16x32_bf16 v[36:39], v[212:215], v[148:151], v[36:39]
    ds_read_b128 v[184:187], v247 offset:4096
    v_mfma_f32_16x16x32_bf16 v[32:35], v[208:211], v[148:151], v[32:35]
    ds_read_b128 v[188:191], v247 offset:6144
    v_mfma_f32_16x16x32_bf16 v[48:51], v[208:211], v[152:155], v[48:51]
    ds_read_b128 v[192:195], v247 offset:8192
    v_mfma_f32_16x16x32_bf16 v[52:55], v[212:215], v[152:155], v[52:55]
    ds_read_b128 v[196:199], v247 offset:10240
    v_mfma_f32_16x16x32_bf16 v[56:59], v[216:219], v[152:155], v[56:59]
    ds_read_b128 v[200:203], v247 offset:12288
    v_mfma_f32_16x16x32_bf16 v[60:63], v[220:223], v[152:155], v[60:63]
    ds_read_b128 v[204:207], v247 offset:14336
    v_mfma_f32_16x16x32_bf16 v[76:79], v[220:223], v[156:159], v[76:79]
    ds_read_b64_tr_b16 v[228:229], v249 offset:0
    v_mfma_f32_16x16x32_bf16 v[72:75], v[216:219], v[156:159], v[72:75]
    ds_read_b64_tr_b16 v[230:231], v249 offset:2048
    v_mfma_f32_16x16x32_bf16 v[68:71], v[212:215], v[156:159], v[68:71]
    ds_read_b64_tr_b16 v[232:233], v248 offset:8192
    v_mfma_f32_16x16x32_bf16 v[64:67], v[208:211], v[156:159], v[64:67]
    ds_read_b64_tr_b16 v[234:235], v248 offset:10240
    v_mfma_f32_16x16x32_bf16 v[80:83], v[208:211], v[160:163], v[80:83]
    ds_read_b64_tr_b16 v[236:237], v249 offset:8192
    v_mfma_f32_16x16x32_bf16 v[84:87], v[212:215], v[160:163], v[84:87]
    ds_read_b64_tr_b16 v[238:239], v249 offset:10240
    v_mfma_f32_16x16x32_bf16 v[88:91], v[216:219], v[160:163], v[88:91]
    s_add_u32 s91, s91, 16384
    s_and_b32 s91, s91, 65535
    s_add_u32 s90, s90, 32768
    s_cmp_eq_u32 s90, 98304
    s_cselect_b32 s90, 0, s90
    v_mfma_f32_16x16x32_bf16 v[92:95], v[220:223], v[160:163], v[92:95]
    s_add_u32 m0, s73, 4224
    s_nop 0
    buffer_load_dwordx4 v4, s[48:51], s72 offen offset:0 sc1 lds
    v_mfma_f32_16x16x32_bf16 v[108:111], v[220:223], v[164:167], v[108:111]
    v_mfma_f32_16x16x32_bf16 v[104:107], v[216:219], v[164:167], v[104:107]
    buffer_load_dwordx4 v4, s[48:51], s72 offen offset:1024 sc1 lds
    v_mfma_f32_16x16x32_bf16 v[100:103], v[212:215], v[164:167], v[100:103]
    v_mfma_f32_16x16x32_bf16 v[96:99], v[208:211], v[164:167], v[96:99]
    buffer_load_dwordx4 v4, s[48:51], s72 offen offset:2048 sc1 lds
    v_mfma_f32_16x16x32_bf16 v[112:115], v[208:211], v[168:171], v[112:115]
    v_mfma_f32_16x16x32_bf16 v[116:119], v[212:215], v[168:171], v[116:119]
    buffer_load_dwordx4 v4, s[48:51], s72 offen offset:3072 sc1 lds
    v_mfma_f32_16x16x32_bf16 v[120:123], v[216:219], v[168:171], v[120:123]
    v_mfma_f32_16x16x32_bf16 v[124:127], v[220:223], v[168:171], v[124:127]
    s_add_u32 m0, s73, 13540
    s_mov_b64 exec, 0x7
    buffer_load_dword v8, s[52:55], s72 offen lds
    s_mov_b64 exec, -1
    v_mfma_f32_16x16x32_bf16 v[140:143], v[220:223], v[172:175], v[140:143]
    v_mfma_f32_16x16x32_bf16 v[136:139], v[216:219], v[172:175], v[136:139]
    s_add_u32 m0, s73, 13552
    s_nop 0
    buffer_load_dwordx4 v5, s[52:55], s72 offen offset:0 lds
    v_mfma_f32_16x16x32_bf16 v[132:135], v[212:215], v[172:175], v[132:135]
    v_mfma_f32_16x16x32_bf16 v[128:131], v[208:211], v[172:175], v[128:131]
    s_waitcnt lgkmcnt(0)
    v_mfma_f32_16x16x32_bf16 v[16:19], v[224:227], v[176:179], v[16:19]
    v_mfma_f32_16x16x32_bf16 v[32:35], v[224:227], v[180:183], v[32:35]
    buffer_load_dwordx4 v5, s[52:55], s72 offen offset:1024 lds
    v_mfma_f32_16x16x32_bf16 v[48:51], v[224:227], v[184:187], v[48:51]
    v_mfma_f32_16x16x32_bf16 v[64:67], v[224:227], v[188:191], v[64:67]
    v_mfma_f32_16x16x32_bf16 v[80:83], v[224:227], v[192:195], v[80:83]
    buffer_load_dwordx4 v5, s[52:55], s72 offen offset:2048 lds
    v_mfma_f32_16x16x32_bf16 v[96:99], v[224:227], v[196:199], v[96:99]
    v_mfma_f32_16x16x32_bf16 v[112:115], v[224:227], v[200:203], v[112:115]
    v_mfma_f32_16x16x32_bf16 v[128:131], v[224:227], v[204:207], v[128:131]
    buffer_load_dwordx4 v5, s[52:55], s72 offen offset:3072 lds
    v_mfma_f32_16x16x32_bf16 v[20:23], v[228:231], v[176:179], v[20:23]
    v_mfma_f32_16x16x32_bf16 v[36:39], v[228:231], v[180:183], v[36:39]
    v_mfma_f32_16x16x32_bf16 v[52:55], v[228:231], v[184:187], v[52:55]
    s_add_u32 m0, s73, 0
    s_nop 0
    buffer_load_dwordx4 v6, s[48:51], s72 offen offset:0 sc1 lds
    v_mfma_f32_16x16x32_bf16 v[68:71], v[228:231], v[188:191], v[68:71]
    v_mfma_f32_16x16x32_bf16 v[84:87], v[228:231], v[192:195], v[84:87]
    v_mfma_f32_16x16x32_bf16 v[100:103], v[228:231], v[196:199], v[100:103]
    buffer_load_dwordx4 v6, s[48:51], s72 offen offset:1024 sc1 lds
    v_mfma_f32_16x16x32_bf16 v[116:119], v[228:231], v[200:203], v[116:119]
    v_mfma_f32_16x16x32_bf16 v[132:135], v[228:231], v[204:207], v[132:135]
    v_mfma_f32_16x16x32_bf16 v[24:27], v[232:235], v[176:179], v[24:27]
    buffer_load_dwordx4 v6, s[48:51], s72 offen offset:2048 sc1 lds
    v_mfma_f32_16x16x32_bf16 v[40:43], v[232:235], v[180:183], v[40:43]
    v_mfma_f32_16x16x32_bf16 v[56:59], v[232:235], v[184:187], v[56:59]
    v_mfma_f32_16x16x32_bf16 v[72:75], v[232:235], v[188:191], v[72:75]
    buffer_load_dwordx4 v6, s[48:51], s72 offen offset:3072 sc1 lds
    v_mfma_f32_16x16x32_bf16 v[88:91], v[232:235], v[192:195], v[88:91]
    v_mfma_f32_16x16x32_bf16 v[104:107], v[232:235], v[196:199], v[104:107]
    v_mfma_f32_16x16x32_bf16 v[120:123], v[232:235], v[200:203], v[120:123]
    s_add_u32 m0, s73, 4092
    s_mov_b64 exec, 0x1ffff
    buffer_load_ushort v9, s[48:51], s72 offen sc1 lds
    s_mov_b64 exec, -1
    v_mfma_f32_16x16x32_bf16 v[136:139], v[232:235], v[204:207], v[136:139]
    v_mfma_f32_16x16x32_bf16 v[28:31], v[236:239], v[176:179], v[28:31]
    v_mfma_f32_16x16x32_bf16 v[44:47], v[236:239], v[180:183], v[44:47]
    v_mfma_f32_16x16x32_bf16 v[60:63], v[236:239], v[184:187], v[60:63]
    v_mfma_f32_16x16x32_bf16 v[76:79], v[236:239], v[188:191], v[76:79]
    v_mfma_f32_16x16x32_bf16 v[92:95], v[236:239], v[192:195], v[92:95]
    v_mfma_f32_16x16x32_bf16 v[108:111], v[236:239], v[196:199], v[108:111]
    v_mfma_f32_16x16x32_bf16 v[124:127], v[236:239], v[200:203], v[124:127]
    v_mfma_f32_16x16x32_bf16 v[140:143], v[236:239], v[204:207], v[140:143]
    s_setprio 2
C_epi:
    v_mov_b32 v4, 0xc0135761
    v_mov_b32 v5, 0xc0135761
    v_mov_b32 v6, 0xbdd2d3e8
    v_mov_b32 v7, 0xbdd2d3e8
    v_mov_b32 v8, 1.0
    v_mov_b32 v9, 1.0
    v_pk_mul_f32 v[144:145], v[16:17], v[16:17]
    v_pk_mul_f32 v[146:147], v[18:19], v[18:19]
    v_pk_mul_f32 v[152:153], v[20:21], v[20:21]
    v_pk_mul_f32 v[154:155], v[22:23], v[22:23]
    v_pk_fma_f32 v[144:145], v[144:145], v[6:7], v[4:5]
    v_pk_fma_f32 v[146:147], v[146:147], v[6:7], v[4:5]
    v_pk_fma_f32 v[152:153], v[152:153], v[6:7], v[4:5]
    v_pk_fma_f32 v[154:155], v[154:155], v[6:7], v[4:5]
    v_pk_mul_f32 v[144:145], v[144:145], v[16:17]
    v_pk_mul_f32 v[146:147], v[146:147], v[18:19]
    v_pk_mul_f32 v[152:153], v[152:153], v[20:21]
    v_pk_mul_f32 v[154:155], v[154:155], v[22:23]
    v_exp_f32 v144, v144
    v_exp_f32 v145, v145
    v_exp_f32 v146, v146
    v_exp_f32 v147, v147
    v_exp_f32 v152, v152
    v_exp_f32 v153, v153
    v_exp_f32 v154, v154
    v_exp_f32 v155, v155
    v_pk_mul_f32 v[148:149], v[16:17], v[24:25]
    v_pk_mul_f32 v[150:151], v[18:19], v[26:27]
    v_pk_mul_f32 v[156:157], v[20:21], v[28:29]
    v_pk_mul_f32 v[158:159], v[22:23], v[30:31]
    v_pk_add_f32 v[144:145], v[144:145], v[8:9]
    v_pk_add_f32 v[146:147], v[146:147], v[8:9]
    v_pk_add_f32 v[152:153], v[152:153], v[8:9]
    v_pk_add_f32 v[154:155], v[154:155], v[8:9]
    v_rcp_f32 v144, v144
    v_rcp_f32 v145, v145
    v_rcp_f32 v146, v146
    v_rcp_f32 v147, v147
    v_rcp_f32 v152, v152
    v_rcp_f32 v153, v153
    v_rcp_f32 v154, v154
    v_rcp_f32 v155, v155
    v_pk_mul_f32 v[144:145], v[144:145], v[148:149]
    v_pk_mul_f32 v[146:147], v[146:147], v[150:151]
    v_pk_mul_f32 v[152:153], v[152:153], v[156:157]
    v_pk_mul_f32 v[154:155], v[154:155], v[158:159]
    v_cvt_pk_bf16_f32 v208, v144, v145
    v_cvt_pk_bf16_f32 v209, v146, v147
    v_cvt_pk_bf16_f32 v210, v152, v153
    v_cvt_pk_bf16_f32 v211, v154, v155
    s_mov_b32 s84, 0
    s_nop 0
    v_permlane16_swap_b32 v208, v210
    v_permlane16_swap_b32 v209, v211
    buffer_store_dwordx4 v[208:211], v10, s[44:47], s84 offen sc1
    v_add_u32 v10, v1, v10
    v_pk_mul_f32 v[160:161], v[32:33], v[32:33]
    v_pk_mul_f32 v[162:163], v[34:35], v[34:35]
    v_pk_mul_f32 v[168:169], v[36:37], v[36:37]
    v_pk_mul_f32 v[170:171], v[38:39], v[38:39]
    v_pk_fma_f32 v[160:161], v[160:161], v[6:7], v[4:5]
    v_pk_fma_f32 v[162:163], v[162:163], v[6:7], v[4:5]
    v_pk_fma_f32 v[168:169], v[168:169], v[6:7], v[4:5]
    v_pk_fma_f32 v[170:171], v[170:171], v[6:7], v[4:5]
    v_pk_mul_f32 v[160:161], v[160:161], v[32:33]
    v_pk_mul_f32 v[162:163], v[162:163], v[34:35]
    v_pk_mul_f32 v[168:169], v[168:169], v[36:37]
    v_pk_mul_f32 v[170:171], v[170:171], v[38:39]
    v_exp_f32 v160, v160
    v_exp_f32 v161, v161
    v_exp_f32 v162, v162
    v_exp_f32 v163, v163
    v_exp_f32 v168, v168
    v_exp_f32 v169, v169
    v_exp_f32 v170, v170
    v_exp_f32 v171, v171
    v_pk_mul_f32 v[164:165], v[32:33], v[40:41]
    v_pk_mul_f32 v[166:167], v[34:35], v[42:43]
    v_pk_mul_f32 v[172:173], v[36:37], v[44:45]
    v_pk_mul_f32 v[174:175], v[38:39], v[46:47]
    v_pk_add_f32 v[160:161], v[160:161], v[8:9]
    v_pk_add_f32 v[162:163], v[162:163], v[8:9]
    v_pk_add_f32 v[168:169], v[168:169], v[8:9]
    v_pk_add_f32 v[170:171], v[170:171], v[8:9]
    v_rcp_f32 v160, v160
    v_rcp_f32 v161, v161
    v_rcp_f32 v162, v162
    v_rcp_f32 v163, v163
    v_rcp_f32 v168, v168
    v_rcp_f32 v169, v169
    v_rcp_f32 v170, v170
    v_rcp_f32 v171, v171
    v_pk_mul_f32 v[160:161], v[160:161], v[164:165]
    v_pk_mul_f32 v[162:163], v[162:163], v[166:167]
    v_pk_mul_f32 v[168:169], v[168:169], v[172:173]
    v_pk_mul_f32 v[170:171], v[170:171], v[174:175]
    v_cvt_pk_bf16_f32 v212, v160, v161
    v_cvt_pk_bf16_f32 v213, v162, v163
    v_cvt_pk_bf16_f32 v214, v168, v169
    v_cvt_pk_bf16_f32 v215, v170, v171
    s_mov_b32 s84, 1024
    s_nop 0
    v_permlane16_swap_b32 v212, v214
    v_permlane16_swap_b32 v213, v215
    buffer_store_dwordx4 v[212:215], v10, s[44:47], s84 offen sc1
    v_add_u32 v10, v1, v10
    v_pk_mul_f32 v[144:145], v[48:49], v[48:49]
    v_pk_mul_f32 v[146:147], v[50:51], v[50:51]
    v_pk_mul_f32 v[152:153], v[52:53], v[52:53]
    v_pk_mul_f32 v[154:155], v[54:55], v[54:55]
    v_pk_fma_f32 v[144:145], v[144:145], v[6:7], v[4:5]
    v_pk_fma_f32 v[146:147], v[146:147], v[6:7], v[4:5]
    v_pk_fma_f32 v[152:153], v[152:153], v[6:7], v[4:5]
    v_pk_fma_f32 v[154:155], v[154:155], v[6:7], v[4:5]
    v_pk_mul_f32 v[144:145], v[144:145], v[48:49]
    v_pk_mul_f32 v[146:147], v[146:147], v[50:51]
    v_pk_mul_f32 v[152:153], v[152:153], v[52:53]
    v_pk_mul_f32 v[154:155], v[154:155], v[54:55]
    v_exp_f32 v144, v144
    v_exp_f32 v145, v145
    v_exp_f32 v146, v146
    v_exp_f32 v147, v147
    v_exp_f32 v152, v152
    v_exp_f32 v153, v153
    v_exp_f32 v154, v154
    v_exp_f32 v155, v155
    v_pk_mul_f32 v[148:149], v[48:49], v[56:57]
    v_pk_mul_f32 v[150:151], v[50:51], v[58:59]
    v_pk_mul_f32 v[156:157], v[52:53], v[60:61]
    v_pk_mul_f32 v[158:159], v[54:55], v[62:63]
    v_pk_add_f32 v[144:145], v[144:145], v[8:9]
    v_pk_add_f32 v[146:147], v[146:147], v[8:9]
    v_pk_add_f32 v[152:153], v[152:153], v[8:9]
    v_pk_add_f32 v[154:155], v[154:155], v[8:9]
    v_rcp_f32 v144, v144
    v_rcp_f32 v145, v145
    v_rcp_f32 v146, v146
    v_rcp_f32 v147, v147
    v_rcp_f32 v152, v152
    v_rcp_f32 v153, v153
    v_rcp_f32 v154, v154
    v_rcp_f32 v155, v155
    v_pk_mul_f32 v[144:145], v[144:145], v[148:149]
    v_pk_mul_f32 v[146:147], v[146:147], v[150:151]
    v_pk_mul_f32 v[152:153], v[152:153], v[156:157]
    v_pk_mul_f32 v[154:155], v[154:155], v[158:159]
    v_cvt_pk_bf16_f32 v208, v144, v145
    v_cvt_pk_bf16_f32 v209, v146, v147
    v_cvt_pk_bf16_f32 v210, v152, v153
    v_cvt_pk_bf16_f32 v211, v154, v155
    s_mov_b32 s84, 2048
    s_nop 0
    v_permlane16_swap_b32 v208, v210
    v_permlane16_swap_b32 v209, v211
    buffer_store_dwordx4 v[208:211], v10, s[44:47], s84 offen sc1
    v_add_u32 v10, v1, v10
    v_pk_mul_f32 v[160:161], v[64:65], v[64:65]
    v_pk_mul_f32 v[162:163], v[66:67], v[66:67]
    v_pk_mul_f32 v[168:169], v[68:69], v[68:69]
    v_pk_mul_f32 v[170:171], v[70:71], v[70:71]
    v_pk_fma_f32 v[160:161], v[160:161], v[6:7], v[4:5]
    v_pk_fma_f32 v[162:163], v[162:163], v[6:7], v[4:5]
    v_pk_fma_f32 v[168:169], v[168:169], v[6:7], v[4:5]
    v_pk_fma_f32 v[170:171], v[170:171], v[6:7], v[4:5]
    v_pk_mul_f32 v[160:161], v[160:161], v[64:65]
    v_pk_mul_f32 v[162:163], v[162:163], v[66:67]
    v_pk_mul_f32 v[168:169], v[168:169], v[68:69]
    v_pk_mul_f32 v[170:171], v[170:171], v[70:71]
    v_exp_f32 v160, v160
    v_exp_f32 v161, v161
    v_exp_f32 v162, v162
    v_exp_f32 v163, v163
    v_exp_f32 v168, v168
    v_exp_f32 v169, v169
    v_exp_f32 v170, v170
    v_exp_f32 v171, v171
    v_pk_mul_f32 v[164:165], v[64:65], v[72:73]
    v_pk_mul_f32 v[166:167], v[66:67], v[74:75]
    v_pk_mul_f32 v[172:173], v[68:69], v[76:77]
    v_pk_mul_f32 v[174:175], v[70:71], v[78:79]
    v_pk_add_f32 v[160:161], v[160:161], v[8:9]
    v_pk_add_f32 v[162:163], v[162:163], v[8:9]
    v_pk_add_f32 v[168:169], v[168:169], v[8:9]
    v_pk_add_f32 v[170:171], v[170:171], v[8:9]
    v_rcp_f32 v160, v160
    v_rcp_f32 v161, v161
    v_rcp_f32 v162, v162
    v_rcp_f32 v163, v163
    v_rcp_f32 v168, v168
    v_rcp_f32 v169, v169
    v_rcp_f32 v170, v170
    v_rcp_f32 v171, v171
    v_pk_mul_f32 v[160:161], v[160:161], v[164:165]
    v_pk_mul_f32 v[162:163], v[162:163], v[166:167]
    v_pk_mul_f32 v[168:169], v[168:169], v[172:173]
    v_pk_mul_f32 v[170:171], v[170:171], v[174:175]
    v_cvt_pk_bf16_f32 v212, v160, v161
    v_cvt_pk_bf16_f32 v213, v162, v163
    v_cvt_pk_bf16_f32 v214, v168, v169
    v_cvt_pk_bf16_f32 v215, v170, v171
    s_mov_b32 s84, 3072
    s_nop 0
    v_permlane16_swap_b32 v212, v214
    v_permlane16_swap_b32 v213, v215
    buffer_store_dwordx4 v[212:215], v10, s[44:47], s84 offen sc1
    s_barrier
    v_add_u32 v10, v1, v10
    v_pk_mul_f32 v[144:145], v[80:81], v[80:81]
    v_pk_mul_f32 v[146:147], v[82:83], v[82:83]
    v_pk_mul_f32 v[152:153], v[84:85], v[84:85]
    v_pk_mul_f32 v[154:155], v[86:87], v[86:87]
    v_pk_fma_f32 v[144:145], v[144:145], v[6:7], v[4:5]
    v_pk_fma_f32 v[146:147], v[146:147], v[6:7], v[4:5]
    v_pk_fma_f32 v[152:153], v[152:153], v[6:7], v[4:5]
    v_pk_fma_f32 v[154:155], v[154:155], v[6:7], v[4:5]
    v_pk_mul_f32 v[144:145], v[144:145], v[80:81]
    v_pk_mul_f32 v[146:147], v[146:147], v[82:83]
    v_pk_mul_f32 v[152:153], v[152:153], v[84:85]
    v_pk_mul_f32 v[154:155], v[154:155], v[86:87]
    v_exp_f32 v144, v144
    v_exp_f32 v145, v145
    v_exp_f32 v146, v146
    v_exp_f32 v147, v147
    v_exp_f32 v152, v152
    v_exp_f32 v153, v153
    v_exp_f32 v154, v154
    v_exp_f32 v155, v155
    v_pk_mul_f32 v[148:149], v[80:81], v[88:89]
    v_pk_mul_f32 v[150:151], v[82:83], v[90:91]
    v_pk_mul_f32 v[156:157], v[84:85], v[92:93]
    v_pk_mul_f32 v[158:159], v[86:87], v[94:95]
    v_pk_add_f32 v[144:145], v[144:145], v[8:9]
    v_pk_add_f32 v[146:147], v[146:147], v[8:9]
    v_pk_add_f32 v[152:153], v[152:153], v[8:9]
    v_pk_add_f32 v[154:155], v[154:155], v[8:9]
    v_rcp_f32 v144, v144
    v_rcp_f32 v145, v145
    v_rcp_f32 v146, v146
    v_rcp_f32 v147, v147
    v_rcp_f32 v152, v152
    v_rcp_f32 v153, v153
    v_rcp_f32 v154, v154
    v_rcp_f32 v155, v155
    v_pk_mul_f32 v[144:145], v[144:145], v[148:149]
    v_pk_mul_f32 v[146:147], v[146:147], v[150:151]
    v_pk_mul_f32 v[152:153], v[152:153], v[156:157]
    v_pk_mul_f32 v[154:155], v[154:155], v[158:159]
    v_cvt_pk_bf16_f32 v208, v144, v145
    v_cvt_pk_bf16_f32 v209, v146, v147
    v_cvt_pk_bf16_f32 v210, v152, v153
    v_cvt_pk_bf16_f32 v211, v154, v155
    s_mov_b32 s84, 4096
    s_nop 0
    v_permlane16_swap_b32 v208, v210
    v_permlane16_swap_b32 v209, v211
    buffer_store_dwordx4 v[208:211], v10, s[44:47], s84 offen sc1
    v_add_u32 v10, v1, v10
    v_pk_mul_f32 v[160:161], v[96:97], v[96:97]
    v_pk_mul_f32 v[162:163], v[98:99], v[98:99]
    v_pk_mul_f32 v[168:169], v[100:101], v[100:101]
    v_pk_mul_f32 v[170:171], v[102:103], v[102:103]
    v_pk_fma_f32 v[160:161], v[160:161], v[6:7], v[4:5]
    v_pk_fma_f32 v[162:163], v[162:163], v[6:7], v[4:5]
    v_pk_fma_f32 v[168:169], v[168:169], v[6:7], v[4:5]
    v_pk_fma_f32 v[170:171], v[170:171], v[6:7], v[4:5]
    v_pk_mul_f32 v[160:161], v[160:161], v[96:97]
    v_pk_mul_f32 v[162:163], v[162:163], v[98:99]
    v_pk_mul_f32 v[168:169], v[168:169], v[100:101]
    v_pk_mul_f32 v[170:171], v[170:171], v[102:103]
    v_exp_f32 v160, v160
    v_exp_f32 v161, v161
    v_exp_f32 v162, v162
    v_exp_f32 v163, v163
    v_exp_f32 v168, v168
    v_exp_f32 v169, v169
    v_exp_f32 v170, v170
    v_exp_f32 v171, v171
    v_pk_mul_f32 v[164:165], v[96:97], v[104:105]
    v_pk_mul_f32 v[166:167], v[98:99], v[106:107]
    v_pk_mul_f32 v[172:173], v[100:101], v[108:109]
    v_pk_mul_f32 v[174:175], v[102:103], v[110:111]
    v_pk_add_f32 v[160:161], v[160:161], v[8:9]
    v_pk_add_f32 v[162:163], v[162:163], v[8:9]
    v_pk_add_f32 v[168:169], v[168:169], v[8:9]
    v_pk_add_f32 v[170:171], v[170:171], v[8:9]
    v_rcp_f32 v160, v160
    v_rcp_f32 v161, v161
    v_rcp_f32 v162, v162
    v_rcp_f32 v163, v163
    v_rcp_f32 v168, v168
    v_rcp_f32 v169, v169
    v_rcp_f32 v170, v170
    v_rcp_f32 v171, v171
    v_pk_mul_f32 v[160:161], v[160:161], v[164:165]
    v_pk_mul_f32 v[162:163], v[162:163], v[166:167]
    v_pk_mul_f32 v[168:169], v[168:169], v[172:173]
    v_pk_mul_f32 v[170:171], v[170:171], v[174:175]
    v_cvt_pk_bf16_f32 v212, v160, v161
    v_cvt_pk_bf16_f32 v213, v162, v163
    v_cvt_pk_bf16_f32 v214, v168, v169
    v_cvt_pk_bf16_f32 v215, v170, v171
    s_mov_b32 s84, 5120
    s_nop 0
    v_permlane16_swap_b32 v212, v214
    v_permlane16_swap_b32 v213, v215
    buffer_store_dwordx4 v[212:215], v10, s[44:47], s84 offen sc1
    v_add_u32 v10, v1, v10
    v_pk_mul_f32 v[144:145], v[112:113], v[112:113]
    v_pk_mul_f32 v[146:147], v[114:115], v[114:115]
    v_pk_mul_f32 v[152:153], v[116:117], v[116:117]
    v_pk_mul_f32 v[154:155], v[118:119], v[118:119]
    v_pk_fma_f32 v[144:145], v[144:145], v[6:7], v[4:5]
    v_pk_fma_f32 v[146:147], v[146:147], v[6:7], v[4:5]
    v_pk_fma_f32 v[152:153], v[152:153], v[6:7], v[4:5]
    v_pk_fma_f32 v[154:155], v[154:155], v[6:7], v[4:5]
    v_pk_mul_f32 v[144:145], v[144:145], v[112:113]
    v_pk_mul_f32 v[146:147], v[146:147], v[114:115]
    v_pk_mul_f32 v[152:153], v[152:153], v[116:117]
    v_pk_mul_f32 v[154:155], v[154:155], v[118:119]
    v_exp_f32 v144, v144
    v_exp_f32 v145, v145
    v_exp_f32 v146, v146
    v_exp_f32 v147, v147
    v_exp_f32 v152, v152
    v_exp_f32 v153, v153
    v_exp_f32 v154, v154
    v_exp_f32 v155, v155
    v_pk_mul_f32 v[148:149], v[112:113], v[120:121]
    v_pk_mul_f32 v[150:151], v[114:115], v[122:123]
    v_pk_mul_f32 v[156:157], v[116:117], v[124:125]
    v_pk_mul_f32 v[158:159], v[118:119], v[126:127]
    v_pk_add_f32 v[144:145], v[144:145], v[8:9]
    v_pk_add_f32 v[146:147], v[146:147], v[8:9]
    v_pk_add_f32 v[152:153], v[152:153], v[8:9]
    v_pk_add_f32 v[154:155], v[154:155], v[8:9]
    v_rcp_f32 v144, v144
    v_rcp_f32 v145, v145
    v_rcp_f32 v146, v146
    v_rcp_f32 v147, v147
    v_rcp_f32 v152, v152
    v_rcp_f32 v153, v153
    v_rcp_f32 v154, v154
    v_rcp_f32 v155, v155
    v_pk_mul_f32 v[144:145], v[144:145], v[148:149]
    v_pk_mul_f32 v[146:147], v[146:147], v[150:151]
    v_pk_mul_f32 v[152:153], v[152:153], v[156:157]
    v_pk_mul_f32 v[154:155], v[154:155], v[158:159]
    v_cvt_pk_bf16_f32 v208, v144, v145
    v_cvt_pk_bf16_f32 v209, v146, v147
    v_cvt_pk_bf16_f32 v210, v152, v153
    v_cvt_pk_bf16_f32 v211, v154, v155
    s_mov_b32 s84, 6144
    s_nop 0
    v_permlane16_swap_b32 v208, v210
    v_permlane16_swap_b32 v209, v211
    buffer_store_dwordx4 v[208:211], v10, s[44:47], s84 offen sc1
    v_add_u32 v10, v1, v10
    v_pk_mul_f32 v[160:161], v[128:129], v[128:129]
    v_pk_mul_f32 v[162:163], v[130:131], v[130:131]
    v_pk_mul_f32 v[168:169], v[132:133], v[132:133]
    v_pk_mul_f32 v[170:171], v[134:135], v[134:135]
    v_pk_fma_f32 v[160:161], v[160:161], v[6:7], v[4:5]
    v_pk_fma_f32 v[162:163], v[162:163], v[6:7], v[4:5]
    v_pk_fma_f32 v[168:169], v[168:169], v[6:7], v[4:5]
    v_pk_fma_f32 v[170:171], v[170:171], v[6:7], v[4:5]
    v_pk_mul_f32 v[160:161], v[160:161], v[128:129]
    v_pk_mul_f32 v[162:163], v[162:163], v[130:131]
    v_pk_mul_f32 v[168:169], v[168:169], v[132:133]
    v_pk_mul_f32 v[170:171], v[170:171], v[134:135]
    v_exp_f32 v160, v160
    v_exp_f32 v161, v161
    v_exp_f32 v162, v162
    v_exp_f32 v163, v163
    v_exp_f32 v168, v168
    v_exp_f32 v169, v169
    v_exp_f32 v170, v170
    v_exp_f32 v171, v171
    v_pk_mul_f32 v[164:165], v[128:129], v[136:137]
    v_pk_mul_f32 v[166:167], v[130:131], v[138:139]
    v_pk_mul_f32 v[172:173], v[132:133], v[140:141]
    v_pk_mul_f32 v[174:175], v[134:135], v[142:143]
    v_pk_add_f32 v[160:161], v[160:161], v[8:9]
    v_pk_add_f32 v[162:163], v[162:163], v[8:9]
    v_pk_add_f32 v[168:169], v[168:169], v[8:9]
    v_pk_add_f32 v[170:171], v[170:171], v[8:9]
    v_rcp_f32 v160, v160
    v_rcp_f32 v161, v161
    v_rcp_f32 v162, v162
    v_rcp_f32 v163, v163
    v_rcp_f32 v168, v168
    v_rcp_f32 v169, v169
    v_rcp_f32 v170, v170
    v_rcp_f32 v171, v171
    v_pk_mul_f32 v[160:161], v[160:161], v[164:165]
    v_pk_mul_f32 v[162:163], v[162:163], v[166:167]
    v_pk_mul_f32 v[168:169], v[168:169], v[172:173]
    v_pk_mul_f32 v[170:171], v[170:171], v[174:175]
    v_cvt_pk_bf16_f32 v212, v160, v161
    v_cvt_pk_bf16_f32 v213, v162, v163
    v_cvt_pk_bf16_f32 v214, v168, v169
    v_cvt_pk_bf16_f32 v215, v170, v171
    s_mov_b32 s84, 7168
    s_nop 0
    v_permlane16_swap_b32 v212, v214
    v_permlane16_swap_b32 v213, v215
    buffer_store_dwordx4 v[212:215], v10, s[44:47], s84 offen sc1
    s_branch G2_conv
.p2align 12
.fill 36, 4, 0xbf810000
G2_conv:
    s_setprio 0
    s_add_u32 s16, s38, 33554432
    s_addc_u32 s17, s39, 0
    s_mov_b32 s18, 4194304
    s_mov_b32 s19, 0x00020000
    s_and_b32 s47, s71, 1
    s_lshl_b32 s46, s74, 16
    s_and_b32 s84, s74, 0xffff0000
    s_cmp_eq_u32 s47, 1
    s_cselect_b32 s84, s84, s46
    v_lshlrev_b32 v255, 5, v255
    s_mov_b32 s86, 425984
    s_waitcnt vmcnt(8)
    buffer_load_dword v254, v255, s[28:31], s86 offen sc1
    ds_read_b128 v[176:179], v15 offset:3584
    ds_read_b128 v[180:183], v15 offset:3072
    ds_read_b128 v[184:187], v15 offset:2560
    ds_read_b128 v[188:191], v15 offset:2048
    ds_read_b128 v[192:195], v15 offset:1536
    ds_read_b128 v[196:199], v15 offset:1024
    ds_read_b128 v[200:203], v15 offset:512
    ds_read_b128 v[204:207], v15 offset:0
    ds_read_b128 v[80:83], v14 offset:0
    ds_read_b64 v[48:49], v3 offset:3584
    ds_read_b64 v[50:51], v3 offset:3592
    ds_read_b128 v[84:87], v14 offset:512
    ds_read_b64 v[52:53], v3 offset:3072
    ds_read_b64 v[54:55], v3 offset:3080
    ds_read_b128 v[88:91], v14 offset:1024
    ds_read_b64 v[56:57], v3 offset:2560
    ds_read_b64 v[58:59], v3 offset:2568
    ds_read_b128 v[92:95], v14 offset:1536
    ds_read_b64 v[60:61], v3 offset:2048
    ds_read_b64 v[62:63], v3 offset:2056
    ds_read_b128 v[96:99], v14 offset:2048
    ds_read_b64 v[64:65], v3 offset:1536
    ds_read_b64 v[66:67], v3 offset:1544
    ds_read_b128 v[100:103], v14 offset:2560
    ds_read_b64 v[68:69], v3 offset:1024
    ds_read_b64 v[70:71], v3 offset:1032
    ds_read_b128 v[104:107], v14 offset:3072
    ds_read_b64 v[72:73], v3 offset:512
    ds_read_b64 v[74:75], v3 offset:520
    ds_read_b128 v[108:111], v14 offset:3584
    ds_read_b64 v[76:77], v3 offset:0
    ds_read_b64 v[78:79], v3 offset:8
    v_mov_b32 v4, v250
    v_mov_b32 v5, v251
    v_mov_b32 v6, v252
    v_mov_b32 v7, v253
    s_waitcnt lgkmcnt(15)
    v_cndmask_b32 v176, v177, v176, s[80:81]
    v_cndmask_b32 v177, v179, v178, s[80:81]
    v_and_b32 v18, 0xffff0000, v176
    v_lshlrev_b32 v19, 16, v176
    v_and_b32 v16, 0xffff0000, v177
    v_lshlrev_b32 v17, 16, v177
    v_mul_f32 v18, s84, v18
    v_mul_f32 v19, s84, v19
    v_mul_f32 v16, s84, v16
    v_mul_f32 v17, s84, v17
    v_cndmask_b32 v180, v181, v180, s[80:81]
    v_cndmask_b32 v181, v183, v182, s[80:81]
    v_and_b32 v22, 0xffff0000, v180
    v_lshlrev_b32 v23, 16, v180
    v_and_b32 v20, 0xffff0000, v181
    v_lshlrev_b32 v21, 16, v181
    v_mul_f32 v22, s84, v22
    v_mul_f32 v23, s84, v23
    v_mul_f32 v20, s84, v20
    v_mul_f32 v21, s84, v21
    v_cndmask_b32 v184, v185, v184, s[80:81]
    v_cndmask_b32 v185, v187, v186, s[80:81]
    v_and_b32 v26, 0xffff0000, v184
    v_lshlrev_b32 v27, 16, v184
    v_and_b32 v24, 0xffff0000, v185
    v_lshlrev_b32 v25, 16, v185
    v_mul_f32 v26, s84, v26
    v_mul_f32 v27, s84, v27
    v_mul_f32 v24, s84, v24
    v_mul_f32 v25, s84, v25
    s_waitcnt lgkmcnt(15)
    v_mfma_f32_16x16x32_bf16 v[16:19], v[48:51], v[80:83], v[16:19]
    v_cndmask_b32 v188, v189, v188, s[80:81]
    v_cndmask_b32 v189, v191, v190, s[80:81]
    v_and_b32 v30, 0xffff0000, v188
    s_waitcnt lgkmcnt(15)
    v_mfma_f32_16x16x32_bf16 v[20:23], v[52:55], v[80:83], v[20:23]
    v_lshlrev_b32 v31, 16, v188
    v_and_b32 v28, 0xffff0000, v189
    v_lshlrev_b32 v29, 16, v189
    v_mfma_f32_16x16x32_bf16 v[24:27], v[52:55], v[84:87], v[24:27]
    v_mul_f32 v30, s84, v30
    v_mul_f32 v31, s84, v31
    v_mul_f32 v28, s84, v28
    v_mfma_f32_16x16x32_bf16 v[20:23], v[48:51], v[84:87], v[20:23]
    v_mul_f32 v29, s84, v29
    v_cndmask_b32 v192, v193, v192, s[80:81]
    v_cndmask_b32 v193, v195, v194, s[80:81]
    s_waitcnt lgkmcnt(15)
    v_mfma_f32_16x16x32_bf16 v[24:27], v[48:51], v[88:91], v[24:27]
    v_and_b32 v34, 0xffff0000, v192
    v_lshlrev_b32 v35, 16, v192
    v_and_b32 v32, 0xffff0000, v193
    v_mfma_f32_16x16x32_bf16 v[28:31], v[52:55], v[88:91], v[28:31]
    v_lshlrev_b32 v33, 16, v193
    v_mul_f32 v34, s84, v34
    v_mul_f32 v35, s84, v35
    v_mul_f32 v32, s84, v32
    v_mul_f32 v33, s84, v33
    s_nop 1
    v_mfma_f32_16x16x32_bf16 v[32:35], v[56:59], v[88:91], v[32:35]
    v_cndmask_b32 v196, v197, v196, s[80:81]
    v_cndmask_b32 v197, v199, v198, s[80:81]
    v_and_b32 v38, 0xffff0000, v196
    v_mfma_f32_16x16x32_bf16 v[28:31], v[56:59], v[84:87], v[28:31]
    v_lshlrev_b32 v39, 16, v196
    v_and_b32 v36, 0xffff0000, v197
    v_lshlrev_b32 v37, 16, v197
    v_mfma_f32_16x16x32_bf16 v[24:27], v[56:59], v[80:83], v[24:27]
    v_mul_f32 v38, s84, v38
    v_mul_f32 v39, s84, v39
    v_mul_f32 v36, s84, v36
    s_waitcnt lgkmcnt(12)
    v_mfma_f32_16x16x32_bf16 v[28:31], v[60:63], v[80:83], v[28:31]
    v_mul_f32 v37, s84, v37
    v_cndmask_b32 v200, v201, v200, s[80:81]
    v_cndmask_b32 v201, v203, v202, s[80:81]
    ds_read_b128 v[144:147], v14 offset:64
    v_mfma_f32_16x16x32_bf16 v[32:35], v[60:63], v[84:87], v[32:35]
    v_and_b32 v42, 0xffff0000, v200
    v_lshlrev_b32 v43, 16, v200
    v_and_b32 v40, 0xffff0000, v201
    ds_read_b64 v[112:113], v3 offset:3648
    v_mfma_f32_16x16x32_bf16 v[36:39], v[60:63], v[88:91], v[36:39]
    v_lshlrev_b32 v41, 16, v201
    v_mul_f32 v42, s84, v42
    v_mul_f32 v43, s84, v43
    ds_read_b64 v[114:115], v3 offset:3656
    v_mul_f32 v40, s84, v40
    v_mul_f32 v41, s84, v41
    s_nop 1
    v_mfma_f32_16x16x32_bf16 v[40:43], v[60:63], v[92:95], v[40:43]
    v_cndmask_b32 v204, v205, v204, s[80:81]
    v_cndmask_b32 v205, v207, v206, s[80:81]
    v_and_b32 v46, 0xffff0000, v204
    ds_read_b128 v[148:151], v14 offset:576
    v_mfma_f32_16x16x32_bf16 v[36:39], v[56:59], v[92:95], v[36:39]
    v_lshlrev_b32 v47, 16, v204
    v_and_b32 v44, 0xffff0000, v205
    v_lshlrev_b32 v45, 16, v205
    ds_read_b64 v[116:117], v3 offset:3136
    v_mfma_f32_16x16x32_bf16 v[32:35], v[52:55], v[92:95], v[32:35]
    v_mul_f32 v46, s84, v46
    v_mul_f32 v47, s84, v47
    v_mul_f32 v44, s84, v44
    ds_read_b64 v[118:119], v3 offset:3144
    v_mfma_f32_16x16x32_bf16 v[28:31], v[48:51], v[92:95], v[28:31]
    v_mul_f32 v45, s84, v45
    ds_read_b128 v[152:155], v14 offset:1088
    s_waitcnt lgkmcnt(15)
    v_mfma_f32_16x16x32_bf16 v[32:35], v[48:51], v[96:99], v[32:35]
    ds_read_b64 v[120:121], v3 offset:2624
    v_mfma_f32_16x16x32_bf16 v[36:39], v[52:55], v[96:99], v[36:39]
    ds_read_b64 v[122:123], v3 offset:2632
    v_mfma_f32_16x16x32_bf16 v[40:43], v[56:59], v[96:99], v[40:43]
    ds_read_b128 v[156:159], v14 offset:1600
    v_mfma_f32_16x16x32_bf16 v[44:47], v[60:63], v[96:99], v[44:47]
    ds_read_b64 v[124:125], v3 offset:2112
    v_mfma_f32_16x16x32_bf16 v[44:47], v[64:67], v[92:95], v[44:47]
    ds_read_b64 v[126:127], v3 offset:2120
    v_mfma_f32_16x16x32_bf16 v[40:43], v[64:67], v[88:91], v[40:43]
    ds_read_b128 v[160:163], v14 offset:2112
    v_mfma_f32_16x16x32_bf16 v[36:39], v[64:67], v[84:87], v[36:39]
    s_mov_b32 s20, s64
    s_mov_b32 s21, s65
    ds_read_b64 v[128:129], v3 offset:1600
    v_mfma_f32_16x16x32_bf16 v[32:35], v[64:67], v[80:83], v[32:35]
    s_mov_b32 s22, 4194304
    s_mov_b32 s23, 0x00020000
    ds_read_b64 v[130:131], v3 offset:1608
    s_waitcnt lgkmcnt(15)
    v_mfma_f32_16x16x32_bf16 v[36:39], v[68:71], v[80:83], v[36:39]
    s_lshl_b32 s35, s69, 11
    s_lshl_b32 s34, s68, 7
    ds_read_b128 v[164:167], v14 offset:2624
    v_mfma_f32_16x16x32_bf16 v[40:43], v[68:71], v[84:87], v[40:43]
    s_add_u32 s34, s34, s35
    s_add_u32 s60, s38, 75497472
    ds_read_b64 v[132:133], v3 offset:1088
    v_mfma_f32_16x16x32_bf16 v[44:47], v[68:71], v[88:91], v[44:47]
    s_addc_u32 s61, s39, 0
    s_mov_b32 s62, 8388608
    ds_read_b64 v[134:135], v3 offset:1096
    v_mfma_f32_16x16x32_bf16 v[44:47], v[56:59], v[100:103], v[44:47]
    s_mov_b32 s63, 0x00020000
    s_lshl_b32 s43, s2, 2
    ds_read_b128 v[168:171], v14 offset:3136
    v_mfma_f32_16x16x32_bf16 v[40:43], v[52:55], v[100:103], v[40:43]
    s_add_u32 s43, s43, s70
    s_lshl_b32 s36, s43, 7
    ds_read_b64 v[136:137], v3 offset:576
    v_mfma_f32_16x16x32_bf16 v[36:39], v[48:51], v[100:103], v[36:39]
    s_add_u32 s36, s36, 294912
    s_lshl_b32 s37, s43, 12
    ds_read_b64 v[138:139], v3 offset:584
    s_waitcnt lgkmcnt(15)
    v_mfma_f32_16x16x32_bf16 v[40:43], v[48:51], v[104:107], v[40:43]
    v_lshlrev_b32 v13, 4, v2
    s_lshl_b32 s47, s70, 13
    ds_read_b128 v[172:175], v14 offset:3648
    v_mfma_f32_16x16x32_bf16 v[44:47], v[52:55], v[104:107], v[44:47]
    s_add_u32 s47, s47, 73728
    v_add_u32 v9, s47, v13
    ds_read_b64 v[140:141], v3 offset:64
    v_mfma_f32_16x16x32_bf16 v[44:47], v[72:75], v[84:87], v[44:47]
    s_lshl_b32 s47, s70, 12
    s_add_u32 s47, s47, 57344
    ds_read_b64 v[142:143], v3 offset:72
    v_mfma_f32_16x16x32_bf16 v[40:43], v[72:75], v[80:83], v[40:43]
    v_add_u32 v253, s47, v13
    v_and_b32 v8, 15, v2
    s_waitcnt lgkmcnt(15)
    v_mfma_f32_16x16x32_bf16 v[44:47], v[76:79], v[80:83], v[44:47]
    v_lshrrev_b32 v10, 4, v2
    v_lshlrev_b32 v10, 2, v10
    v_add_u32 v14, 64, v14
    v_add_u32 v3, 64, v3
    v_mfma_f32_16x16x32_bf16 v[44:47], v[48:51], v[108:111], v[44:47]
    v_sub_u32 v8, v8, v10
    v_and_b32 v10, 1, v8
    s_waitcnt lgkmcnt(15)
    v_mfma_f32_16x16x32_bf16 v[16:19], v[112:115], v[144:147], v[16:19]
    v_lshlrev_b32 v10, 4, v10
    v_mov_b32 v250, 0x3f80
    s_waitcnt lgkmcnt(15)
    v_mfma_f32_16x16x32_bf16 v[20:23], v[116:119], v[144:147], v[20:23]
    v_lshlrev_b32 v10, v10, v250
    v_lshrrev_b32 v8, 1, v8
    v_mfma_f32_16x16x32_bf16 v[24:27], v[116:119], v[148:151], v[24:27]
    v_cmp_eq_u32 s[46:47], 0, v8
    v_mov_b32 v210, 0
    v_mfma_f32_16x16x32_bf16 v[20:23], v[112:115], v[148:151], v[20:23]
    v_mov_b32 v211, 0
    v_cndmask_b32 v208, v12, v10, s[46:47]
    s_waitcnt vmcnt(0)
    s_cmp_ge_u32 s2, 224
    s_cbranch_scc1 FH_nopubC
    s_mov_b64 exec, 1
    buffer_store_dword v11, v12, s[28:31], s79 offen sc1
    s_mov_b64 exec, -1
FH_nopubC:
FP_chkC:
    v_cmp_ne_u32 vcc, 1, v254
    s_nop 3
    s_cbranch_vccz FP_okC
    s_sleep 8
    buffer_load_dword v254, v255, s[28:31], s86 offen sc1
    s_waitcnt vmcnt(0)
    s_branch FP_chkC
FP_okC:
    s_waitcnt lgkmcnt(15)
    v_mfma_f32_16x16x32_bf16 v[24:27], v[112:115], v[152:155], v[24:27]
    v_cndmask_b32 v214, v12, v10, s[46:47]
    v_cmp_eq_u32 s[46:47], 1, v8
    v_mfma_f32_16x16x32_bf16 v[28:31], v[116:119], v[152:155], v[28:31]
    v_mov_b32 v212, 0
    v_mov_b32 v213, 0
    v_mfma_f32_16x16x32_bf16 v[32:35], v[120:123], v[152:155], v[32:35]
    v_cndmask_b32 v209, v12, v10, s[46:47]
    v_cndmask_b32 v215, v12, v10, s[46:47]
    v_mfma_f32_16x16x32_bf16 v[28:31], v[120:123], v[148:151], v[28:31]
    s_add_u32 s24, s38, 41943040
    s_addc_u32 s25, s39, 0
    v_mfma_f32_16x16x32_bf16 v[24:27], v[120:123], v[144:147], v[24:27]
    s_mov_b32 s26, 8192
    s_mov_b32 s27, 0x00020000
    s_waitcnt lgkmcnt(12)
    v_mfma_f32_16x16x32_bf16 v[28:31], v[124:127], v[144:147], v[28:31]
    v_and_b32 v10, 15, v2
    s_lshl_b32 s46, s75, 6
    ds_read_b128 v[80:83], v14 offset:64
    v_mfma_f32_16x16x32_bf16 v[32:35], v[124:127], v[148:151], v[32:35]
    s_lshl_b32 s47, s68, 7
    s_add_u32 s46, s46, s47
    ds_read_b64 v[48:49], v3 offset:3648
    v_mfma_f32_16x16x32_bf16 v[36:39], v[124:127], v[152:155], v[36:39]
    v_add_u32 v10, s46, v10
    v_lshlrev_b32 v249, 2, v10
    ds_read_b64 v[50:51], v3 offset:3656
    v_mfma_f32_16x16x32_bf16 v[40:43], v[124:127], v[156:159], v[40:43]
    v_lshlrev_b32 v10, 11, v10
    s_lshl_b32 s46, s76, 5
    ds_read_b128 v[84:87], v14 offset:576
    v_mfma_f32_16x16x32_bf16 v[36:39], v[120:123], v[156:159], v[36:39]
    s_lshl_b32 s47, s69, 6
    s_add_u32 s46, s46, s47
    ds_read_b64 v[52:53], v3 offset:3136
    v_mfma_f32_16x16x32_bf16 v[32:35], v[116:119], v[156:159], v[32:35]
    s_lshl_b32 s46, s46, 1
    v_add_u32 v10, s46, v10
    ds_read_b64 v[54:55], v3 offset:3144
    v_mfma_f32_16x16x32_bf16 v[28:31], v[112:115], v[156:159], v[28:31]
    v_lshrrev_b32 v250, 4, v2
    v_and_b32 v8, 1, v250
    ds_read_b128 v[88:91], v14 offset:1088
    s_waitcnt lgkmcnt(15)
    v_mfma_f32_16x16x32_bf16 v[32:35], v[112:115], v[160:163], v[32:35]
    v_lshlrev_b32 v8, 5, v8
    v_lshrrev_b32 v251, 1, v250
    ds_read_b64 v[56:57], v3 offset:2624
    v_mfma_f32_16x16x32_bf16 v[36:39], v[116:119], v[160:163], v[36:39]
    v_lshlrev_b32 v251, 4, v251
    v_add3_u32 v252, v10, v8, v251
    ds_read_b64 v[58:59], v3 offset:2632
    v_mfma_f32_16x16x32_bf16 v[40:43], v[120:123], v[160:163], v[40:43]
    buffer_load_dword v240, v249, s[24:27], 0 offen offset:0 sc1
    buffer_load_dword v242, v249, s[24:27], 0 offen offset:64 sc1
    ds_read_b128 v[92:95], v14 offset:1600
    v_mfma_f32_16x16x32_bf16 v[44:47], v[124:127], v[160:163], v[44:47]
    buffer_load_dword v244, v249, s[24:27], 0 offen offset:128 sc1
    buffer_load_dword v246, v249, s[24:27], 0 offen offset:192 sc1
    ds_read_b64 v[60:61], v3 offset:2112
    v_mfma_f32_16x16x32_bf16 v[44:47], v[128:131], v[156:159], v[44:47]
    ds_read_b64 v[62:63], v3 offset:2120
    v_mfma_f32_16x16x32_bf16 v[40:43], v[128:131], v[152:155], v[40:43]
    ds_read_b128 v[96:99], v14 offset:2112
    v_mfma_f32_16x16x32_bf16 v[36:39], v[128:131], v[148:151], v[36:39]
    ds_read_b64 v[64:65], v3 offset:1600
    v_mfma_f32_16x16x32_bf16 v[32:35], v[128:131], v[144:147], v[32:35]
    ds_read_b64 v[66:67], v3 offset:1608
    s_waitcnt lgkmcnt(15)
    v_mfma_f32_16x16x32_bf16 v[36:39], v[132:135], v[144:147], v[36:39]
    ds_read_b128 v[100:103], v14 offset:2624
    v_mfma_f32_16x16x32_bf16 v[40:43], v[132:135], v[148:151], v[40:43]
    ds_read_b64 v[68:69], v3 offset:1088
    v_mfma_f32_16x16x32_bf16 v[44:47], v[132:135], v[152:155], v[44:47]
    ds_read_b64 v[70:71], v3 offset:1096
    v_mfma_f32_16x16x32_bf16 v[44:47], v[120:123], v[164:167], v[44:47]
    ds_read_b128 v[104:107], v14 offset:3136
    v_mfma_f32_16x16x32_bf16 v[40:43], v[116:119], v[164:167], v[40:43]
    ds_read_b64 v[72:73], v3 offset:576
    v_mfma_f32_16x16x32_bf16 v[36:39], v[112:115], v[164:167], v[36:39]
    ds_read_b64 v[74:75], v3 offset:584
    s_waitcnt lgkmcnt(15)
    v_mfma_f32_16x16x32_bf16 v[40:43], v[112:115], v[168:171], v[40:43]
    ds_read_b128 v[108:111], v14 offset:3648
    v_mfma_f32_16x16x32_bf16 v[44:47], v[116:119], v[168:171], v[44:47]
    ds_read_b64 v[76:77], v3 offset:64
    v_mfma_f32_16x16x32_bf16 v[44:47], v[136:139], v[148:151], v[44:47]
    ds_read_b64 v[78:79], v3 offset:72
    v_mfma_f32_16x16x32_bf16 v[40:43], v[136:139], v[144:147], v[40:43]
    s_waitcnt lgkmcnt(15)
    v_mfma_f32_16x16x32_bf16 v[44:47], v[140:143], v[144:147], v[44:47]
    v_add_u32 v14, 64, v14
    v_add_u32 v3, 64, v3
    v_mfma_f32_16x16x32_bf16 v[44:47], v[112:115], v[172:175], v[44:47]
    s_mov_b32 s88, 3
LOOP_122:
    s_waitcnt lgkmcnt(15)
    v_mfma_f32_16x16x32_bf16 v[16:19], v[48:51], v[80:83], v[16:19]
    s_waitcnt lgkmcnt(15)
    v_mfma_f32_16x16x32_bf16 v[20:23], v[52:55], v[80:83], v[20:23]
    v_mfma_f32_16x16x32_bf16 v[24:27], v[52:55], v[84:87], v[24:27]
    v_mfma_f32_16x16x32_bf16 v[20:23], v[48:51], v[84:87], v[20:23]
    s_waitcnt lgkmcnt(15)
    v_mfma_f32_16x16x32_bf16 v[24:27], v[48:51], v[88:91], v[24:27]
    v_mfma_f32_16x16x32_bf16 v[28:31], v[52:55], v[88:91], v[28:31]
    v_mfma_f32_16x16x32_bf16 v[32:35], v[56:59], v[88:91], v[32:35]
    v_mfma_f32_16x16x32_bf16 v[28:31], v[56:59], v[84:87], v[28:31]
    v_mfma_f32_16x16x32_bf16 v[24:27], v[56:59], v[80:83], v[24:27]
    s_waitcnt lgkmcnt(12)
    v_mfma_f32_16x16x32_bf16 v[28:31], v[60:63], v[80:83], v[28:31]
    ds_read_b128 v[144:147], v14 offset:64
    v_mfma_f32_16x16x32_bf16 v[32:35], v[60:63], v[84:87], v[32:35]
    ds_read_b64 v[112:113], v3 offset:3648
    v_mfma_f32_16x16x32_bf16 v[36:39], v[60:63], v[88:91], v[36:39]
    ds_read_b64 v[114:115], v3 offset:3656
    v_mfma_f32_16x16x32_bf16 v[40:43], v[60:63], v[92:95], v[40:43]
    ds_read_b128 v[148:151], v14 offset:576
    v_mfma_f32_16x16x32_bf16 v[36:39], v[56:59], v[92:95], v[36:39]
    ds_read_b64 v[116:117], v3 offset:3136
    v_mfma_f32_16x16x32_bf16 v[32:35], v[52:55], v[92:95], v[32:35]
    ds_read_b64 v[118:119], v3 offset:3144
    v_mfma_f32_16x16x32_bf16 v[28:31], v[48:51], v[92:95], v[28:31]
    ds_read_b128 v[152:155], v14 offset:1088
    s_waitcnt lgkmcnt(15)
    v_mfma_f32_16x16x32_bf16 v[32:35], v[48:51], v[96:99], v[32:35]
    ds_read_b64 v[120:121], v3 offset:2624
    v_mfma_f32_16x16x32_bf16 v[36:39], v[52:55], v[96:99], v[36:39]
    ds_read_b64 v[122:123], v3 offset:2632
    v_mfma_f32_16x16x32_bf16 v[40:43], v[56:59], v[96:99], v[40:43]
    ds_read_b128 v[156:159], v14 offset:1600
    v_mfma_f32_16x16x32_bf16 v[44:47], v[60:63], v[96:99], v[44:47]
    ds_read_b64 v[124:125], v3 offset:2112
    v_mfma_f32_16x16x32_bf16 v[44:47], v[64:67], v[92:95], v[44:47]
    ds_read_b64 v[126:127], v3 offset:2120
    v_mfma_f32_16x16x32_bf16 v[40:43], v[64:67], v[88:91], v[40:43]
    ds_read_b128 v[160:163], v14 offset:2112
    v_mfma_f32_16x16x32_bf16 v[36:39], v[64:67], v[84:87], v[36:39]
    ds_read_b64 v[128:129], v3 offset:1600
    v_mfma_f32_16x16x32_bf16 v[32:35], v[64:67], v[80:83], v[32:35]
    ds_read_b64 v[130:131], v3 offset:1608
    s_waitcnt lgkmcnt(15)
    v_mfma_f32_16x16x32_bf16 v[36:39], v[68:71], v[80:83], v[36:39]
    ds_read_b128 v[164:167], v14 offset:2624
    v_mfma_f32_16x16x32_bf16 v[40:43], v[68:71], v[84:87], v[40:43]
    ds_read_b64 v[132:133], v3 offset:1088
    v_mfma_f32_16x16x32_bf16 v[44:47], v[68:71], v[88:91], v[44:47]
    ds_read_b64 v[134:135], v3 offset:1096
    v_mfma_f32_16x16x32_bf16 v[44:47], v[56:59], v[100:103], v[44:47]
    ds_read_b128 v[168:171], v14 offset:3136
    v_mfma_f32_16x16x32_bf16 v[40:43], v[52:55], v[100:103], v[40:43]
    ds_read_b64 v[136:137], v3 offset:576
    v_mfma_f32_16x16x32_bf16 v[36:39], v[48:51], v[100:103], v[36:39]
    ds_read_b64 v[138:139], v3 offset:584
    s_waitcnt lgkmcnt(15)
    v_mfma_f32_16x16x32_bf16 v[40:43], v[48:51], v[104:107], v[40:43]
    ds_read_b128 v[172:175], v14 offset:3648
    v_mfma_f32_16x16x32_bf16 v[44:47], v[52:55], v[104:107], v[44:47]
    ds_read_b64 v[140:141], v3 offset:64
    v_mfma_f32_16x16x32_bf16 v[44:47], v[72:75], v[84:87], v[44:47]
    ds_read_b64 v[142:143], v3 offset:72
    v_mfma_f32_16x16x32_bf16 v[40:43], v[72:75], v[80:83], v[40:43]
    s_waitcnt lgkmcnt(15)
    v_mfma_f32_16x16x32_bf16 v[44:47], v[76:79], v[80:83], v[44:47]
    v_add_u32 v14, 64, v14
    v_add_u32 v3, 64, v3
    v_mfma_f32_16x16x32_bf16 v[44:47], v[48:51], v[108:111], v[44:47]
    s_waitcnt lgkmcnt(15)
    v_mfma_f32_16x16x32_bf16 v[16:19], v[112:115], v[144:147], v[16:19]
    s_waitcnt lgkmcnt(15)
    v_mfma_f32_16x16x32_bf16 v[20:23], v[116:119], v[144:147], v[20:23]
    v_mfma_f32_16x16x32_bf16 v[24:27], v[116:119], v[148:151], v[24:27]
    v_mfma_f32_16x16x32_bf16 v[20:23], v[112:115], v[148:151], v[20:23]
    s_waitcnt lgkmcnt(15)
    v_mfma_f32_16x16x32_bf16 v[24:27], v[112:115], v[152:155], v[24:27]
    v_mfma_f32_16x16x32_bf16 v[28:31], v[116:119], v[152:155], v[28:31]
    v_mfma_f32_16x16x32_bf16 v[32:35], v[120:123], v[152:155], v[32:35]
    v_mfma_f32_16x16x32_bf16 v[28:31], v[120:123], v[148:151], v[28:31]
    v_mfma_f32_16x16x32_bf16 v[24:27], v[120:123], v[144:147], v[24:27]
    s_waitcnt lgkmcnt(12)
    v_mfma_f32_16x16x32_bf16 v[28:31], v[124:127], v[144:147], v[28:31]
    ds_read_b128 v[80:83], v14 offset:64
    v_mfma_f32_16x16x32_bf16 v[32:35], v[124:127], v[148:151], v[32:35]
    ds_read_b64 v[48:49], v3 offset:3648
    v_mfma_f32_16x16x32_bf16 v[36:39], v[124:127], v[152:155], v[36:39]
    ds_read_b64 v[50:51], v3 offset:3656
    v_mfma_f32_16x16x32_bf16 v[40:43], v[124:127], v[156:159], v[40:43]
    ds_read_b128 v[84:87], v14 offset:576
    v_mfma_f32_16x16x32_bf16 v[36:39], v[120:123], v[156:159], v[36:39]
    ds_read_b64 v[52:53], v3 offset:3136
    v_mfma_f32_16x16x32_bf16 v[32:35], v[116:119], v[156:159], v[32:35]
    ds_read_b64 v[54:55], v3 offset:3144
    v_mfma_f32_16x16x32_bf16 v[28:31], v[112:115], v[156:159], v[28:31]
    ds_read_b128 v[88:91], v14 offset:1088
    s_waitcnt lgkmcnt(15)
    v_mfma_f32_16x16x32_bf16 v[32:35], v[112:115], v[160:163], v[32:35]
    ds_read_b64 v[56:57], v3 offset:2624
    v_mfma_f32_16x16x32_bf16 v[36:39], v[116:119], v[160:163], v[36:39]
    ds_read_b64 v[58:59], v3 offset:2632
    v_mfma_f32_16x16x32_bf16 v[40:43], v[120:123], v[160:163], v[40:43]
    ds_read_b128 v[92:95], v14 offset:1600
    v_mfma_f32_16x16x32_bf16 v[44:47], v[124:127], v[160:163], v[44:47]
    ds_read_b64 v[60:61], v3 offset:2112
    v_mfma_f32_16x16x32_bf16 v[44:47], v[128:131], v[156:159], v[44:47]
    ds_read_b64 v[62:63], v3 offset:2120
    v_mfma_f32_16x16x32_bf16 v[40:43], v[128:131], v[152:155], v[40:43]
    ds_read_b128 v[96:99], v14 offset:2112
    v_mfma_f32_16x16x32_bf16 v[36:39], v[128:131], v[148:151], v[36:39]
    ds_read_b64 v[64:65], v3 offset:1600
    v_mfma_f32_16x16x32_bf16 v[32:35], v[128:131], v[144:147], v[32:35]
    ds_read_b64 v[66:67], v3 offset:1608
    s_waitcnt lgkmcnt(15)
    v_mfma_f32_16x16x32_bf16 v[36:39], v[132:135], v[144:147], v[36:39]
    ds_read_b128 v[100:103], v14 offset:2624
    v_mfma_f32_16x16x32_bf16 v[40:43], v[132:135], v[148:151], v[40:43]
    ds_read_b64 v[68:69], v3 offset:1088
    v_mfma_f32_16x16x32_bf16 v[44:47], v[132:135], v[152:155], v[44:47]
    ds_read_b64 v[70:71], v3 offset:1096
    v_mfma_f32_16x16x32_bf16 v[44:47], v[120:123], v[164:167], v[44:47]
    ds_read_b128 v[104:107], v14 offset:3136
    v_mfma_f32_16x16x32_bf16 v[40:43], v[116:119], v[164:167], v[40:43]
    ds_read_b64 v[72:73], v3 offset:576
    v_mfma_f32_16x16x32_bf16 v[36:39], v[112:115], v[164:167], v[36:39]
    ds_read_b64 v[74:75], v3 offset:584
    s_waitcnt lgkmcnt(15)
    v_mfma_f32_16x16x32_bf16 v[40:43], v[112:115], v[168:171], v[40:43]
    ds_read_b128 v[108:111], v14 offset:3648
    v_mfma_f32_16x16x32_bf16 v[44:47], v[116:119], v[168:171], v[44:47]
    ds_read_b64 v[76:77], v3 offset:64
    v_mfma_f32_16x16x32_bf16 v[44:47], v[136:139], v[148:151], v[44:47]
    ds_read_b64 v[78:79], v3 offset:72
    v_mfma_f32_16x16x32_bf16 v[40:43], v[136:139], v[144:147], v[40:43]
    s_waitcnt lgkmcnt(15)
    v_mfma_f32_16x16x32_bf16 v[44:47], v[140:143], v[144:147], v[44:47]
    v_add_u32 v14, 64, v14
    v_add_u32 v3, 64, v3
    v_mfma_f32_16x16x32_bf16 v[44:47], v[112:115], v[172:175], v[44:47]
    s_sub_u32 s88, s88, 1
    s_cmp_lg_u32 s88, 0
    s_cbranch_scc1 LOOP_122
    s_nop 7
    v_cvt_pk_bf16_f32 v112, v16, v17
    v_cvt_pk_bf16_f32 v113, v18, v19
    v_cvt_pk_bf16_f32 v114, v20, v21
    v_cvt_pk_bf16_f32 v115, v22, v23
    v_cndmask_b32 v116, v114, v112, s[80:81]
    v_cndmask_b32 v117, v115, v113, s[80:81]
    v_cndmask_b32 v118, v112, v114, s[80:81]
    v_cndmask_b32 v119, v113, v115, s[80:81]
    s_nop 0
    v_mov_b32_dpp v120, v116 quad_perm:[1,0,3,2] row_mask:0xf bank_mask:0xf
    v_mov_b32_dpp v121, v117 quad_perm:[1,0,3,2] row_mask:0xf bank_mask:0xf
    v_cndmask_b32 v124, v118, v120, s[80:81]
    v_cndmask_b32 v125, v120, v118, s[80:81]
    v_cndmask_b32 v126, v119, v121, s[80:81]
    v_cndmask_b32 v127, v121, v119, s[80:81]
    s_add_u32 s47, s77, 0
    buffer_store_dwordx4 v[124:127], v4, s[16:19], s47 offen sc1
    v_cvt_pk_bf16_f32 v128, v24, v25
    v_cvt_pk_bf16_f32 v129, v26, v27
    v_cvt_pk_bf16_f32 v130, v28, v29
    v_cvt_pk_bf16_f32 v131, v30, v31
    v_cndmask_b32 v132, v130, v128, s[80:81]
    v_cndmask_b32 v133, v131, v129, s[80:81]
    v_cndmask_b32 v134, v128, v130, s[80:81]
    v_cndmask_b32 v135, v129, v131, s[80:81]
    s_nop 0
    v_mov_b32_dpp v136, v132 quad_perm:[1,0,3,2] row_mask:0xf bank_mask:0xf
    v_mov_b32_dpp v137, v133 quad_perm:[1,0,3,2] row_mask:0xf bank_mask:0xf
    v_cndmask_b32 v140, v134, v136, s[80:81]
    v_cndmask_b32 v141, v136, v134, s[80:81]
    v_cndmask_b32 v142, v135, v137, s[80:81]
    v_cndmask_b32 v143, v137, v135, s[80:81]
    s_add_u32 s47, s77, 65536
    buffer_store_dwordx4 v[140:143], v4, s[16:19], s47 offen sc1
    v_cvt_pk_bf16_f32 v144, v32, v33
    v_cvt_pk_bf16_f32 v145, v34, v35
    v_cvt_pk_bf16_f32 v146, v36, v37
    v_cvt_pk_bf16_f32 v147, v38, v39
    v_cndmask_b32 v148, v146, v144, s[80:81]
    v_cndmask_b32 v149, v147, v145, s[80:81]
    v_cndmask_b32 v150, v144, v146, s[80:81]
    v_cndmask_b32 v151, v145, v147, s[80:81]
    s_nop 0
    v_mov_b32_dpp v152, v148 quad_perm:[1,0,3,2] row_mask:0xf bank_mask:0xf
    v_mov_b32_dpp v153, v149 quad_perm:[1,0,3,2] row_mask:0xf bank_mask:0xf
    v_cndmask_b32 v156, v150, v152, s[80:81]
    v_cndmask_b32 v157, v152, v150, s[80:81]
    v_cndmask_b32 v158, v151, v153, s[80:81]
    v_cndmask_b32 v159, v153, v151, s[80:81]
    s_add_u32 s47, s77, 131072
    buffer_store_dwordx4 v[156:159], v4, s[16:19], s47 offen sc1
    v_cvt_pk_bf16_f32 v160, v40, v41
    v_cvt_pk_bf16_f32 v161, v42, v43
    v_cvt_pk_bf16_f32 v162, v44, v45
    v_cvt_pk_bf16_f32 v163, v46, v47
    v_cndmask_b32 v164, v162, v160, s[80:81]
    v_cndmask_b32 v165, v163, v161, s[80:81]
    v_cndmask_b32 v166, v160, v162, s[80:81]
    v_cndmask_b32 v167, v161, v163, s[80:81]
    s_nop 0
    v_mov_b32_dpp v168, v164 quad_perm:[1,0,3,2] row_mask:0xf bank_mask:0xf
    v_mov_b32_dpp v169, v165 quad_perm:[1,0,3,2] row_mask:0xf bank_mask:0xf
    v_cndmask_b32 v172, v166, v168, s[80:81]
    v_cndmask_b32 v173, v168, v166, s[80:81]
    v_cndmask_b32 v174, v167, v169, s[80:81]
    v_cndmask_b32 v175, v169, v167, s[80:81]
    s_add_u32 s47, s77, 196608
    buffer_store_dwordx4 v[172:175], v4, s[16:19], s47 offen sc1
G2_cons:
    s_setprio 2
    s_mov_b32 s44, 0
    v_mov_b32 v3, v5
    v_mov_b32 v14, v6
    v_mov_b32 v15, v7
    s_waitcnt lgkmcnt(0)
    s_barrier
    ds_read_b64_tr_b16 v[88:89], v14 offset:4096
    ds_read_b64_tr_b16 v[90:91], v14 offset:5120
    ds_read_b128 v[48:51], v3 offset:0
    s_add_u32 s44, s44, 8192
    ds_read_b128 v[52:55], v3 offset:1024
    s_cmp_eq_u32 s44, 57344
    ds_read_b128 v[56:59], v3 offset:2048
    s_cselect_b32 s44, 0, s44
    ds_read_b128 v[60:63], v3 offset:3072
    ds_read_b64_tr_b16 v[92:93], v15 offset:4096
    v_add_u32 v3, s44, v5
    ds_read_b64_tr_b16 v[94:95], v15 offset:5120
    ds_read_b64_tr_b16 v[80:81], v14 offset:0
    ds_read_b64_tr_b16 v[82:83], v14 offset:1024
    ds_read_b64_tr_b16 v[84:85], v15 offset:0
    ds_read_b64_tr_b16 v[86:87], v15 offset:1024
    v_subrev_u32 v14, s44, v6
    v_subrev_u32 v15, s44, v7
    s_waitcnt lgkmcnt(0)
    s_barrier
    v_mfma_f32_16x16x32_bf16 v[144:147], v[88:91], v[48:51], 0
    ds_read_b128 v[64:67], v3 offset:0
    v_mfma_f32_16x16x32_bf16 v[148:151], v[92:95], v[48:51], 0
    ds_read_b64_tr_b16 v[104:105], v14 offset:4096
    v_mfma_f32_16x16x32_bf16 v[156:159], v[92:95], v[52:55], 0
    ds_read_b64_tr_b16 v[106:107], v14 offset:5120
    v_mfma_f32_16x16x32_bf16 v[152:155], v[88:91], v[52:55], 0
    ds_read_b128 v[68:71], v3 offset:1024
    v_mfma_f32_16x16x32_bf16 v[160:163], v[88:91], v[56:59], 0
    ds_read_b128 v[72:75], v3 offset:2048
    v_mfma_f32_16x16x32_bf16 v[164:167], v[92:95], v[56:59], 0
    ds_read_b128 v[76:79], v3 offset:3072
    v_mfma_f32_16x16x32_bf16 v[172:175], v[92:95], v[60:63], 0
    ds_read_b64_tr_b16 v[108:109], v15 offset:4096
    v_mfma_f32_16x16x32_bf16 v[168:171], v[88:91], v[60:63], 0
    ds_read_b64_tr_b16 v[110:111], v15 offset:5120
    v_mfma_f32_16x16x32_bf16 v[136:139], v[80:83], v[60:63], 0
    ds_read_b64_tr_b16 v[96:97], v14 offset:0
    s_add_u32 s44, s44, 8192
    v_mfma_f32_16x16x32_bf16 v[140:143], v[84:87], v[60:63], 0
    ds_read_b64_tr_b16 v[98:99], v14 offset:1024
    s_cmp_eq_u32 s44, 57344
    v_mfma_f32_16x16x32_bf16 v[132:135], v[84:87], v[56:59], 0
    ds_read_b64_tr_b16 v[100:101], v15 offset:0
    s_cselect_b32 s44, 0, s44
    v_mfma_f32_16x16x32_bf16 v[128:131], v[80:83], v[56:59], 0
    ds_read_b64_tr_b16 v[102:103], v15 offset:1024
    v_add_u32 v3, s44, v5
    v_mfma_f32_16x16x32_bf16 v[120:123], v[80:83], v[52:55], 0
    v_subrev_u32 v14, s44, v6
    v_mfma_f32_16x16x32_bf16 v[124:127], v[84:87], v[52:55], 0
    v_subrev_u32 v15, s44, v7
    v_mfma_f32_16x16x32_bf16 v[116:119], v[84:87], v[48:51], 0
    v_mfma_f32_16x16x32_bf16 v[112:115], v[80:83], v[48:51], 0
    s_mov_b32 s88, 3
LOOP_127:
    s_waitcnt lgkmcnt(0)
    s_barrier
    v_mfma_f32_16x16x32_bf16 v[144:147], v[104:107], v[64:67], v[144:147]
    ds_read_b128 v[48:51], v3 offset:0
    v_mfma_f32_16x16x32_bf16 v[148:151], v[108:111], v[64:67], v[148:151]
    ds_read_b64_tr_b16 v[88:89], v14 offset:4096
    v_mfma_f32_16x16x32_bf16 v[156:159], v[108:111], v[68:71], v[156:159]
    ds_read_b64_tr_b16 v[90:91], v14 offset:5120
    v_mfma_f32_16x16x32_bf16 v[152:155], v[104:107], v[68:71], v[152:155]
    ds_read_b128 v[52:55], v3 offset:1024
    v_mfma_f32_16x16x32_bf16 v[160:163], v[104:107], v[72:75], v[160:163]
    ds_read_b128 v[56:59], v3 offset:2048
    v_mfma_f32_16x16x32_bf16 v[164:167], v[108:111], v[72:75], v[164:167]
    ds_read_b128 v[60:63], v3 offset:3072
    v_mfma_f32_16x16x32_bf16 v[172:175], v[108:111], v[76:79], v[172:175]
    ds_read_b64_tr_b16 v[92:93], v15 offset:4096
    v_mfma_f32_16x16x32_bf16 v[168:171], v[104:107], v[76:79], v[168:171]
    ds_read_b64_tr_b16 v[94:95], v15 offset:5120
    v_mfma_f32_16x16x32_bf16 v[136:139], v[96:99], v[76:79], v[136:139]
    ds_read_b64_tr_b16 v[80:81], v14 offset:0
    s_add_u32 s44, s44, 8192
    v_mfma_f32_16x16x32_bf16 v[140:143], v[100:103], v[76:79], v[140:143]
    ds_read_b64_tr_b16 v[82:83], v14 offset:1024
    s_cmp_eq_u32 s44, 57344
    v_mfma_f32_16x16x32_bf16 v[132:135], v[100:103], v[72:75], v[132:135]
    ds_read_b64_tr_b16 v[84:85], v15 offset:0
    s_cselect_b32 s44, 0, s44
    v_mfma_f32_16x16x32_bf16 v[128:131], v[96:99], v[72:75], v[128:131]
    ds_read_b64_tr_b16 v[86:87], v15 offset:1024
    v_add_u32 v3, s44, v5
    v_mfma_f32_16x16x32_bf16 v[120:123], v[96:99], v[68:71], v[120:123]
    v_subrev_u32 v14, s44, v6
    v_mfma_f32_16x16x32_bf16 v[124:127], v[100:103], v[68:71], v[124:127]
    v_subrev_u32 v15, s44, v7
    v_mfma_f32_16x16x32_bf16 v[116:119], v[100:103], v[64:67], v[116:119]
    v_mfma_f32_16x16x32_bf16 v[112:115], v[96:99], v[64:67], v[112:115]
    s_waitcnt lgkmcnt(0)
    s_barrier
    v_mfma_f32_16x16x32_bf16 v[144:147], v[88:91], v[48:51], v[144:147]
    ds_read_b128 v[64:67], v3 offset:0
    v_mfma_f32_16x16x32_bf16 v[148:151], v[92:95], v[48:51], v[148:151]
    ds_read_b64_tr_b16 v[104:105], v14 offset:4096
    v_mfma_f32_16x16x32_bf16 v[156:159], v[92:95], v[52:55], v[156:159]
    ds_read_b64_tr_b16 v[106:107], v14 offset:5120
    v_mfma_f32_16x16x32_bf16 v[152:155], v[88:91], v[52:55], v[152:155]
    ds_read_b128 v[68:71], v3 offset:1024
    v_mfma_f32_16x16x32_bf16 v[160:163], v[88:91], v[56:59], v[160:163]
    ds_read_b128 v[72:75], v3 offset:2048
    v_mfma_f32_16x16x32_bf16 v[164:167], v[92:95], v[56:59], v[164:167]
    ds_read_b128 v[76:79], v3 offset:3072
    v_mfma_f32_16x16x32_bf16 v[172:175], v[92:95], v[60:63], v[172:175]
    ds_read_b64_tr_b16 v[108:109], v15 offset:4096
    v_mfma_f32_16x16x32_bf16 v[168:171], v[88:91], v[60:63], v[168:171]
    ds_read_b64_tr_b16 v[110:111], v15 offset:5120
    v_mfma_f32_16x16x32_bf16 v[136:139], v[80:83], v[60:63], v[136:139]
    ds_read_b64_tr_b16 v[96:97], v14 offset:0
    s_add_u32 s44, s44, 8192
    v_mfma_f32_16x16x32_bf16 v[140:143], v[84:87], v[60:63], v[140:143]
    ds_read_b64_tr_b16 v[98:99], v14 offset:1024
    s_cmp_eq_u32 s44, 57344
    v_mfma_f32_16x16x32_bf16 v[132:135], v[84:87], v[56:59], v[132:135]
    ds_read_b64_tr_b16 v[100:101], v15 offset:0
    s_cselect_b32 s44, 0, s44
    v_mfma_f32_16x16x32_bf16 v[128:131], v[80:83], v[56:59], v[128:131]
    ds_read_b64_tr_b16 v[102:103], v15 offset:1024
    v_add_u32 v3, s44, v5
    v_mfma_f32_16x16x32_bf16 v[120:123], v[80:83], v[52:55], v[120:123]
    v_subrev_u32 v14, s44, v6
    v_mfma_f32_16x16x32_bf16 v[124:127], v[84:87], v[52:55], v[124:127]
    v_subrev_u32 v15, s44, v7
    v_mfma_f32_16x16x32_bf16 v[116:119], v[84:87], v[48:51], v[116:119]
    s_sub_u32 s88, s88, 1
    s_cmp_lg_u32 s88, 0
    v_mfma_f32_16x16x32_bf16 v[112:115], v[80:83], v[48:51], v[112:115]
    s_cbranch_scc1 LOOP_127
    s_waitcnt lgkmcnt(0)
    s_barrier
    v_mfma_f32_16x16x32_bf16 v[144:147], v[104:107], v[64:67], v[144:147]
    ds_read_b128 v[48:51], v3 offset:0
    v_mfma_f32_16x16x32_bf16 v[148:151], v[108:111], v[64:67], v[148:151]
    ds_read_b64_tr_b16 v[88:89], v14 offset:4096
    v_mfma_f32_16x16x32_bf16 v[156:159], v[108:111], v[68:71], v[156:159]
    ds_read_b64_tr_b16 v[90:91], v14 offset:5120
    v_mfma_f32_16x16x32_bf16 v[152:155], v[104:107], v[68:71], v[152:155]
    ds_read_b128 v[52:55], v3 offset:1024
    v_mfma_f32_16x16x32_bf16 v[160:163], v[104:107], v[72:75], v[160:163]
    ds_read_b128 v[56:59], v3 offset:2048
    v_mfma_f32_16x16x32_bf16 v[164:167], v[108:111], v[72:75], v[164:167]
    ds_read_b128 v[60:63], v3 offset:3072
    v_mfma_f32_16x16x32_bf16 v[172:175], v[108:111], v[76:79], v[172:175]
    ds_read_b64_tr_b16 v[92:93], v15 offset:4096
    v_mfma_f32_16x16x32_bf16 v[168:171], v[104:107], v[76:79], v[168:171]
    ds_read_b64_tr_b16 v[94:95], v15 offset:5120
    v_mfma_f32_16x16x32_bf16 v[136:139], v[96:99], v[76:79], v[136:139]
    ds_read_b64_tr_b16 v[80:81], v14 offset:0
    s_add_u32 s44, s44, 8192
    v_mfma_f32_16x16x32_bf16 v[140:143], v[100:103], v[76:79], v[140:143]
    ds_read_b64_tr_b16 v[82:83], v14 offset:1024
    s_cmp_eq_u32 s44, 57344
    v_mfma_f32_16x16x32_bf16 v[132:135], v[100:103], v[72:75], v[132:135]
    ds_read_b64_tr_b16 v[84:85], v15 offset:0
    s_cselect_b32 s44, 0, s44
    v_mfma_f32_16x16x32_bf16 v[128:131], v[96:99], v[72:75], v[128:131]
    ds_read_b64_tr_b16 v[86:87], v15 offset:1024
    v_add_u32 v3, s44, v5
    v_mfma_f32_16x16x32_bf16 v[120:123], v[96:99], v[68:71], v[120:123]
    v_subrev_u32 v14, s44, v6
    v_mfma_f32_16x16x32_bf16 v[124:127], v[100:103], v[68:71], v[124:127]
    v_subrev_u32 v15, s44, v7
    v_mfma_f32_16x16x32_bf16 v[116:119], v[100:103], v[64:67], v[116:119]
    v_mfma_f32_16x16x32_bf16 v[112:115], v[96:99], v[64:67], v[112:115]
    s_waitcnt vmcnt(0) lgkmcnt(0)
    s_barrier
    s_cmp_lg_u32 s70, 0
    s_cbranch_scc1 G2_nopub
    s_mov_b64 exec, 1
    buffer_store_dword v11, v12, s[28:31], s34 offen sc1
    s_mov_b64 exec, -1
G2_nopub:
    v_mfma_f32_16x16x32_bf16 v[144:147], v[88:91], v[48:51], v[144:147]
    ds_read_b64_tr_b16 v[104:105], v14 offset:4096
    ds_read_b64_tr_b16 v[106:107], v14 offset:5120
    ds_read_b128 v[64:67], v3 offset:0
    v_mfma_f32_16x16x32_bf16 v[148:151], v[92:95], v[48:51], v[148:151]
    s_add_u32 s44, s44, 8192
    ds_read_b128 v[68:71], v3 offset:1024
    s_cmp_eq_u32 s44, 57344
    v_mfma_f32_16x16x32_bf16 v[156:159], v[92:95], v[52:55], v[156:159]
    ds_read_b128 v[72:75], v3 offset:2048
    s_cselect_b32 s44, 0, s44
    ds_read_b128 v[76:79], v3 offset:3072
    v_mfma_f32_16x16x32_bf16 v[152:155], v[88:91], v[52:55], v[152:155]
    ds_read_b64_tr_b16 v[108:109], v15 offset:4096
    v_add_u32 v3, s44, v5
    ds_read_b64_tr_b16 v[110:111], v15 offset:5120
    v_mfma_f32_16x16x32_bf16 v[160:163], v[88:91], v[56:59], v[160:163]
    ds_read_b64_tr_b16 v[96:97], v14 offset:0
    ds_read_b64_tr_b16 v[98:99], v14 offset:1024
    ds_read_b64_tr_b16 v[100:101], v15 offset:0
    v_mfma_f32_16x16x32_bf16 v[164:167], v[92:95], v[56:59], v[164:167]
    ds_read_b64_tr_b16 v[102:103], v15 offset:1024
    v_subrev_u32 v14, s44, v6
    v_subrev_u32 v15, s44, v7
    v_mfma_f32_16x16x32_bf16 v[172:175], v[92:95], v[60:63], v[172:175]
    v_sub_f32 v240, 1.0, v240
    v_sub_f32 v242, 1.0, v242
    v_mfma_f32_16x16x32_bf16 v[168:171], v[88:91], v[60:63], v[168:171]
    v_sub_f32 v244, 1.0, v244
    v_sub_f32 v246, 1.0, v246
    v_cvt_pk_bf16_f32 v240, v240, v240
    v_mfma_f32_16x16x32_bf16 v[136:139], v[80:83], v[60:63], v[136:139]
    v_cvt_pk_bf16_f32 v242, v242, v242
    v_cvt_pk_bf16_f32 v244, v244, v244
    v_cvt_pk_bf16_f32 v246, v246, v246
    v_mfma_f32_16x16x32_bf16 v[140:143], v[84:87], v[60:63], v[140:143]
    v_and_b32 v241, 0xffff0000, v240
    v_and_b32 v243, 0xffff0000, v242
    v_and_b32 v245, 0xffff0000, v244
    v_mfma_f32_16x16x32_bf16 v[132:135], v[84:87], v[56:59], v[132:135]
    v_and_b32 v247, 0xffff0000, v246
    v_lshlrev_b32 v240, 16, v240
    v_lshlrev_b32 v242, 16, v242
    v_mfma_f32_16x16x32_bf16 v[128:131], v[80:83], v[56:59], v[128:131]
    v_lshlrev_b32 v244, 16, v244
    v_lshlrev_b32 v246, 16, v246
    v_mfma_f32_16x16x32_bf16 v[120:123], v[80:83], v[52:55], v[120:123]
    v_mfma_f32_16x16x32_bf16 v[124:127], v[84:87], v[52:55], v[124:127]
    v_mfma_f32_16x16x32_bf16 v[116:119], v[84:87], v[48:51], v[116:119]
    v_mfma_f32_16x16x32_bf16 v[112:115], v[80:83], v[48:51], v[112:115]
    s_mov_b32 s88, 18
LOOP_132:
    s_waitcnt lgkmcnt(0)
    s_barrier
    v_mfma_f32_16x16x32_bf16 v[144:147], v[104:107], v[64:67], v[144:147]
    ds_read_b128 v[48:51], v3 offset:0
    v_mfma_f32_16x16x32_bf16 v[148:151], v[108:111], v[64:67], v[148:151]
    ds_read_b64_tr_b16 v[88:89], v14 offset:4096
    v_mfma_f32_16x16x32_bf16 v[156:159], v[108:111], v[68:71], v[156:159]
    ds_read_b64_tr_b16 v[90:91], v14 offset:5120
    v_mfma_f32_16x16x32_bf16 v[152:155], v[104:107], v[68:71], v[152:155]
    ds_read_b128 v[52:55], v3 offset:1024
    v_mfma_f32_16x16x32_bf16 v[160:163], v[104:107], v[72:75], v[160:163]
    ds_read_b128 v[56:59], v3 offset:2048
    v_mfma_f32_16x16x32_bf16 v[164:167], v[108:111], v[72:75], v[164:167]
    ds_read_b128 v[60:63], v3 offset:3072
    v_mfma_f32_16x16x32_bf16 v[172:175], v[108:111], v[76:79], v[172:175]
    ds_read_b64_tr_b16 v[92:93], v15 offset:4096
    v_mfma_f32_16x16x32_bf16 v[168:171], v[104:107], v[76:79], v[168:171]
    ds_read_b64_tr_b16 v[94:95], v15 offset:5120
    v_mfma_f32_16x16x32_bf16 v[136:139], v[96:99], v[76:79], v[136:139]
    ds_read_b64_tr_b16 v[80:81], v14 offset:0
    s_add_u32 s44, s44, 8192
    v_mfma_f32_16x16x32_bf16 v[140:143], v[100:103], v[76:79], v[140:143]
    ds_read_b64_tr_b16 v[82:83], v14 offset:1024
    s_cmp_eq_u32 s44, 57344
    v_mfma_f32_16x16x32_bf16 v[132:135], v[100:103], v[72:75], v[132:135]
    ds_read_b64_tr_b16 v[84:85], v15 offset:0
    s_cselect_b32 s44, 0, s44
    v_mfma_f32_16x16x32_bf16 v[128:131], v[96:99], v[72:75], v[128:131]
    ds_read_b64_tr_b16 v[86:87], v15 offset:1024
    v_add_u32 v3, s44, v5
    v_mfma_f32_16x16x32_bf16 v[120:123], v[96:99], v[68:71], v[120:123]
    v_subrev_u32 v14, s44, v6
    v_mfma_f32_16x16x32_bf16 v[124:127], v[100:103], v[68:71], v[124:127]
    v_subrev_u32 v15, s44, v7
    v_mfma_f32_16x16x32_bf16 v[116:119], v[100:103], v[64:67], v[116:119]
    v_mfma_f32_16x16x32_bf16 v[112:115], v[96:99], v[64:67], v[112:115]
    s_waitcnt lgkmcnt(0)
    s_barrier
    v_mfma_f32_16x16x32_bf16 v[144:147], v[88:91], v[48:51], v[144:147]
    ds_read_b128 v[64:67], v3 offset:0
    v_mfma_f32_16x16x32_bf16 v[148:151], v[92:95], v[48:51], v[148:151]
    ds_read_b64_tr_b16 v[104:105], v14 offset:4096
    v_mfma_f32_16x16x32_bf16 v[156:159], v[92:95], v[52:55], v[156:159]
    ds_read_b64_tr_b16 v[106:107], v14 offset:5120
    v_mfma_f32_16x16x32_bf16 v[152:155], v[88:91], v[52:55], v[152:155]
    ds_read_b128 v[68:71], v3 offset:1024
    v_mfma_f32_16x16x32_bf16 v[160:163], v[88:91], v[56:59], v[160:163]
    ds_read_b128 v[72:75], v3 offset:2048
    v_mfma_f32_16x16x32_bf16 v[164:167], v[92:95], v[56:59], v[164:167]
    ds_read_b128 v[76:79], v3 offset:3072
    v_mfma_f32_16x16x32_bf16 v[172:175], v[92:95], v[60:63], v[172:175]
    ds_read_b64_tr_b16 v[108:109], v15 offset:4096
    v_mfma_f32_16x16x32_bf16 v[168:171], v[88:91], v[60:63], v[168:171]
    ds_read_b64_tr_b16 v[110:111], v15 offset:5120
    v_mfma_f32_16x16x32_bf16 v[136:139], v[80:83], v[60:63], v[136:139]
    ds_read_b64_tr_b16 v[96:97], v14 offset:0
    s_add_u32 s44, s44, 8192
    v_mfma_f32_16x16x32_bf16 v[140:143], v[84:87], v[60:63], v[140:143]
    ds_read_b64_tr_b16 v[98:99], v14 offset:1024
    s_cmp_eq_u32 s44, 57344
    v_mfma_f32_16x16x32_bf16 v[132:135], v[84:87], v[56:59], v[132:135]
    ds_read_b64_tr_b16 v[100:101], v15 offset:0
    s_cselect_b32 s44, 0, s44
    v_mfma_f32_16x16x32_bf16 v[128:131], v[80:83], v[56:59], v[128:131]
    ds_read_b64_tr_b16 v[102:103], v15 offset:1024
    v_add_u32 v3, s44, v5
    v_mfma_f32_16x16x32_bf16 v[120:123], v[80:83], v[52:55], v[120:123]
    v_subrev_u32 v14, s44, v6
    v_mfma_f32_16x16x32_bf16 v[124:127], v[84:87], v[52:55], v[124:127]
    v_subrev_u32 v15, s44, v7
    v_mfma_f32_16x16x32_bf16 v[116:119], v[84:87], v[48:51], v[116:119]
    s_sub_u32 s88, s88, 1
    s_cmp_lg_u32 s88, 0
    v_mfma_f32_16x16x32_bf16 v[112:115], v[80:83], v[48:51], v[112:115]
    s_cbranch_scc1 LOOP_132
    s_waitcnt lgkmcnt(0)
    s_barrier
    v_mfma_f32_16x16x32_bf16 v[144:147], v[104:107], v[64:67], v[144:147]
    ds_read_b128 v[48:51], v3 offset:0
    v_mfma_f32_16x16x32_bf16 v[148:151], v[108:111], v[64:67], v[148:151]
    ds_read_b64_tr_b16 v[80:81], v14 offset:0
    v_mfma_f32_16x16x32_bf16 v[156:159], v[108:111], v[68:71], v[156:159]
    ds_read_b64_tr_b16 v[82:83], v14 offset:1024
    v_mfma_f32_16x16x32_bf16 v[152:155], v[104:107], v[68:71], v[152:155]
    ds_read_b128 v[52:55], v3 offset:1024
    v_mfma_f32_16x16x32_bf16 v[160:163], v[104:107], v[72:75], v[160:163]
    ds_read_b128 v[56:59], v3 offset:2048
    v_mfma_f32_16x16x32_bf16 v[164:167], v[108:111], v[72:75], v[164:167]
    ds_read_b128 v[60:63], v3 offset:3072
    v_mfma_f32_16x16x32_bf16 v[172:175], v[108:111], v[76:79], v[172:175]
    ds_read_b64_tr_b16 v[84:85], v15 offset:0
    v_mfma_f32_16x16x32_bf16 v[168:171], v[104:107], v[76:79], v[168:171]
    ds_read_b64_tr_b16 v[86:87], v15 offset:1024
    v_mfma_f32_16x16x32_bf16 v[136:139], v[96:99], v[76:79], v[136:139]
    s_add_u32 s44, s44, 8192
    v_cvt_pk_bf16_f32 v176, v144, v145
    v_cvt_pk_bf16_f32 v177, v146, v147
    v_cvt_pk_bf16_f32 v178, v148, v149
    v_mfma_f32_16x16x32_bf16 v[140:143], v[100:103], v[76:79], v[140:143]
    s_cmp_eq_u32 s44, 57344
    v_cvt_pk_bf16_f32 v179, v150, v151
    buffer_store_dwordx4 v[176:179], v13, s[60:63], s37 offen offset:0 sc1
    v_cvt_pk_bf16_f32 v180, v152, v153
    v_mfma_f32_16x16x32_bf16 v[132:135], v[100:103], v[72:75], v[132:135]
    s_cselect_b32 s44, 0, s44
    v_cvt_pk_bf16_f32 v181, v154, v155
    v_cvt_pk_bf16_f32 v182, v156, v157
    v_cvt_pk_bf16_f32 v183, v158, v159
    v_mfma_f32_16x16x32_bf16 v[128:131], v[96:99], v[72:75], v[128:131]
    v_add_u32 v3, s44, v5
    buffer_store_dwordx4 v[180:183], v13, s[60:63], s37 offen offset:1024 sc1
    v_cvt_pk_bf16_f32 v184, v160, v161
    v_cvt_pk_bf16_f32 v185, v162, v163
    v_mfma_f32_16x16x32_bf16 v[120:123], v[96:99], v[68:71], v[120:123]
    v_subrev_u32 v14, s44, v6
    v_cvt_pk_bf16_f32 v186, v164, v165
    v_cvt_pk_bf16_f32 v187, v166, v167
    buffer_store_dwordx4 v[184:187], v13, s[60:63], s37 offen offset:2048 sc1
    v_mfma_f32_16x16x32_bf16 v[124:127], v[100:103], v[68:71], v[124:127]
    v_subrev_u32 v15, s44, v7
    v_cvt_pk_bf16_f32 v188, v168, v169
    v_cvt_pk_bf16_f32 v189, v170, v171
    v_cvt_pk_bf16_f32 v190, v172, v173
    v_mfma_f32_16x16x32_bf16 v[116:119], v[100:103], v[64:67], v[116:119]
    v_cvt_pk_bf16_f32 v191, v174, v175
    buffer_store_dwordx4 v[188:191], v13, s[60:63], s37 offen offset:3072 sc1
    v_mfma_f32_16x16x32_bf16 v[112:115], v[96:99], v[64:67], v[112:115]
    s_mov_b32 s88, 3
LOOP_136:
    s_waitcnt lgkmcnt(0)
    s_barrier
    v_mfma_f32_16x16x32_bf16 v[112:115], v[80:83], v[48:51], v[112:115]
    ds_read_b64_tr_b16 v[96:97], v14 offset:0
    ds_read_b64_tr_b16 v[98:99], v14 offset:1024
    v_mfma_f32_16x16x32_bf16 v[116:119], v[84:87], v[48:51], v[116:119]
    ds_read_b128 v[64:67], v3 offset:0
    s_add_u32 s44, s44, 8192
    v_mfma_f32_16x16x32_bf16 v[124:127], v[84:87], v[52:55], v[124:127]
    ds_read_b128 v[68:71], v3 offset:1024
    s_cmp_eq_u32 s44, 57344
    v_mfma_f32_16x16x32_bf16 v[120:123], v[80:83], v[52:55], v[120:123]
    ds_read_b128 v[72:75], v3 offset:2048
    s_cselect_b32 s44, 0, s44
    v_mfma_f32_16x16x32_bf16 v[128:131], v[80:83], v[56:59], v[128:131]
    ds_read_b128 v[76:79], v3 offset:3072
    ds_read_b64_tr_b16 v[100:101], v15 offset:0
    v_mfma_f32_16x16x32_bf16 v[132:135], v[84:87], v[56:59], v[132:135]
    v_add_u32 v3, s44, v5
    ds_read_b64_tr_b16 v[102:103], v15 offset:1024
    v_mfma_f32_16x16x32_bf16 v[140:143], v[84:87], v[60:63], v[140:143]
    v_subrev_u32 v14, s44, v6
    v_subrev_u32 v15, s44, v7
    v_mfma_f32_16x16x32_bf16 v[136:139], v[80:83], v[60:63], v[136:139]
    s_waitcnt lgkmcnt(0)
    s_barrier
    v_mfma_f32_16x16x32_bf16 v[112:115], v[96:99], v[64:67], v[112:115]
    ds_read_b64_tr_b16 v[80:81], v14 offset:0
    ds_read_b64_tr_b16 v[82:83], v14 offset:1024
    v_mfma_f32_16x16x32_bf16 v[116:119], v[100:103], v[64:67], v[116:119]
    ds_read_b128 v[48:51], v3 offset:0
    s_add_u32 s44, s44, 8192
    v_mfma_f32_16x16x32_bf16 v[124:127], v[100:103], v[68:71], v[124:127]
    ds_read_b128 v[52:55], v3 offset:1024
    s_cmp_eq_u32 s44, 57344
    v_mfma_f32_16x16x32_bf16 v[120:123], v[96:99], v[68:71], v[120:123]
    ds_read_b128 v[56:59], v3 offset:2048
    s_cselect_b32 s44, 0, s44
    v_mfma_f32_16x16x32_bf16 v[128:131], v[96:99], v[72:75], v[128:131]
    ds_read_b128 v[60:63], v3 offset:3072
    ds_read_b64_tr_b16 v[84:85], v15 offset:0
    v_mfma_f32_16x16x32_bf16 v[132:135], v[100:103], v[72:75], v[132:135]
    v_add_u32 v3, s44, v5
    ds_read_b64_tr_b16 v[86:87], v15 offset:1024
    v_mfma_f32_16x16x32_bf16 v[140:143], v[100:103], v[76:79], v[140:143]
    v_subrev_u32 v14, s44, v6
    v_subrev_u32 v15, s44, v7
    v_mfma_f32_16x16x32_bf16 v[136:139], v[96:99], v[76:79], v[136:139]
    s_sub_u32 s88, s88, 1
    s_cmp_lg_u32 s88, 0
    s_cbranch_scc1 LOOP_136
    s_waitcnt vmcnt(0) lgkmcnt(0)
    s_mov_b64 exec, 1
    buffer_store_dword v11, v12, s[28:31], s36 offen sc1
    s_mov_b64 exec, -1
    s_barrier
    v_mfma_f32_16x16x32_bf16 v[112:115], v[80:83], v[48:51], v[112:115]
    ds_read_b64_tr_b16 v[96:97], v14 offset:0
    ds_read_b64_tr_b16 v[98:99], v14 offset:1024
    v_mfma_f32_16x16x32_bf16 v[116:119], v[84:87], v[48:51], v[116:119]
    ds_read_b128 v[64:67], v3 offset:0
    s_add_u32 s44, s44, 8192
    v_mfma_f32_16x16x32_bf16 v[124:127], v[84:87], v[52:55], v[124:127]
    ds_read_b128 v[68:71], v3 offset:1024
    s_cmp_eq_u32 s44, 57344
    v_mfma_f32_16x16x32_bf16 v[120:123], v[80:83], v[52:55], v[120:123]
    ds_read_b128 v[72:75], v3 offset:2048
    s_cselect_b32 s44, 0, s44
    v_mfma_f32_16x16x32_bf16 v[128:131], v[80:83], v[56:59], v[128:131]
    ds_read_b128 v[76:79], v3 offset:3072
    ds_read_b64_tr_b16 v[100:101], v15 offset:0
    v_mfma_f32_16x16x32_bf16 v[132:135], v[84:87], v[56:59], v[132:135]
    v_add_u32 v3, s44, v5
    ds_read_b64_tr_b16 v[102:103], v15 offset:1024
    v_mfma_f32_16x16x32_bf16 v[140:143], v[84:87], v[60:63], v[140:143]
    v_subrev_u32 v14, s44, v6
    v_subrev_u32 v15, s44, v7
    v_mfma_f32_16x16x32_bf16 v[136:139], v[80:83], v[60:63], v[136:139]
    s_mov_b32 s88, 6
LOOP_140:
    s_waitcnt lgkmcnt(0)
    s_barrier
    v_mfma_f32_16x16x32_bf16 v[112:115], v[96:99], v[64:67], v[112:115]
    ds_read_b64_tr_b16 v[80:81], v14 offset:0
    ds_read_b64_tr_b16 v[82:83], v14 offset:1024
    v_mfma_f32_16x16x32_bf16 v[116:119], v[100:103], v[64:67], v[116:119]
    ds_read_b128 v[48:51], v3 offset:0
    s_add_u32 s44, s44, 8192
    v_mfma_f32_16x16x32_bf16 v[124:127], v[100:103], v[68:71], v[124:127]
    ds_read_b128 v[52:55], v3 offset:1024
    s_cmp_eq_u32 s44, 57344
    v_mfma_f32_16x16x32_bf16 v[120:123], v[96:99], v[68:71], v[120:123]
    ds_read_b128 v[56:59], v3 offset:2048
    s_cselect_b32 s44, 0, s44
    v_mfma_f32_16x16x32_bf16 v[128:131], v[96:99], v[72:75], v[128:131]
    ds_read_b128 v[60:63], v3 offset:3072
    ds_read_b64_tr_b16 v[84:85], v15 offset:0
    v_mfma_f32_16x16x32_bf16 v[132:135], v[100:103], v[72:75], v[132:135]
    v_add_u32 v3, s44, v5
    ds_read_b64_tr_b16 v[86:87], v15 offset:1024
    v_mfma_f32_16x16x32_bf16 v[140:143], v[100:103], v[76:79], v[140:143]
    v_subrev_u32 v14, s44, v6
    v_subrev_u32 v15, s44, v7
    v_mfma_f32_16x16x32_bf16 v[136:139], v[96:99], v[76:79], v[136:139]
    s_waitcnt lgkmcnt(0)
    s_barrier
    v_mfma_f32_16x16x32_bf16 v[112:115], v[80:83], v[48:51], v[112:115]
    ds_read_b64_tr_b16 v[96:97], v14 offset:0
    ds_read_b64_tr_b16 v[98:99], v14 offset:1024
    v_mfma_f32_16x16x32_bf16 v[116:119], v[84:87], v[48:51], v[116:119]
    ds_read_b128 v[64:67], v3 offset:0
    s_add_u32 s44, s44, 8192
    v_mfma_f32_16x16x32_bf16 v[124:127], v[84:87], v[52:55], v[124:127]
    ds_read_b128 v[68:71], v3 offset:1024
    s_cmp_eq_u32 s44, 57344
    v_mfma_f32_16x16x32_bf16 v[120:123], v[80:83], v[52:55], v[120:123]
    ds_read_b128 v[72:75], v3 offset:2048
    s_cselect_b32 s44, 0, s44
    v_mfma_f32_16x16x32_bf16 v[128:131], v[80:83], v[56:59], v[128:131]
    ds_read_b128 v[76:79], v3 offset:3072
    ds_read_b64_tr_b16 v[100:101], v15 offset:0
    v_mfma_f32_16x16x32_bf16 v[132:135], v[84:87], v[56:59], v[132:135]
    v_add_u32 v3, s44, v5
    ds_read_b64_tr_b16 v[102:103], v15 offset:1024
    v_mfma_f32_16x16x32_bf16 v[140:143], v[84:87], v[60:63], v[140:143]
    v_subrev_u32 v14, s44, v6
    v_subrev_u32 v15, s44, v7
    v_mfma_f32_16x16x32_bf16 v[136:139], v[80:83], v[60:63], v[136:139]
    s_sub_u32 s88, s88, 1
    s_cmp_lg_u32 s88, 0
    s_cbranch_scc1 LOOP_140
    s_waitcnt lgkmcnt(0)
    s_barrier
    v_mfma_f32_16x16x32_bf16 v[112:115], v[96:99], v[64:67], v[112:115]
    ds_read_b128 v[48:51], v253 offset:0
    ds_read_b128 v[52:55], v253 offset:1024
    v_mfma_f32_16x16x32_bf16 v[116:119], v[100:103], v[64:67], v[116:119]
    ds_read_b128 v[56:59], v253 offset:2048
    ds_read_b128 v[60:63], v253 offset:3072
    v_mfma_f32_16x16x32_bf16 v[124:127], v[100:103], v[68:71], v[124:127]
    ds_read_b128 v[176:179], v9 offset:0
    ds_read_b128 v[180:183], v9 offset:1024
    v_mfma_f32_16x16x32_bf16 v[120:123], v[96:99], v[68:71], v[120:123]
    ds_read_b128 v[184:187], v9 offset:2048
    ds_read_b128 v[188:191], v9 offset:3072
    v_mfma_f32_16x16x32_bf16 v[128:131], v[96:99], v[72:75], v[128:131]
    ds_read_b128 v[192:195], v9 offset:4096
    ds_read_b128 v[196:199], v9 offset:5120
    v_mfma_f32_16x16x32_bf16 v[132:135], v[100:103], v[72:75], v[132:135]
    ds_read_b128 v[200:203], v9 offset:6144
    ds_read_b128 v[204:207], v9 offset:7168
    v_mfma_f32_16x16x32_bf16 v[140:143], v[100:103], v[76:79], v[140:143]
    v_mfma_f32_16x16x32_bf16 v[136:139], v[96:99], v[76:79], v[136:139]
    s_waitcnt lgkmcnt(11)
    v_mfma_f32_16x16x32_bf16 v[112:115], v[208:211], v[48:51], v[112:115]
    v_mfma_f32_16x16x32_bf16 v[116:119], v[212:215], v[48:51], v[116:119]
    s_waitcnt lgkmcnt(10)
    v_mfma_f32_16x16x32_bf16 v[120:123], v[208:211], v[52:55], v[120:123]
    v_mfma_f32_16x16x32_bf16 v[124:127], v[212:215], v[52:55], v[124:127]
    s_waitcnt lgkmcnt(9)
    v_mfma_f32_16x16x32_bf16 v[128:131], v[208:211], v[56:59], v[128:131]
    v_mfma_f32_16x16x32_bf16 v[132:135], v[212:215], v[56:59], v[132:135]
    s_waitcnt lgkmcnt(8)
    v_mfma_f32_16x16x32_bf16 v[136:139], v[208:211], v[60:63], v[136:139]
    v_mfma_f32_16x16x32_bf16 v[140:143], v[212:215], v[60:63], v[140:143]
    s_waitcnt lgkmcnt(6)
    v_pk_fma_f32 v[112:113], v[112:113], v[240:241], v[176:177]
    v_pk_fma_f32 v[116:117], v[116:117], v[240:241], v[180:181]
    v_pk_fma_f32 v[114:115], v[114:115], v[240:241], v[178:179]
    v_pk_fma_f32 v[118:119], v[118:119], v[240:241], v[182:183]
    v_cvt_pk_bf16_f32 v16, v112, v113
    v_cvt_pk_bf16_f32 v18, v116, v117
    v_cvt_pk_bf16_f32 v17, v114, v115
    v_cvt_pk_bf16_f32 v19, v118, v119
    s_mov_b32 s47, 0
    s_nop 0
    v_permlane16_swap_b32 v16, v18
    v_permlane16_swap_b32 v17, v19
    buffer_store_dwordx4 v[16:19], v252, s[20:23], s47 offen sc1
    s_waitcnt lgkmcnt(4)
    v_pk_fma_f32 v[120:121], v[120:121], v[242:243], v[184:185]
    v_pk_fma_f32 v[124:125], v[124:125], v[242:243], v[188:189]
    v_pk_fma_f32 v[122:123], v[122:123], v[242:243], v[186:187]
    v_pk_fma_f32 v[126:127], v[126:127], v[242:243], v[190:191]
    v_cvt_pk_bf16_f32 v20, v120, v121
    v_cvt_pk_bf16_f32 v22, v124, v125
    v_cvt_pk_bf16_f32 v21, v122, v123
    v_cvt_pk_bf16_f32 v23, v126, v127
    s_mov_b32 s47, 32768
    s_nop 0
    v_permlane16_swap_b32 v20, v22
    v_permlane16_swap_b32 v21, v23
    buffer_store_dwordx4 v[20:23], v252, s[20:23], s47 offen sc1
    s_waitcnt lgkmcnt(2)
    v_pk_fma_f32 v[128:129], v[128:129], v[244:245], v[192:193]
    v_pk_fma_f32 v[132:133], v[132:133], v[244:245], v[196:197]
    v_pk_fma_f32 v[130:131], v[130:131], v[244:245], v[194:195]
    v_pk_fma_f32 v[134:135], v[134:135], v[244:245], v[198:199]
    v_cvt_pk_bf16_f32 v16, v128, v129
    v_cvt_pk_bf16_f32 v18, v132, v133
    v_cvt_pk_bf16_f32 v17, v130, v131
    v_cvt_pk_bf16_f32 v19, v134, v135
    s_mov_b32 s47, 65536
    s_nop 0
    v_permlane16_swap_b32 v16, v18
    v_permlane16_swap_b32 v17, v19
    buffer_store_dwordx4 v[16:19], v252, s[20:23], s47 offen sc1
    s_waitcnt lgkmcnt(0)
    v_pk_fma_f32 v[136:137], v[136:137], v[246:247], v[200:201]
    v_pk_fma_f32 v[140:141], v[140:141], v[246:247], v[204:205]
    v_pk_fma_f32 v[138:139], v[138:139], v[246:247], v[202:203]
    v_pk_fma_f32 v[142:143], v[142:143], v[246:247], v[206:207]
    v_cvt_pk_bf16_f32 v20, v136, v137
    v_cvt_pk_bf16_f32 v22, v140, v141
    v_cvt_pk_bf16_f32 v21, v138, v139
    v_cvt_pk_bf16_f32 v23, v142, v143
    s_mov_b32 s47, 98304
    s_nop 0
    v_permlane16_swap_b32 v20, v22
    v_permlane16_swap_b32 v21, v23
    buffer_store_dwordx4 v[20:23], v252, s[20:23], s47 offen sc1
C_end:
    s_endpgm
G1_prep:
    s_waitcnt lgkmcnt(0)
    s_mov_b32 s72, s66
    s_mov_b32 s73, s67
    s_mov_b32 s74, 256
    s_mov_b32 s75, 0x00020000
    s_mov_b32 s8, s4
    s_mov_b32 s9, s5
    s_mov_b32 s10, 4194304
    s_mov_b32 s11, 0x00020000
    s_mov_b32 s48, s6
    s_mov_b32 s49, s7
    s_mov_b32 s50, 4194304
    s_mov_b32 s51, 0x00020000
    s_mov_b32 s52, s28
    s_mov_b32 s53, s29
    s_mov_b32 s54, 4194304
    s_mov_b32 s55, 0x00020000
    s_mov_b32 s56, s30
    s_mov_b32 s57, s31
    s_mov_b32 s58, 8192
    s_mov_b32 s59, 0x00020000
    s_add_u32 s60, s38, 16777216
    s_addc_u32 s61, s39, 0
    s_mov_b32 s62, 8388608
    s_mov_b32 s63, 0x00020000
    s_mov_b32 s64, s36
    s_mov_b32 s65, s37
    s_mov_b32 s66, 2048
    s_mov_b32 s67, 0x00020000
    s_add_u32 s68, s38, 41943040
    s_addc_u32 s69, s39, 0
    s_mov_b32 s70, 8192
    s_mov_b32 s71, 0x00020000
    s_sub_u32 s41, s2, 224
    v_lshlrev_b32 v3, 2, v0
    v_lshlrev_b32 v4, 4, v0
    buffer_load_dwordx4 v[144:147], v4, s[56:59], 0 offen
    s_lshl_b32 s43, s41, 6
    s_sub_u32 s43, s43, 4
    s_lshl_b32 s43, s43, 11
    s_add_u32 s42, s43, 2048
    buffer_load_dword v12, v3, s[48:51], s42 offen
    s_add_u32 s42, s43, 4096
    buffer_load_dword v13, v3, s[48:51], s42 offen
    s_add_u32 s42, s43, 6144
    buffer_load_dword v14, v3, s[48:51], s42 offen
    s_add_u32 s42, s43, 8192
    buffer_load_dword v15, v3, s[48:51], s42 offen
    buffer_load_dword v79, v3, s[52:55], s42 offen
    s_add_u32 s42, s43, 10240
    buffer_load_dword v16, v3, s[48:51], s42 offen
    buffer_load_dword v80, v3, s[52:55], s42 offen
    s_add_u32 s42, s43, 12288
    buffer_load_dword v17, v3, s[48:51], s42 offen
    buffer_load_dword v81, v3, s[52:55], s42 offen
    s_add_u32 s42, s43, 14336
    buffer_load_dword v18, v3, s[48:51], s42 offen
    buffer_load_dword v82, v3, s[52:55], s42 offen
    s_add_u32 s42, s43, 16384
    buffer_load_dword v19, v3, s[48:51], s42 offen
    buffer_load_dword v83, v3, s[52:55], s42 offen
    s_add_u32 s42, s43, 18432
    buffer_load_dword v20, v3, s[48:51], s42 offen
    buffer_load_dword v84, v3, s[52:55], s42 offen
    s_add_u32 s42, s43, 20480
    buffer_load_dword v21, v3, s[48:51], s42 offen
    buffer_load_dword v85, v3, s[52:55], s42 offen
    s_add_u32 s42, s43, 22528
    buffer_load_dword v22, v3, s[48:51], s42 offen
    buffer_load_dword v86, v3, s[52:55], s42 offen
    s_add_u32 s42, s43, 24576
    buffer_load_dword v23, v3, s[48:51], s42 offen
    buffer_load_dword v87, v3, s[52:55], s42 offen
    s_add_u32 s42, s43, 26624
    buffer_load_dword v24, v3, s[48:51], s42 offen
    buffer_load_dword v88, v3, s[52:55], s42 offen
    s_add_u32 s42, s43, 28672
    buffer_load_dword v25, v3, s[48:51], s42 offen
    buffer_load_dword v89, v3, s[52:55], s42 offen
    s_add_u32 s42, s43, 30720
    buffer_load_dword v26, v3, s[48:51], s42 offen
    buffer_load_dword v90, v3, s[52:55], s42 offen
    s_add_u32 s42, s43, 32768
    buffer_load_dword v27, v3, s[48:51], s42 offen
    buffer_load_dword v91, v3, s[52:55], s42 offen
    s_add_u32 s42, s43, 34816
    buffer_load_dword v28, v3, s[48:51], s42 offen
    buffer_load_dword v92, v3, s[52:55], s42 offen
    s_add_u32 s42, s43, 36864
    buffer_load_dword v29, v3, s[48:51], s42 offen
    buffer_load_dword v93, v3, s[52:55], s42 offen
    s_add_u32 s42, s43, 38912
    buffer_load_dword v30, v3, s[48:51], s42 offen
    buffer_load_dword v94, v3, s[52:55], s42 offen
    s_add_u32 s42, s43, 40960
    buffer_load_dword v31, v3, s[48:51], s42 offen
    buffer_load_dword v95, v3, s[52:55], s42 offen
    s_add_u32 s42, s43, 43008
    buffer_load_dword v32, v3, s[48:51], s42 offen
    buffer_load_dword v96, v3, s[52:55], s42 offen
    s_add_u32 s42, s43, 45056
    buffer_load_dword v33, v3, s[48:51], s42 offen
    buffer_load_dword v97, v3, s[52:55], s42 offen
    s_add_u32 s42, s43, 47104
    buffer_load_dword v34, v3, s[48:51], s42 offen
    buffer_load_dword v98, v3, s[52:55], s42 offen
    s_add_u32 s42, s43, 49152
    buffer_load_dword v35, v3, s[48:51], s42 offen
    buffer_load_dword v99, v3, s[52:55], s42 offen
    s_add_u32 s42, s43, 51200
    buffer_load_dword v36, v3, s[48:51], s42 offen
    buffer_load_dword v100, v3, s[52:55], s42 offen
    s_add_u32 s42, s43, 53248
    buffer_load_dword v37, v3, s[48:51], s42 offen
    buffer_load_dword v101, v3, s[52:55], s42 offen
    s_add_u32 s42, s43, 55296
    buffer_load_dword v38, v3, s[48:51], s42 offen
    buffer_load_dword v102, v3, s[52:55], s42 offen
    s_add_u32 s42, s43, 57344
    buffer_load_dword v39, v3, s[48:51], s42 offen
    buffer_load_dword v103, v3, s[52:55], s42 offen
    s_add_u32 s42, s43, 59392
    buffer_load_dword v40, v3, s[48:51], s42 offen
    buffer_load_dword v104, v3, s[52:55], s42 offen
    s_add_u32 s42, s43, 61440
    buffer_load_dword v41, v3, s[48:51], s42 offen
    buffer_load_dword v105, v3, s[52:55], s42 offen
    s_waitcnt vmcnt(36)
    s_add_u32 s42, s43, 63488
    buffer_load_dword v42, v3, s[48:51], s42 offen
    buffer_load_dword v106, v3, s[52:55], s42 offen
    s_add_u32 s42, s43, 65536
    buffer_load_dword v43, v3, s[48:51], s42 offen
    buffer_load_dword v107, v3, s[52:55], s42 offen
    s_add_u32 s42, s43, 67584
    buffer_load_dword v44, v3, s[48:51], s42 offen
    buffer_load_dword v108, v3, s[52:55], s42 offen
    s_add_u32 s42, s43, 69632
    buffer_load_dword v45, v3, s[48:51], s42 offen
    buffer_load_dword v109, v3, s[52:55], s42 offen
    s_add_u32 s42, s43, 71680
    buffer_load_dword v46, v3, s[48:51], s42 offen
    buffer_load_dword v110, v3, s[52:55], s42 offen
    s_add_u32 s42, s43, 73728
    buffer_load_dword v47, v3, s[48:51], s42 offen
    buffer_load_dword v111, v3, s[52:55], s42 offen
    s_add_u32 s42, s43, 75776
    buffer_load_dword v48, v3, s[48:51], s42 offen
    buffer_load_dword v112, v3, s[52:55], s42 offen
    s_add_u32 s42, s43, 77824
    buffer_load_dword v49, v3, s[48:51], s42 offen
    buffer_load_dword v113, v3, s[52:55], s42 offen
    s_add_u32 s42, s43, 79872
    buffer_load_dword v50, v3, s[48:51], s42 offen
    buffer_load_dword v114, v3, s[52:55], s42 offen
    s_add_u32 s42, s43, 81920
    buffer_load_dword v51, v3, s[48:51], s42 offen
    buffer_load_dword v115, v3, s[52:55], s42 offen
    s_waitcnt vmcnt(36)
    s_add_u32 s42, s43, 83968
    buffer_load_dword v52, v3, s[48:51], s42 offen
    buffer_load_dword v116, v3, s[52:55], s42 offen
    s_add_u32 s42, s43, 86016
    buffer_load_dword v53, v3, s[48:51], s42 offen
    buffer_load_dword v117, v3, s[52:55], s42 offen
    s_add_u32 s42, s43, 88064
    buffer_load_dword v54, v3, s[48:51], s42 offen
    buffer_load_dword v118, v3, s[52:55], s42 offen
    s_add_u32 s42, s43, 90112
    buffer_load_dword v55, v3, s[48:51], s42 offen
    buffer_load_dword v119, v3, s[52:55], s42 offen
    s_add_u32 s42, s43, 92160
    buffer_load_dword v56, v3, s[48:51], s42 offen
    buffer_load_dword v120, v3, s[52:55], s42 offen
    s_add_u32 s42, s43, 94208
    buffer_load_dword v57, v3, s[48:51], s42 offen
    buffer_load_dword v121, v3, s[52:55], s42 offen
    s_add_u32 s42, s43, 96256
    buffer_load_dword v58, v3, s[48:51], s42 offen
    buffer_load_dword v122, v3, s[52:55], s42 offen
    s_add_u32 s42, s43, 98304
    buffer_load_dword v59, v3, s[48:51], s42 offen
    buffer_load_dword v123, v3, s[52:55], s42 offen
    s_add_u32 s42, s43, 100352
    buffer_load_dword v60, v3, s[48:51], s42 offen
    buffer_load_dword v124, v3, s[52:55], s42 offen
    s_add_u32 s42, s43, 102400
    buffer_load_dword v61, v3, s[48:51], s42 offen
    buffer_load_dword v125, v3, s[52:55], s42 offen
    s_waitcnt vmcnt(36)
    s_add_u32 s42, s43, 104448
    buffer_load_dword v62, v3, s[48:51], s42 offen
    buffer_load_dword v126, v3, s[52:55], s42 offen
    s_add_u32 s42, s43, 106496
    buffer_load_dword v63, v3, s[48:51], s42 offen
    buffer_load_dword v127, v3, s[52:55], s42 offen
    s_add_u32 s42, s43, 108544
    buffer_load_dword v64, v3, s[48:51], s42 offen
    buffer_load_dword v128, v3, s[52:55], s42 offen
    s_add_u32 s42, s43, 110592
    buffer_load_dword v65, v3, s[48:51], s42 offen
    buffer_load_dword v129, v3, s[52:55], s42 offen
    s_add_u32 s42, s43, 112640
    buffer_load_dword v66, v3, s[48:51], s42 offen
    buffer_load_dword v130, v3, s[52:55], s42 offen
    s_add_u32 s42, s43, 114688
    buffer_load_dword v67, v3, s[48:51], s42 offen
    buffer_load_dword v131, v3, s[52:55], s42 offen
    s_add_u32 s42, s43, 116736
    buffer_load_dword v68, v3, s[48:51], s42 offen
    buffer_load_dword v132, v3, s[52:55], s42 offen
    s_add_u32 s42, s43, 118784
    buffer_load_dword v69, v3, s[48:51], s42 offen
    buffer_load_dword v133, v3, s[52:55], s42 offen
    s_add_u32 s42, s43, 120832
    buffer_load_dword v70, v3, s[48:51], s42 offen
    buffer_load_dword v134, v3, s[52:55], s42 offen
    s_add_u32 s42, s43, 122880
    buffer_load_dword v71, v3, s[48:51], s42 offen
    buffer_load_dword v135, v3, s[52:55], s42 offen
    s_waitcnt vmcnt(36)
    s_add_u32 s42, s43, 124928
    buffer_load_dword v72, v3, s[48:51], s42 offen
    buffer_load_dword v136, v3, s[52:55], s42 offen
    s_add_u32 s42, s43, 126976
    buffer_load_dword v73, v3, s[48:51], s42 offen
    buffer_load_dword v137, v3, s[52:55], s42 offen
    s_add_u32 s42, s43, 129024
    buffer_load_dword v74, v3, s[48:51], s42 offen
    buffer_load_dword v138, v3, s[52:55], s42 offen
    s_add_u32 s42, s43, 131072
    buffer_load_dword v75, v3, s[48:51], s42 offen
    buffer_load_dword v139, v3, s[52:55], s42 offen
    s_add_u32 s42, s43, 133120
    buffer_load_dword v76, v3, s[48:51], s42 offen
    buffer_load_dword v140, v3, s[52:55], s42 offen
    s_add_u32 s42, s43, 135168
    buffer_load_dword v77, v3, s[48:51], s42 offen
    buffer_load_dword v141, v3, s[52:55], s42 offen
    s_add_u32 s42, s43, 137216
    buffer_load_dword v78, v3, s[48:51], s42 offen
    buffer_load_dword v142, v3, s[52:55], s42 offen
    s_add_u32 s20, s38, 67108864
    s_addc_u32 s21, s39, 0
    s_mov_b32 s22, 430080
    s_mov_b32 s23, 0x00020000
    s_cmp_ge_u32 s40, 2
    s_cbranch_scc1 G1_nozero
    s_mul_i32 s42, s41, 104
    s_add_u32 s43, s41, 3328
    v_add_u32 v5, s42, v0
    v_mov_b32 v8, s43
    v_cmp_eq_u32 vcc, 0x68, v0
    v_mov_b32 v9, 0
    s_nop 0
    v_cndmask_b32 v5, v5, v8, vcc
    v_lshlrev_b32 v5, 7, v5
    v_cmp_ge_u32 vcc, 0x68, v0
    s_and_saveexec_b64 s[42:43], vcc
    buffer_store_dword v9, v5, s[20:23], 0 offen sc1
    s_mov_b64 exec, -1
G1_nozero:
    s_mul_i32 s42, s40, 9216
    v_mul_u32_u24 v5, 144, v2
    v_add_u32 v5, s42, v5
    v_lshrrev_b32 v6, 3, v2
    v_lshlrev_b32 v8, 13, v6
    v_mul_u32_u24 v6, 144, v6
    v_and_b32 v7, 7, v2
    v_lshlrev_b32 v7, 4, v7
    v_add3_u32 v6, v6, v7, s42
    s_lshl_b32 s43, s40, 19
    s_lshl_b32 s44, s41, 7
    s_sub_u32 s44, 3968, s44
    s_add_u32 s43, s43, s44
    v_add3_u32 v7, v7, v8, s43
G1_prep2:
    s_waitcnt vmcnt(0)
    v_lshlrev_b32 v156, 16, v144
    v_and_b32 v157, 0xffff0000, v144
    v_lshlrev_b32 v158, 16, v145
    v_and_b32 v159, 0xffff0000, v145
    v_lshlrev_b32 v165, 16, v12
    v_lshlrev_b32 v166, 16, v13
    v_lshlrev_b32 v167, 16, v14
    v_lshlrev_b32 v168, 16, v15
    v_lshlrev_b32 v169, 16, v16
    v_lshlrev_b32 v170, 16, v17
    v_lshlrev_b32 v171, 16, v18
    v_lshlrev_b32 v172, 16, v19
    v_lshlrev_b32 v173, 16, v20
    v_lshlrev_b32 v174, 16, v21
    v_lshlrev_b32 v175, 16, v22
    v_mul_f32 v177, v165, v159
    v_mul_f32 v178, v166, v159
    v_mul_f32 v179, v167, v159
    v_mul_f32 v180, v168, v159
    v_mul_f32 v181, v169, v159
    v_mul_f32 v182, v170, v159
    v_mul_f32 v183, v171, v159
    v_mul_f32 v184, v172, v159
    v_fmac_f32 v177, v166, v158
    v_fmac_f32 v178, v167, v158
    v_fmac_f32 v179, v168, v158
    v_fmac_f32 v180, v169, v158
    v_fmac_f32 v181, v170, v158
    v_fmac_f32 v182, v171, v158
    v_fmac_f32 v183, v172, v158
    v_fmac_f32 v184, v173, v158
    v_fmac_f32 v177, v167, v157
    v_fmac_f32 v178, v168, v157
    v_fmac_f32 v179, v169, v157
    v_fmac_f32 v180, v170, v157
    v_fmac_f32 v181, v171, v157
    v_fmac_f32 v182, v172, v157
    v_fmac_f32 v183, v173, v157
    v_fmac_f32 v184, v174, v157
    v_fmac_f32 v177, v168, v156
    v_fmac_f32 v178, v169, v156
    v_fmac_f32 v179, v170, v156
    v_fmac_f32 v180, v171, v156
    v_fmac_f32 v181, v172, v156
    v_fmac_f32 v182, v173, v156
    v_fmac_f32 v183, v174, v156
    v_fmac_f32 v184, v175, v156
    v_cvt_pk_bf16_f32 v196, v177, v178
    v_lshlrev_b32 v177, 16, v196
    v_and_b32 v178, 0xffff0000, v196
    v_cvt_pk_bf16_f32 v196, v179, v180
    v_lshlrev_b32 v179, 16, v196
    v_and_b32 v180, 0xffff0000, v196
    v_cvt_pk_bf16_f32 v196, v181, v182
    v_lshlrev_b32 v181, 16, v196
    v_and_b32 v182, 0xffff0000, v196
    v_cvt_pk_bf16_f32 v196, v183, v184
    v_lshlrev_b32 v183, 16, v196
    v_and_b32 v184, 0xffff0000, v196
    v_lshlrev_b32 v198, 16, v79
    v_mul_f32 v177, v177, v198
    v_lshlrev_b32 v197, 16, v80
    v_mul_f32 v178, v178, v197
    v_lshlrev_b32 v198, 16, v81
    v_mul_f32 v179, v179, v198
    v_lshlrev_b32 v197, 16, v82
    v_mul_f32 v180, v180, v197
    v_lshlrev_b32 v198, 16, v83
    v_mul_f32 v181, v181, v198
    v_lshlrev_b32 v197, 16, v84
    v_mul_f32 v182, v182, v197
    v_lshlrev_b32 v198, 16, v85
    v_mul_f32 v183, v183, v198
    v_lshlrev_b32 v197, 16, v86
    v_mul_f32 v184, v184, v197
    v_cvt_pk_bf16_f32 v192, v184, v183
    v_cvt_pk_bf16_f32 v193, v182, v181
    v_cvt_pk_bf16_f32 v194, v180, v179
    v_cvt_pk_bf16_f32 v195, v178, v177
    ds_write_b128 v5, v[192:195] offset:112
    v_lshlrev_b32 v165, 16, v20
    v_lshlrev_b32 v166, 16, v21
    v_lshlrev_b32 v167, 16, v22
    v_lshlrev_b32 v168, 16, v23
    v_lshlrev_b32 v169, 16, v24
    v_lshlrev_b32 v170, 16, v25
    v_lshlrev_b32 v171, 16, v26
    v_lshlrev_b32 v172, 16, v27
    v_lshlrev_b32 v173, 16, v28
    v_lshlrev_b32 v174, 16, v29
    v_lshlrev_b32 v175, 16, v30
    v_mul_f32 v177, v165, v159
    v_mul_f32 v178, v166, v159
    v_mul_f32 v179, v167, v159
    v_mul_f32 v180, v168, v159
    v_mul_f32 v181, v169, v159
    v_mul_f32 v182, v170, v159
    v_mul_f32 v183, v171, v159
    v_mul_f32 v184, v172, v159
    v_fmac_f32 v177, v166, v158
    v_fmac_f32 v178, v167, v158
    v_fmac_f32 v179, v168, v158
    v_fmac_f32 v180, v169, v158
    v_fmac_f32 v181, v170, v158
    v_fmac_f32 v182, v171, v158
    v_fmac_f32 v183, v172, v158
    v_fmac_f32 v184, v173, v158
    v_fmac_f32 v177, v167, v157
    v_fmac_f32 v178, v168, v157
    v_fmac_f32 v179, v169, v157
    v_fmac_f32 v180, v170, v157
    v_fmac_f32 v181, v171, v157
    v_fmac_f32 v182, v172, v157
    v_fmac_f32 v183, v173, v157
    v_fmac_f32 v184, v174, v157
    v_fmac_f32 v177, v168, v156
    v_fmac_f32 v178, v169, v156
    v_fmac_f32 v179, v170, v156
    v_fmac_f32 v180, v171, v156
    v_fmac_f32 v181, v172, v156
    v_fmac_f32 v182, v173, v156
    v_fmac_f32 v183, v174, v156
    v_fmac_f32 v184, v175, v156
    v_cvt_pk_bf16_f32 v196, v177, v178
    v_lshlrev_b32 v177, 16, v196
    v_and_b32 v178, 0xffff0000, v196
    v_cvt_pk_bf16_f32 v196, v179, v180
    v_lshlrev_b32 v179, 16, v196
    v_and_b32 v180, 0xffff0000, v196
    v_cvt_pk_bf16_f32 v196, v181, v182
    v_lshlrev_b32 v181, 16, v196
    v_and_b32 v182, 0xffff0000, v196
    v_cvt_pk_bf16_f32 v196, v183, v184
    v_lshlrev_b32 v183, 16, v196
    v_and_b32 v184, 0xffff0000, v196
    v_lshlrev_b32 v198, 16, v87
    v_mul_f32 v177, v177, v198
    v_lshlrev_b32 v197, 16, v88
    v_mul_f32 v178, v178, v197
    v_lshlrev_b32 v198, 16, v89
    v_mul_f32 v179, v179, v198
    v_lshlrev_b32 v197, 16, v90
    v_mul_f32 v180, v180, v197
    v_lshlrev_b32 v198, 16, v91
    v_mul_f32 v181, v181, v198
    v_lshlrev_b32 v197, 16, v92
    v_mul_f32 v182, v182, v197
    v_lshlrev_b32 v198, 16, v93
    v_mul_f32 v183, v183, v198
    v_lshlrev_b32 v197, 16, v94
    v_mul_f32 v184, v184, v197
    v_cvt_pk_bf16_f32 v192, v184, v183
    v_cvt_pk_bf16_f32 v193, v182, v181
    v_cvt_pk_bf16_f32 v194, v180, v179
    v_cvt_pk_bf16_f32 v195, v178, v177
    ds_write_b128 v5, v[192:195] offset:96
    v_lshlrev_b32 v165, 16, v28
    v_lshlrev_b32 v166, 16, v29
    v_lshlrev_b32 v167, 16, v30
    v_lshlrev_b32 v168, 16, v31
    v_lshlrev_b32 v169, 16, v32
    v_lshlrev_b32 v170, 16, v33
    v_lshlrev_b32 v171, 16, v34
    v_lshlrev_b32 v172, 16, v35
    v_lshlrev_b32 v173, 16, v36
    v_lshlrev_b32 v174, 16, v37
    v_lshlrev_b32 v175, 16, v38
    v_mul_f32 v177, v165, v159
    v_mul_f32 v178, v166, v159
    v_mul_f32 v179, v167, v159
    v_mul_f32 v180, v168, v159
    v_mul_f32 v181, v169, v159
    v_mul_f32 v182, v170, v159
    v_mul_f32 v183, v171, v159
    v_mul_f32 v184, v172, v159
    v_fmac_f32 v177, v166, v158
    v_fmac_f32 v178, v167, v158
    v_fmac_f32 v179, v168, v158
    v_fmac_f32 v180, v169, v158
    v_fmac_f32 v181, v170, v158
    v_fmac_f32 v182, v171, v158
    v_fmac_f32 v183, v172, v158
    v_fmac_f32 v184, v173, v158
    v_fmac_f32 v177, v167, v157
    v_fmac_f32 v178, v168, v157
    v_fmac_f32 v179, v169, v157
    v_fmac_f32 v180, v170, v157
    v_fmac_f32 v181, v171, v157
    v_fmac_f32 v182, v172, v157
    v_fmac_f32 v183, v173, v157
    v_fmac_f32 v184, v174, v157
    v_fmac_f32 v177, v168, v156
    v_fmac_f32 v178, v169, v156
    v_fmac_f32 v179, v170, v156
    v_fmac_f32 v180, v171, v156
    v_fmac_f32 v181, v172, v156
    v_fmac_f32 v182, v173, v156
    v_fmac_f32 v183, v174, v156
    v_fmac_f32 v184, v175, v156
    v_cvt_pk_bf16_f32 v196, v177, v178
    v_lshlrev_b32 v177, 16, v196
    v_and_b32 v178, 0xffff0000, v196
    v_cvt_pk_bf16_f32 v196, v179, v180
    v_lshlrev_b32 v179, 16, v196
    v_and_b32 v180, 0xffff0000, v196
    v_cvt_pk_bf16_f32 v196, v181, v182
    v_lshlrev_b32 v181, 16, v196
    v_and_b32 v182, 0xffff0000, v196
    v_cvt_pk_bf16_f32 v196, v183, v184
    v_lshlrev_b32 v183, 16, v196
    v_and_b32 v184, 0xffff0000, v196
    v_lshlrev_b32 v198, 16, v95
    v_mul_f32 v177, v177, v198
    v_lshlrev_b32 v197, 16, v96
    v_mul_f32 v178, v178, v197
    v_lshlrev_b32 v198, 16, v97
    v_mul_f32 v179, v179, v198
    v_lshlrev_b32 v197, 16, v98
    v_mul_f32 v180, v180, v197
    v_lshlrev_b32 v198, 16, v99
    v_mul_f32 v181, v181, v198
    v_lshlrev_b32 v197, 16, v100
    v_mul_f32 v182, v182, v197
    v_lshlrev_b32 v198, 16, v101
    v_mul_f32 v183, v183, v198
    v_lshlrev_b32 v197, 16, v102
    v_mul_f32 v184, v184, v197
    v_cvt_pk_bf16_f32 v192, v184, v183
    v_cvt_pk_bf16_f32 v193, v182, v181
    v_cvt_pk_bf16_f32 v194, v180, v179
    v_cvt_pk_bf16_f32 v195, v178, v177
    ds_write_b128 v5, v[192:195] offset:80
    v_lshlrev_b32 v165, 16, v36
    v_lshlrev_b32 v166, 16, v37
    v_lshlrev_b32 v167, 16, v38
    v_lshlrev_b32 v168, 16, v39
    v_lshlrev_b32 v169, 16, v40
    v_lshlrev_b32 v170, 16, v41
    v_lshlrev_b32 v171, 16, v42
    v_lshlrev_b32 v172, 16, v43
    v_lshlrev_b32 v173, 16, v44
    v_lshlrev_b32 v174, 16, v45
    v_lshlrev_b32 v175, 16, v46
    v_mul_f32 v177, v165, v159
    v_mul_f32 v178, v166, v159
    v_mul_f32 v179, v167, v159
    v_mul_f32 v180, v168, v159
    v_mul_f32 v181, v169, v159
    v_mul_f32 v182, v170, v159
    v_mul_f32 v183, v171, v159
    v_mul_f32 v184, v172, v159
    v_fmac_f32 v177, v166, v158
    v_fmac_f32 v178, v167, v158
    v_fmac_f32 v179, v168, v158
    v_fmac_f32 v180, v169, v158
    v_fmac_f32 v181, v170, v158
    v_fmac_f32 v182, v171, v158
    v_fmac_f32 v183, v172, v158
    v_fmac_f32 v184, v173, v158
    v_fmac_f32 v177, v167, v157
    v_fmac_f32 v178, v168, v157
    v_fmac_f32 v179, v169, v157
    v_fmac_f32 v180, v170, v157
    v_fmac_f32 v181, v171, v157
    v_fmac_f32 v182, v172, v157
    v_fmac_f32 v183, v173, v157
    v_fmac_f32 v184, v174, v157
    v_fmac_f32 v177, v168, v156
    v_fmac_f32 v178, v169, v156
    v_fmac_f32 v179, v170, v156
    v_fmac_f32 v180, v171, v156
    v_fmac_f32 v181, v172, v156
    v_fmac_f32 v182, v173, v156
    v_fmac_f32 v183, v174, v156
    v_fmac_f32 v184, v175, v156
    v_cvt_pk_bf16_f32 v196, v177, v178
    v_lshlrev_b32 v177, 16, v196
    v_and_b32 v178, 0xffff0000, v196
    v_cvt_pk_bf16_f32 v196, v179, v180
    v_lshlrev_b32 v179, 16, v196
    v_and_b32 v180, 0xffff0000, v196
    v_cvt_pk_bf16_f32 v196, v181, v182
    v_lshlrev_b32 v181, 16, v196
    v_and_b32 v182, 0xffff0000, v196
    v_cvt_pk_bf16_f32 v196, v183, v184
    v_lshlrev_b32 v183, 16, v196
    v_and_b32 v184, 0xffff0000, v196
    v_lshlrev_b32 v198, 16, v103
    v_mul_f32 v177, v177, v198
    v_lshlrev_b32 v197, 16, v104
    v_mul_f32 v178, v178, v197
    v_lshlrev_b32 v198, 16, v105
    v_mul_f32 v179, v179, v198
    v_lshlrev_b32 v197, 16, v106
    v_mul_f32 v180, v180, v197
    v_lshlrev_b32 v198, 16, v107
    v_mul_f32 v181, v181, v198
    v_lshlrev_b32 v197, 16, v108
    v_mul_f32 v182, v182, v197
    v_lshlrev_b32 v198, 16, v109
    v_mul_f32 v183, v183, v198
    v_lshlrev_b32 v197, 16, v110
    v_mul_f32 v184, v184, v197
    v_cvt_pk_bf16_f32 v192, v184, v183
    v_cvt_pk_bf16_f32 v193, v182, v181
    v_cvt_pk_bf16_f32 v194, v180, v179
    v_cvt_pk_bf16_f32 v195, v178, v177
    ds_write_b128 v5, v[192:195] offset:64
    v_lshlrev_b32 v165, 16, v44
    v_lshlrev_b32 v166, 16, v45
    v_lshlrev_b32 v167, 16, v46
    v_lshlrev_b32 v168, 16, v47
    v_lshlrev_b32 v169, 16, v48
    v_lshlrev_b32 v170, 16, v49
    v_lshlrev_b32 v171, 16, v50
    v_lshlrev_b32 v172, 16, v51
    v_lshlrev_b32 v173, 16, v52
    v_lshlrev_b32 v174, 16, v53
    v_lshlrev_b32 v175, 16, v54
    v_mul_f32 v177, v165, v159
    v_mul_f32 v178, v166, v159
    v_mul_f32 v179, v167, v159
    v_mul_f32 v180, v168, v159
    v_mul_f32 v181, v169, v159
    v_mul_f32 v182, v170, v159
    v_mul_f32 v183, v171, v159
    v_mul_f32 v184, v172, v159
    v_fmac_f32 v177, v166, v158
    v_fmac_f32 v178, v167, v158
    v_fmac_f32 v179, v168, v158
    v_fmac_f32 v180, v169, v158
    v_fmac_f32 v181, v170, v158
    v_fmac_f32 v182, v171, v158
    v_fmac_f32 v183, v172, v158
    v_fmac_f32 v184, v173, v158
    v_fmac_f32 v177, v167, v157
    v_fmac_f32 v178, v168, v157
    v_fmac_f32 v179, v169, v157
    v_fmac_f32 v180, v170, v157
    v_fmac_f32 v181, v171, v157
    v_fmac_f32 v182, v172, v157
    v_fmac_f32 v183, v173, v157
    v_fmac_f32 v184, v174, v157
    v_fmac_f32 v177, v168, v156
    v_fmac_f32 v178, v169, v156
    v_fmac_f32 v179, v170, v156
    v_fmac_f32 v180, v171, v156
    v_fmac_f32 v181, v172, v156
    v_fmac_f32 v182, v173, v156
    v_fmac_f32 v183, v174, v156
    v_fmac_f32 v184, v175, v156
    v_cvt_pk_bf16_f32 v196, v177, v178
    v_lshlrev_b32 v177, 16, v196
    v_and_b32 v178, 0xffff0000, v196
    v_cvt_pk_bf16_f32 v196, v179, v180
    v_lshlrev_b32 v179, 16, v196
    v_and_b32 v180, 0xffff0000, v196
    v_cvt_pk_bf16_f32 v196, v181, v182
    v_lshlrev_b32 v181, 16, v196
    v_and_b32 v182, 0xffff0000, v196
    v_cvt_pk_bf16_f32 v196, v183, v184
    v_lshlrev_b32 v183, 16, v196
    v_and_b32 v184, 0xffff0000, v196
    v_lshlrev_b32 v198, 16, v111
    v_mul_f32 v177, v177, v198
    v_lshlrev_b32 v197, 16, v112
    v_mul_f32 v178, v178, v197
    v_lshlrev_b32 v198, 16, v113
    v_mul_f32 v179, v179, v198
    v_lshlrev_b32 v197, 16, v114
    v_mul_f32 v180, v180, v197
    v_lshlrev_b32 v198, 16, v115
    v_mul_f32 v181, v181, v198
    v_lshlrev_b32 v197, 16, v116
    v_mul_f32 v182, v182, v197
    v_lshlrev_b32 v198, 16, v117
    v_mul_f32 v183, v183, v198
    v_lshlrev_b32 v197, 16, v118
    v_mul_f32 v184, v184, v197
    v_cvt_pk_bf16_f32 v192, v184, v183
    v_cvt_pk_bf16_f32 v193, v182, v181
    v_cvt_pk_bf16_f32 v194, v180, v179
    v_cvt_pk_bf16_f32 v195, v178, v177
    ds_write_b128 v5, v[192:195] offset:48
    v_lshlrev_b32 v165, 16, v52
    v_lshlrev_b32 v166, 16, v53
    v_lshlrev_b32 v167, 16, v54
    v_lshlrev_b32 v168, 16, v55
    v_lshlrev_b32 v169, 16, v56
    v_lshlrev_b32 v170, 16, v57
    v_lshlrev_b32 v171, 16, v58
    v_lshlrev_b32 v172, 16, v59
    v_lshlrev_b32 v173, 16, v60
    v_lshlrev_b32 v174, 16, v61
    v_lshlrev_b32 v175, 16, v62
    v_mul_f32 v177, v165, v159
    v_mul_f32 v178, v166, v159
    v_mul_f32 v179, v167, v159
    v_mul_f32 v180, v168, v159
    v_mul_f32 v181, v169, v159
    v_mul_f32 v182, v170, v159
    v_mul_f32 v183, v171, v159
    v_mul_f32 v184, v172, v159
    v_fmac_f32 v177, v166, v158
    v_fmac_f32 v178, v167, v158
    v_fmac_f32 v179, v168, v158
    v_fmac_f32 v180, v169, v158
    v_fmac_f32 v181, v170, v158
    v_fmac_f32 v182, v171, v158
    v_fmac_f32 v183, v172, v158
    v_fmac_f32 v184, v173, v158
    v_fmac_f32 v177, v167, v157
    v_fmac_f32 v178, v168, v157
    v_fmac_f32 v179, v169, v157
    v_fmac_f32 v180, v170, v157
    v_fmac_f32 v181, v171, v157
    v_fmac_f32 v182, v172, v157
    v_fmac_f32 v183, v173, v157
    v_fmac_f32 v184, v174, v157
    v_fmac_f32 v177, v168, v156
    v_fmac_f32 v178, v169, v156
    v_fmac_f32 v179, v170, v156
    v_fmac_f32 v180, v171, v156
    v_fmac_f32 v181, v172, v156
    v_fmac_f32 v182, v173, v156
    v_fmac_f32 v183, v174, v156
    v_fmac_f32 v184, v175, v156
    v_cvt_pk_bf16_f32 v196, v177, v178
    v_lshlrev_b32 v177, 16, v196
    v_and_b32 v178, 0xffff0000, v196
    v_cvt_pk_bf16_f32 v196, v179, v180
    v_lshlrev_b32 v179, 16, v196
    v_and_b32 v180, 0xffff0000, v196
    v_cvt_pk_bf16_f32 v196, v181, v182
    v_lshlrev_b32 v181, 16, v196
    v_and_b32 v182, 0xffff0000, v196
    v_cvt_pk_bf16_f32 v196, v183, v184
    v_lshlrev_b32 v183, 16, v196
    v_and_b32 v184, 0xffff0000, v196
    v_lshlrev_b32 v198, 16, v119
    v_mul_f32 v177, v177, v198
    v_lshlrev_b32 v197, 16, v120
    v_mul_f32 v178, v178, v197
    v_lshlrev_b32 v198, 16, v121
    v_mul_f32 v179, v179, v198
    v_lshlrev_b32 v197, 16, v122
    v_mul_f32 v180, v180, v197
    v_lshlrev_b32 v198, 16, v123
    v_mul_f32 v181, v181, v198
    v_lshlrev_b32 v197, 16, v124
    v_mul_f32 v182, v182, v197
    v_lshlrev_b32 v198, 16, v125
    v_mul_f32 v183, v183, v198
    v_lshlrev_b32 v197, 16, v126
    v_mul_f32 v184, v184, v197
    v_cvt_pk_bf16_f32 v192, v184, v183
    v_cvt_pk_bf16_f32 v193, v182, v181
    v_cvt_pk_bf16_f32 v194, v180, v179
    v_cvt_pk_bf16_f32 v195, v178, v177
    ds_write_b128 v5, v[192:195] offset:32
    v_lshlrev_b32 v165, 16, v60
    v_lshlrev_b32 v166, 16, v61
    v_lshlrev_b32 v167, 16, v62
    v_lshlrev_b32 v168, 16, v63
    v_lshlrev_b32 v169, 16, v64
    v_lshlrev_b32 v170, 16, v65
    v_lshlrev_b32 v171, 16, v66
    v_lshlrev_b32 v172, 16, v67
    v_lshlrev_b32 v173, 16, v68
    v_lshlrev_b32 v174, 16, v69
    v_lshlrev_b32 v175, 16, v70
    v_mul_f32 v177, v165, v159
    v_mul_f32 v178, v166, v159
    v_mul_f32 v179, v167, v159
    v_mul_f32 v180, v168, v159
    v_mul_f32 v181, v169, v159
    v_mul_f32 v182, v170, v159
    v_mul_f32 v183, v171, v159
    v_mul_f32 v184, v172, v159
    v_fmac_f32 v177, v166, v158
    v_fmac_f32 v178, v167, v158
    v_fmac_f32 v179, v168, v158
    v_fmac_f32 v180, v169, v158
    v_fmac_f32 v181, v170, v158
    v_fmac_f32 v182, v171, v158
    v_fmac_f32 v183, v172, v158
    v_fmac_f32 v184, v173, v158
    v_fmac_f32 v177, v167, v157
    v_fmac_f32 v178, v168, v157
    v_fmac_f32 v179, v169, v157
    v_fmac_f32 v180, v170, v157
    v_fmac_f32 v181, v171, v157
    v_fmac_f32 v182, v172, v157
    v_fmac_f32 v183, v173, v157
    v_fmac_f32 v184, v174, v157
    v_fmac_f32 v177, v168, v156
    v_fmac_f32 v178, v169, v156
    v_fmac_f32 v179, v170, v156
    v_fmac_f32 v180, v171, v156
    v_fmac_f32 v181, v172, v156
    v_fmac_f32 v182, v173, v156
    v_fmac_f32 v183, v174, v156
    v_fmac_f32 v184, v175, v156
    v_cvt_pk_bf16_f32 v196, v177, v178
    v_lshlrev_b32 v177, 16, v196
    v_and_b32 v178, 0xffff0000, v196
    v_cvt_pk_bf16_f32 v196, v179, v180
    v_lshlrev_b32 v179, 16, v196
    v_and_b32 v180, 0xffff0000, v196
    v_cvt_pk_bf16_f32 v196, v181, v182
    v_lshlrev_b32 v181, 16, v196
    v_and_b32 v182, 0xffff0000, v196
    v_cvt_pk_bf16_f32 v196, v183, v184
    v_lshlrev_b32 v183, 16, v196
    v_and_b32 v184, 0xffff0000, v196
    v_lshlrev_b32 v198, 16, v127
    v_mul_f32 v177, v177, v198
    v_lshlrev_b32 v197, 16, v128
    v_mul_f32 v178, v178, v197
    v_lshlrev_b32 v198, 16, v129
    v_mul_f32 v179, v179, v198
    v_lshlrev_b32 v197, 16, v130
    v_mul_f32 v180, v180, v197
    v_lshlrev_b32 v198, 16, v131
    v_mul_f32 v181, v181, v198
    v_lshlrev_b32 v197, 16, v132
    v_mul_f32 v182, v182, v197
    v_lshlrev_b32 v198, 16, v133
    v_mul_f32 v183, v183, v198
    v_lshlrev_b32 v197, 16, v134
    v_mul_f32 v184, v184, v197
    v_cvt_pk_bf16_f32 v192, v184, v183
    v_cvt_pk_bf16_f32 v193, v182, v181
    v_cvt_pk_bf16_f32 v194, v180, v179
    v_cvt_pk_bf16_f32 v195, v178, v177
    ds_write_b128 v5, v[192:195] offset:16
    v_lshlrev_b32 v165, 16, v68
    v_lshlrev_b32 v166, 16, v69
    v_lshlrev_b32 v167, 16, v70
    v_lshlrev_b32 v168, 16, v71
    v_lshlrev_b32 v169, 16, v72
    v_lshlrev_b32 v170, 16, v73
    v_lshlrev_b32 v171, 16, v74
    v_lshlrev_b32 v172, 16, v75
    v_lshlrev_b32 v173, 16, v76
    v_lshlrev_b32 v174, 16, v77
    v_lshlrev_b32 v175, 16, v78
    v_mul_f32 v177, v165, v159
    v_mul_f32 v178, v166, v159
    v_mul_f32 v179, v167, v159
    v_mul_f32 v180, v168, v159
    v_mul_f32 v181, v169, v159
    v_mul_f32 v182, v170, v159
    v_mul_f32 v183, v171, v159
    v_mul_f32 v184, v172, v159
    v_fmac_f32 v177, v166, v158
    v_fmac_f32 v178, v167, v158
    v_fmac_f32 v179, v168, v158
    v_fmac_f32 v180, v169, v158
    v_fmac_f32 v181, v170, v158
    v_fmac_f32 v182, v171, v158
    v_fmac_f32 v183, v172, v158
    v_fmac_f32 v184, v173, v158
    v_fmac_f32 v177, v167, v157
    v_fmac_f32 v178, v168, v157
    v_fmac_f32 v179, v169, v157
    v_fmac_f32 v180, v170, v157
    v_fmac_f32 v181, v171, v157
    v_fmac_f32 v182, v172, v157
    v_fmac_f32 v183, v173, v157
    v_fmac_f32 v184, v174, v157
    v_fmac_f32 v177, v168, v156
    v_fmac_f32 v178, v169, v156
    v_fmac_f32 v179, v170, v156
    v_fmac_f32 v180, v171, v156
    v_fmac_f32 v181, v172, v156
    v_fmac_f32 v182, v173, v156
    v_fmac_f32 v183, v174, v156
    v_fmac_f32 v184, v175, v156
    v_cvt_pk_bf16_f32 v196, v177, v178
    v_lshlrev_b32 v177, 16, v196
    v_and_b32 v178, 0xffff0000, v196
    v_cvt_pk_bf16_f32 v196, v179, v180
    v_lshlrev_b32 v179, 16, v196
    v_and_b32 v180, 0xffff0000, v196
    v_cvt_pk_bf16_f32 v196, v181, v182
    v_lshlrev_b32 v181, 16, v196
    v_and_b32 v182, 0xffff0000, v196
    v_cvt_pk_bf16_f32 v196, v183, v184
    v_lshlrev_b32 v183, 16, v196
    v_and_b32 v184, 0xffff0000, v196
    v_lshlrev_b32 v198, 16, v135
    v_mul_f32 v177, v177, v198
    v_lshlrev_b32 v197, 16, v136
    v_mul_f32 v178, v178, v197
    v_lshlrev_b32 v198, 16, v137
    v_mul_f32 v179, v179, v198
    v_lshlrev_b32 v197, 16, v138
    v_mul_f32 v180, v180, v197
    v_lshlrev_b32 v198, 16, v139
    v_mul_f32 v181, v181, v198
    v_lshlrev_b32 v197, 16, v140
    v_mul_f32 v182, v182, v197
    v_lshlrev_b32 v198, 16, v141
    v_mul_f32 v183, v183, v198
    v_lshlrev_b32 v197, 16, v142
    v_mul_f32 v184, v184, v197
    v_cvt_pk_bf16_f32 v192, v184, v183
    v_cvt_pk_bf16_f32 v193, v182, v181
    v_cvt_pk_bf16_f32 v194, v180, v179
    v_cvt_pk_bf16_f32 v195, v178, v177
    ds_write_b128 v5, v[192:195] offset:0
    s_waitcnt lgkmcnt(0)
    ds_read_b128 v[200:203], v6 offset:0
    ds_read_b128 v[204:207], v6 offset:1152
    ds_read_b128 v[208:211], v6 offset:2304
    ds_read_b128 v[212:215], v6 offset:3456
    ds_read_b128 v[216:219], v6 offset:4608
    ds_read_b128 v[220:223], v6 offset:5760
    ds_read_b128 v[224:227], v6 offset:6912
    ds_read_b128 v[228:231], v6 offset:8064
    s_waitcnt lgkmcnt(7)
    s_mov_b32 s47, 0
    buffer_store_dwordx4 v[200:203], v7, s[60:63], s47 offen sc1
    s_waitcnt lgkmcnt(6)
    s_mov_b32 s47, 65536
    buffer_store_dwordx4 v[204:207], v7, s[60:63], s47 offen sc1
    s_waitcnt lgkmcnt(5)
    s_mov_b32 s47, 131072
    buffer_store_dwordx4 v[208:211], v7, s[60:63], s47 offen sc1
    s_waitcnt lgkmcnt(4)
    s_mov_b32 s47, 196608
    buffer_store_dwordx4 v[212:215], v7, s[60:63], s47 offen sc1
    s_waitcnt lgkmcnt(3)
    s_mov_b32 s47, 262144
    buffer_store_dwordx4 v[216:219], v7, s[60:63], s47 offen sc1
    s_waitcnt lgkmcnt(2)
    s_mov_b32 s47, 327680
    buffer_store_dwordx4 v[220:223], v7, s[60:63], s47 offen sc1
    s_waitcnt lgkmcnt(1)
    s_mov_b32 s47, 393216
    buffer_store_dwordx4 v[224:227], v7, s[60:63], s47 offen sc1
    s_waitcnt lgkmcnt(0)
    s_mov_b32 s47, 458752
    buffer_store_dwordx4 v[228:231], v7, s[60:63], s47 offen sc1
    s_nop 1
    v_lshlrev_b32 v156, 16, v146
    v_and_b32 v157, 0xffff0000, v146
    v_lshlrev_b32 v158, 16, v147
    v_and_b32 v159, 0xffff0000, v147
    v_and_b32 v165, 0xffff0000, v12
    v_and_b32 v166, 0xffff0000, v13
    v_and_b32 v167, 0xffff0000, v14
    v_and_b32 v168, 0xffff0000, v15
    v_and_b32 v169, 0xffff0000, v16
    v_and_b32 v170, 0xffff0000, v17
    v_and_b32 v171, 0xffff0000, v18
    v_and_b32 v172, 0xffff0000, v19
    v_and_b32 v173, 0xffff0000, v20
    v_and_b32 v174, 0xffff0000, v21
    v_and_b32 v175, 0xffff0000, v22
    v_mul_f32 v177, v165, v159
    v_mul_f32 v178, v166, v159
    v_mul_f32 v179, v167, v159
    v_mul_f32 v180, v168, v159
    v_mul_f32 v181, v169, v159
    v_mul_f32 v182, v170, v159
    v_mul_f32 v183, v171, v159
    v_mul_f32 v184, v172, v159
    v_fmac_f32 v177, v166, v158
    v_fmac_f32 v178, v167, v158
    v_fmac_f32 v179, v168, v158
    v_fmac_f32 v180, v169, v158
    v_fmac_f32 v181, v170, v158
    v_fmac_f32 v182, v171, v158
    v_fmac_f32 v183, v172, v158
    v_fmac_f32 v184, v173, v158
    v_fmac_f32 v177, v167, v157
    v_fmac_f32 v178, v168, v157
    v_fmac_f32 v179, v169, v157
    v_fmac_f32 v180, v170, v157
    v_fmac_f32 v181, v171, v157
    v_fmac_f32 v182, v172, v157
    v_fmac_f32 v183, v173, v157
    v_fmac_f32 v184, v174, v157
    v_fmac_f32 v177, v168, v156
    v_fmac_f32 v178, v169, v156
    v_fmac_f32 v179, v170, v156
    v_fmac_f32 v180, v171, v156
    v_fmac_f32 v181, v172, v156
    v_fmac_f32 v182, v173, v156
    v_fmac_f32 v183, v174, v156
    v_fmac_f32 v184, v175, v156
    v_cvt_pk_bf16_f32 v196, v177, v178
    v_lshlrev_b32 v177, 16, v196
    v_and_b32 v178, 0xffff0000, v196
    v_cvt_pk_bf16_f32 v196, v179, v180
    v_lshlrev_b32 v179, 16, v196
    v_and_b32 v180, 0xffff0000, v196
    v_cvt_pk_bf16_f32 v196, v181, v182
    v_lshlrev_b32 v181, 16, v196
    v_and_b32 v182, 0xffff0000, v196
    v_cvt_pk_bf16_f32 v196, v183, v184
    v_lshlrev_b32 v183, 16, v196
    v_and_b32 v184, 0xffff0000, v196
    v_and_b32 v198, 0xffff0000, v79
    v_mul_f32 v177, v177, v198
    v_and_b32 v197, 0xffff0000, v80
    v_mul_f32 v178, v178, v197
    v_and_b32 v198, 0xffff0000, v81
    v_mul_f32 v179, v179, v198
    v_and_b32 v197, 0xffff0000, v82
    v_mul_f32 v180, v180, v197
    v_and_b32 v198, 0xffff0000, v83
    v_mul_f32 v181, v181, v198
    v_and_b32 v197, 0xffff0000, v84
    v_mul_f32 v182, v182, v197
    v_and_b32 v198, 0xffff0000, v85
    v_mul_f32 v183, v183, v198
    v_and_b32 v197, 0xffff0000, v86
    v_mul_f32 v184, v184, v197
    v_cvt_pk_bf16_f32 v192, v184, v183
    v_cvt_pk_bf16_f32 v193, v182, v181
    v_cvt_pk_bf16_f32 v194, v180, v179
    v_cvt_pk_bf16_f32 v195, v178, v177
    ds_write_b128 v5, v[192:195] offset:112
    v_and_b32 v165, 0xffff0000, v20
    v_and_b32 v166, 0xffff0000, v21
    v_and_b32 v167, 0xffff0000, v22
    v_and_b32 v168, 0xffff0000, v23
    v_and_b32 v169, 0xffff0000, v24
    v_and_b32 v170, 0xffff0000, v25
    v_and_b32 v171, 0xffff0000, v26
    v_and_b32 v172, 0xffff0000, v27
    v_and_b32 v173, 0xffff0000, v28
    v_and_b32 v174, 0xffff0000, v29
    v_and_b32 v175, 0xffff0000, v30
    v_mul_f32 v177, v165, v159
    v_mul_f32 v178, v166, v159
    v_mul_f32 v179, v167, v159
    v_mul_f32 v180, v168, v159
    v_mul_f32 v181, v169, v159
    v_mul_f32 v182, v170, v159
    v_mul_f32 v183, v171, v159
    v_mul_f32 v184, v172, v159
    v_fmac_f32 v177, v166, v158
    v_fmac_f32 v178, v167, v158
    v_fmac_f32 v179, v168, v158
    v_fmac_f32 v180, v169, v158
    v_fmac_f32 v181, v170, v158
    v_fmac_f32 v182, v171, v158
    v_fmac_f32 v183, v172, v158
    v_fmac_f32 v184, v173, v158
    v_fmac_f32 v177, v167, v157
    v_fmac_f32 v178, v168, v157
    v_fmac_f32 v179, v169, v157
    v_fmac_f32 v180, v170, v157
    v_fmac_f32 v181, v171, v157
    v_fmac_f32 v182, v172, v157
    v_fmac_f32 v183, v173, v157
    v_fmac_f32 v184, v174, v157
    v_fmac_f32 v177, v168, v156
    v_fmac_f32 v178, v169, v156
    v_fmac_f32 v179, v170, v156
    v_fmac_f32 v180, v171, v156
    v_fmac_f32 v181, v172, v156
    v_fmac_f32 v182, v173, v156
    v_fmac_f32 v183, v174, v156
    v_fmac_f32 v184, v175, v156
    v_cvt_pk_bf16_f32 v196, v177, v178
    v_lshlrev_b32 v177, 16, v196
    v_and_b32 v178, 0xffff0000, v196
    v_cvt_pk_bf16_f32 v196, v179, v180
    v_lshlrev_b32 v179, 16, v196
    v_and_b32 v180, 0xffff0000, v196
    v_cvt_pk_bf16_f32 v196, v181, v182
    v_lshlrev_b32 v181, 16, v196
    v_and_b32 v182, 0xffff0000, v196
    v_cvt_pk_bf16_f32 v196, v183, v184
    v_lshlrev_b32 v183, 16, v196
    v_and_b32 v184, 0xffff0000, v196
    v_and_b32 v198, 0xffff0000, v87
    v_mul_f32 v177, v177, v198
    v_and_b32 v197, 0xffff0000, v88
    v_mul_f32 v178, v178, v197
    v_and_b32 v198, 0xffff0000, v89
    v_mul_f32 v179, v179, v198
    v_and_b32 v197, 0xffff0000, v90
    v_mul_f32 v180, v180, v197
    v_and_b32 v198, 0xffff0000, v91
    v_mul_f32 v181, v181, v198
    v_and_b32 v197, 0xffff0000, v92
    v_mul_f32 v182, v182, v197
    v_and_b32 v198, 0xffff0000, v93
    v_mul_f32 v183, v183, v198
    v_and_b32 v197, 0xffff0000, v94
    v_mul_f32 v184, v184, v197
    v_cvt_pk_bf16_f32 v192, v184, v183
    v_cvt_pk_bf16_f32 v193, v182, v181
    v_cvt_pk_bf16_f32 v194, v180, v179
    v_cvt_pk_bf16_f32 v195, v178, v177
    ds_write_b128 v5, v[192:195] offset:96
    v_and_b32 v165, 0xffff0000, v28
    v_and_b32 v166, 0xffff0000, v29
    v_and_b32 v167, 0xffff0000, v30
    v_and_b32 v168, 0xffff0000, v31
    v_and_b32 v169, 0xffff0000, v32
    v_and_b32 v170, 0xffff0000, v33
    v_and_b32 v171, 0xffff0000, v34
    v_and_b32 v172, 0xffff0000, v35
    v_and_b32 v173, 0xffff0000, v36
    v_and_b32 v174, 0xffff0000, v37
    v_and_b32 v175, 0xffff0000, v38
    v_mul_f32 v177, v165, v159
    v_mul_f32 v178, v166, v159
    v_mul_f32 v179, v167, v159
    v_mul_f32 v180, v168, v159
    v_mul_f32 v181, v169, v159
    v_mul_f32 v182, v170, v159
    v_mul_f32 v183, v171, v159
    v_mul_f32 v184, v172, v159
    v_fmac_f32 v177, v166, v158
    v_fmac_f32 v178, v167, v158
    v_fmac_f32 v179, v168, v158
    v_fmac_f32 v180, v169, v158
    v_fmac_f32 v181, v170, v158
    v_fmac_f32 v182, v171, v158
    v_fmac_f32 v183, v172, v158
    v_fmac_f32 v184, v173, v158
    v_fmac_f32 v177, v167, v157
    v_fmac_f32 v178, v168, v157
    v_fmac_f32 v179, v169, v157
    v_fmac_f32 v180, v170, v157
    v_fmac_f32 v181, v171, v157
    v_fmac_f32 v182, v172, v157
    v_fmac_f32 v183, v173, v157
    v_fmac_f32 v184, v174, v157
    v_fmac_f32 v177, v168, v156
    v_fmac_f32 v178, v169, v156
    v_fmac_f32 v179, v170, v156
    v_fmac_f32 v180, v171, v156
    v_fmac_f32 v181, v172, v156
    v_fmac_f32 v182, v173, v156
    v_fmac_f32 v183, v174, v156
    v_fmac_f32 v184, v175, v156
    v_cvt_pk_bf16_f32 v196, v177, v178
    v_lshlrev_b32 v177, 16, v196
    v_and_b32 v178, 0xffff0000, v196
    v_cvt_pk_bf16_f32 v196, v179, v180
    v_lshlrev_b32 v179, 16, v196
    v_and_b32 v180, 0xffff0000, v196
    v_cvt_pk_bf16_f32 v196, v181, v182
    v_lshlrev_b32 v181, 16, v196
    v_and_b32 v182, 0xffff0000, v196
    v_cvt_pk_bf16_f32 v196, v183, v184
    v_lshlrev_b32 v183, 16, v196
    v_and_b32 v184, 0xffff0000, v196
    v_and_b32 v198, 0xffff0000, v95
    v_mul_f32 v177, v177, v198
    v_and_b32 v197, 0xffff0000, v96
    v_mul_f32 v178, v178, v197
    v_and_b32 v198, 0xffff0000, v97
    v_mul_f32 v179, v179, v198
    v_and_b32 v197, 0xffff0000, v98
    v_mul_f32 v180, v180, v197
    v_and_b32 v198, 0xffff0000, v99
    v_mul_f32 v181, v181, v198
    v_and_b32 v197, 0xffff0000, v100
    v_mul_f32 v182, v182, v197
    v_and_b32 v198, 0xffff0000, v101
    v_mul_f32 v183, v183, v198
    v_and_b32 v197, 0xffff0000, v102
    v_mul_f32 v184, v184, v197
    v_cvt_pk_bf16_f32 v192, v184, v183
    v_cvt_pk_bf16_f32 v193, v182, v181
    v_cvt_pk_bf16_f32 v194, v180, v179
    v_cvt_pk_bf16_f32 v195, v178, v177
    ds_write_b128 v5, v[192:195] offset:80
    v_and_b32 v165, 0xffff0000, v36
    v_and_b32 v166, 0xffff0000, v37
    v_and_b32 v167, 0xffff0000, v38
    v_and_b32 v168, 0xffff0000, v39
    v_and_b32 v169, 0xffff0000, v40
    v_and_b32 v170, 0xffff0000, v41
    v_and_b32 v171, 0xffff0000, v42
    v_and_b32 v172, 0xffff0000, v43
    v_and_b32 v173, 0xffff0000, v44
    v_and_b32 v174, 0xffff0000, v45
    v_and_b32 v175, 0xffff0000, v46
    v_mul_f32 v177, v165, v159
    v_mul_f32 v178, v166, v159
    v_mul_f32 v179, v167, v159
    v_mul_f32 v180, v168, v159
    v_mul_f32 v181, v169, v159
    v_mul_f32 v182, v170, v159
    v_mul_f32 v183, v171, v159
    v_mul_f32 v184, v172, v159
    v_fmac_f32 v177, v166, v158
    v_fmac_f32 v178, v167, v158
    v_fmac_f32 v179, v168, v158
    v_fmac_f32 v180, v169, v158
    v_fmac_f32 v181, v170, v158
    v_fmac_f32 v182, v171, v158
    v_fmac_f32 v183, v172, v158
    v_fmac_f32 v184, v173, v158
    v_fmac_f32 v177, v167, v157
    v_fmac_f32 v178, v168, v157
    v_fmac_f32 v179, v169, v157
    v_fmac_f32 v180, v170, v157
    v_fmac_f32 v181, v171, v157
    v_fmac_f32 v182, v172, v157
    v_fmac_f32 v183, v173, v157
    v_fmac_f32 v184, v174, v157
    v_fmac_f32 v177, v168, v156
    v_fmac_f32 v178, v169, v156
    v_fmac_f32 v179, v170, v156
    v_fmac_f32 v180, v171, v156
    v_fmac_f32 v181, v172, v156
    v_fmac_f32 v182, v173, v156
    v_fmac_f32 v183, v174, v156
    v_fmac_f32 v184, v175, v156
    v_cvt_pk_bf16_f32 v196, v177, v178
    v_lshlrev_b32 v177, 16, v196
    v_and_b32 v178, 0xffff0000, v196
    v_cvt_pk_bf16_f32 v196, v179, v180
    v_lshlrev_b32 v179, 16, v196
    v_and_b32 v180, 0xffff0000, v196
    v_cvt_pk_bf16_f32 v196, v181, v182
    v_lshlrev_b32 v181, 16, v196
    v_and_b32 v182, 0xffff0000, v196
    v_cvt_pk_bf16_f32 v196, v183, v184
    v_lshlrev_b32 v183, 16, v196
    v_and_b32 v184, 0xffff0000, v196
    v_and_b32 v198, 0xffff0000, v103
    v_mul_f32 v177, v177, v198
    v_and_b32 v197, 0xffff0000, v104
    v_mul_f32 v178, v178, v197
    v_and_b32 v198, 0xffff0000, v105
    v_mul_f32 v179, v179, v198
    v_and_b32 v197, 0xffff0000, v106
    v_mul_f32 v180, v180, v197
    v_and_b32 v198, 0xffff0000, v107
    v_mul_f32 v181, v181, v198
    v_and_b32 v197, 0xffff0000, v108
    v_mul_f32 v182, v182, v197
    v_and_b32 v198, 0xffff0000, v109
    v_mul_f32 v183, v183, v198
    v_and_b32 v197, 0xffff0000, v110
    v_mul_f32 v184, v184, v197
    v_cvt_pk_bf16_f32 v192, v184, v183
    v_cvt_pk_bf16_f32 v193, v182, v181
    v_cvt_pk_bf16_f32 v194, v180, v179
    v_cvt_pk_bf16_f32 v195, v178, v177
    ds_write_b128 v5, v[192:195] offset:64
    v_and_b32 v165, 0xffff0000, v44
    v_and_b32 v166, 0xffff0000, v45
    v_and_b32 v167, 0xffff0000, v46
    v_and_b32 v168, 0xffff0000, v47
    v_and_b32 v169, 0xffff0000, v48
    v_and_b32 v170, 0xffff0000, v49
    v_and_b32 v171, 0xffff0000, v50
    v_and_b32 v172, 0xffff0000, v51
    v_and_b32 v173, 0xffff0000, v52
    v_and_b32 v174, 0xffff0000, v53
    v_and_b32 v175, 0xffff0000, v54
    v_mul_f32 v177, v165, v159
    v_mul_f32 v178, v166, v159
    v_mul_f32 v179, v167, v159
    v_mul_f32 v180, v168, v159
    v_mul_f32 v181, v169, v159
    v_mul_f32 v182, v170, v159
    v_mul_f32 v183, v171, v159
    v_mul_f32 v184, v172, v159
    v_fmac_f32 v177, v166, v158
    v_fmac_f32 v178, v167, v158
    v_fmac_f32 v179, v168, v158
    v_fmac_f32 v180, v169, v158
    v_fmac_f32 v181, v170, v158
    v_fmac_f32 v182, v171, v158
    v_fmac_f32 v183, v172, v158
    v_fmac_f32 v184, v173, v158
    v_fmac_f32 v177, v167, v157
    v_fmac_f32 v178, v168, v157
    v_fmac_f32 v179, v169, v157
    v_fmac_f32 v180, v170, v157
    v_fmac_f32 v181, v171, v157
    v_fmac_f32 v182, v172, v157
    v_fmac_f32 v183, v173, v157
    v_fmac_f32 v184, v174, v157
    v_fmac_f32 v177, v168, v156
    v_fmac_f32 v178, v169, v156
    v_fmac_f32 v179, v170, v156
    v_fmac_f32 v180, v171, v156
    v_fmac_f32 v181, v172, v156
    v_fmac_f32 v182, v173, v156
    v_fmac_f32 v183, v174, v156
    v_fmac_f32 v184, v175, v156
    v_cvt_pk_bf16_f32 v196, v177, v178
    v_lshlrev_b32 v177, 16, v196
    v_and_b32 v178, 0xffff0000, v196
    v_cvt_pk_bf16_f32 v196, v179, v180
    v_lshlrev_b32 v179, 16, v196
    v_and_b32 v180, 0xffff0000, v196
    v_cvt_pk_bf16_f32 v196, v181, v182
    v_lshlrev_b32 v181, 16, v196
    v_and_b32 v182, 0xffff0000, v196
    v_cvt_pk_bf16_f32 v196, v183, v184
    v_lshlrev_b32 v183, 16, v196
    v_and_b32 v184, 0xffff0000, v196
    v_and_b32 v198, 0xffff0000, v111
    v_mul_f32 v177, v177, v198
    v_and_b32 v197, 0xffff0000, v112
    v_mul_f32 v178, v178, v197
    v_and_b32 v198, 0xffff0000, v113
    v_mul_f32 v179, v179, v198
    v_and_b32 v197, 0xffff0000, v114
    v_mul_f32 v180, v180, v197
    v_and_b32 v198, 0xffff0000, v115
    v_mul_f32 v181, v181, v198
    v_and_b32 v197, 0xffff0000, v116
    v_mul_f32 v182, v182, v197
    v_and_b32 v198, 0xffff0000, v117
    v_mul_f32 v183, v183, v198
    v_and_b32 v197, 0xffff0000, v118
    v_mul_f32 v184, v184, v197
    v_cvt_pk_bf16_f32 v192, v184, v183
    v_cvt_pk_bf16_f32 v193, v182, v181
    v_cvt_pk_bf16_f32 v194, v180, v179
    v_cvt_pk_bf16_f32 v195, v178, v177
    ds_write_b128 v5, v[192:195] offset:48
    v_and_b32 v165, 0xffff0000, v52
    v_and_b32 v166, 0xffff0000, v53
    v_and_b32 v167, 0xffff0000, v54
    v_and_b32 v168, 0xffff0000, v55
    v_and_b32 v169, 0xffff0000, v56
    v_and_b32 v170, 0xffff0000, v57
    v_and_b32 v171, 0xffff0000, v58
    v_and_b32 v172, 0xffff0000, v59
    v_and_b32 v173, 0xffff0000, v60
    v_and_b32 v174, 0xffff0000, v61
    v_and_b32 v175, 0xffff0000, v62
    v_mul_f32 v177, v165, v159
    v_mul_f32 v178, v166, v159
    v_mul_f32 v179, v167, v159
    v_mul_f32 v180, v168, v159
    v_mul_f32 v181, v169, v159
    v_mul_f32 v182, v170, v159
    v_mul_f32 v183, v171, v159
    v_mul_f32 v184, v172, v159
    v_fmac_f32 v177, v166, v158
    v_fmac_f32 v178, v167, v158
    v_fmac_f32 v179, v168, v158
    v_fmac_f32 v180, v169, v158
    v_fmac_f32 v181, v170, v158
    v_fmac_f32 v182, v171, v158
    v_fmac_f32 v183, v172, v158
    v_fmac_f32 v184, v173, v158
    v_fmac_f32 v177, v167, v157
    v_fmac_f32 v178, v168, v157
    v_fmac_f32 v179, v169, v157
    v_fmac_f32 v180, v170, v157
    v_fmac_f32 v181, v171, v157
    v_fmac_f32 v182, v172, v157
    v_fmac_f32 v183, v173, v157
    v_fmac_f32 v184, v174, v157
    v_fmac_f32 v177, v168, v156
    v_fmac_f32 v178, v169, v156
    v_fmac_f32 v179, v170, v156
    v_fmac_f32 v180, v171, v156
    v_fmac_f32 v181, v172, v156
    v_fmac_f32 v182, v173, v156
    v_fmac_f32 v183, v174, v156
    v_fmac_f32 v184, v175, v156
    v_cvt_pk_bf16_f32 v196, v177, v178
    v_lshlrev_b32 v177, 16, v196
    v_and_b32 v178, 0xffff0000, v196
    v_cvt_pk_bf16_f32 v196, v179, v180
    v_lshlrev_b32 v179, 16, v196
    v_and_b32 v180, 0xffff0000, v196
    v_cvt_pk_bf16_f32 v196, v181, v182
    v_lshlrev_b32 v181, 16, v196
    v_and_b32 v182, 0xffff0000, v196
    v_cvt_pk_bf16_f32 v196, v183, v184
    v_lshlrev_b32 v183, 16, v196
    v_and_b32 v184, 0xffff0000, v196
    v_and_b32 v198, 0xffff0000, v119
    v_mul_f32 v177, v177, v198
    v_and_b32 v197, 0xffff0000, v120
    v_mul_f32 v178, v178, v197
    v_and_b32 v198, 0xffff0000, v121
    v_mul_f32 v179, v179, v198
    v_and_b32 v197, 0xffff0000, v122
    v_mul_f32 v180, v180, v197
    v_and_b32 v198, 0xffff0000, v123
    v_mul_f32 v181, v181, v198
    v_and_b32 v197, 0xffff0000, v124
    v_mul_f32 v182, v182, v197
    v_and_b32 v198, 0xffff0000, v125
    v_mul_f32 v183, v183, v198
    v_and_b32 v197, 0xffff0000, v126
    v_mul_f32 v184, v184, v197
    v_cvt_pk_bf16_f32 v192, v184, v183
    v_cvt_pk_bf16_f32 v193, v182, v181
    v_cvt_pk_bf16_f32 v194, v180, v179
    v_cvt_pk_bf16_f32 v195, v178, v177
    ds_write_b128 v5, v[192:195] offset:32
    v_and_b32 v165, 0xffff0000, v60
    v_and_b32 v166, 0xffff0000, v61
    v_and_b32 v167, 0xffff0000, v62
    v_and_b32 v168, 0xffff0000, v63
    v_and_b32 v169, 0xffff0000, v64
    v_and_b32 v170, 0xffff0000, v65
    v_and_b32 v171, 0xffff0000, v66
    v_and_b32 v172, 0xffff0000, v67
    v_and_b32 v173, 0xffff0000, v68
    v_and_b32 v174, 0xffff0000, v69
    v_and_b32 v175, 0xffff0000, v70
    v_mul_f32 v177, v165, v159
    v_mul_f32 v178, v166, v159
    v_mul_f32 v179, v167, v159
    v_mul_f32 v180, v168, v159
    v_mul_f32 v181, v169, v159
    v_mul_f32 v182, v170, v159
    v_mul_f32 v183, v171, v159
    v_mul_f32 v184, v172, v159
    v_fmac_f32 v177, v166, v158
    v_fmac_f32 v178, v167, v158
    v_fmac_f32 v179, v168, v158
    v_fmac_f32 v180, v169, v158
    v_fmac_f32 v181, v170, v158
    v_fmac_f32 v182, v171, v158
    v_fmac_f32 v183, v172, v158
    v_fmac_f32 v184, v173, v158
    v_fmac_f32 v177, v167, v157
    v_fmac_f32 v178, v168, v157
    v_fmac_f32 v179, v169, v157
    v_fmac_f32 v180, v170, v157
    v_fmac_f32 v181, v171, v157
    v_fmac_f32 v182, v172, v157
    v_fmac_f32 v183, v173, v157
    v_fmac_f32 v184, v174, v157
    v_fmac_f32 v177, v168, v156
    v_fmac_f32 v178, v169, v156
    v_fmac_f32 v179, v170, v156
    v_fmac_f32 v180, v171, v156
    v_fmac_f32 v181, v172, v156
    v_fmac_f32 v182, v173, v156
    v_fmac_f32 v183, v174, v156
    v_fmac_f32 v184, v175, v156
    v_cvt_pk_bf16_f32 v196, v177, v178
    v_lshlrev_b32 v177, 16, v196
    v_and_b32 v178, 0xffff0000, v196
    v_cvt_pk_bf16_f32 v196, v179, v180
    v_lshlrev_b32 v179, 16, v196
    v_and_b32 v180, 0xffff0000, v196
    v_cvt_pk_bf16_f32 v196, v181, v182
    v_lshlrev_b32 v181, 16, v196
    v_and_b32 v182, 0xffff0000, v196
    v_cvt_pk_bf16_f32 v196, v183, v184
    v_lshlrev_b32 v183, 16, v196
    v_and_b32 v184, 0xffff0000, v196
    v_and_b32 v198, 0xffff0000, v127
    v_mul_f32 v177, v177, v198
    v_and_b32 v197, 0xffff0000, v128
    v_mul_f32 v178, v178, v197
    v_and_b32 v198, 0xffff0000, v129
    v_mul_f32 v179, v179, v198
    v_and_b32 v197, 0xffff0000, v130
    v_mul_f32 v180, v180, v197
    v_and_b32 v198, 0xffff0000, v131
    v_mul_f32 v181, v181, v198
    v_and_b32 v197, 0xffff0000, v132
    v_mul_f32 v182, v182, v197
    v_and_b32 v198, 0xffff0000, v133
    v_mul_f32 v183, v183, v198
    v_and_b32 v197, 0xffff0000, v134
    v_mul_f32 v184, v184, v197
    v_cvt_pk_bf16_f32 v192, v184, v183
    v_cvt_pk_bf16_f32 v193, v182, v181
    v_cvt_pk_bf16_f32 v194, v180, v179
    v_cvt_pk_bf16_f32 v195, v178, v177
    ds_write_b128 v5, v[192:195] offset:16
    v_and_b32 v165, 0xffff0000, v68
    v_and_b32 v166, 0xffff0000, v69
    v_and_b32 v167, 0xffff0000, v70
    v_and_b32 v168, 0xffff0000, v71
    v_and_b32 v169, 0xffff0000, v72
    v_and_b32 v170, 0xffff0000, v73
    v_and_b32 v171, 0xffff0000, v74
    v_and_b32 v172, 0xffff0000, v75
    v_and_b32 v173, 0xffff0000, v76
    v_and_b32 v174, 0xffff0000, v77
    v_and_b32 v175, 0xffff0000, v78
    v_mul_f32 v177, v165, v159
    v_mul_f32 v178, v166, v159
    v_mul_f32 v179, v167, v159
    v_mul_f32 v180, v168, v159
    v_mul_f32 v181, v169, v159
    v_mul_f32 v182, v170, v159
    v_mul_f32 v183, v171, v159
    v_mul_f32 v184, v172, v159
    v_fmac_f32 v177, v166, v158
    v_fmac_f32 v178, v167, v158
    v_fmac_f32 v179, v168, v158
    v_fmac_f32 v180, v169, v158
    v_fmac_f32 v181, v170, v158
    v_fmac_f32 v182, v171, v158
    v_fmac_f32 v183, v172, v158
    v_fmac_f32 v184, v173, v158
    v_fmac_f32 v177, v167, v157
    v_fmac_f32 v178, v168, v157
    v_fmac_f32 v179, v169, v157
    v_fmac_f32 v180, v170, v157
    v_fmac_f32 v181, v171, v157
    v_fmac_f32 v182, v172, v157
    v_fmac_f32 v183, v173, v157
    v_fmac_f32 v184, v174, v157
    v_fmac_f32 v177, v168, v156
    v_fmac_f32 v178, v169, v156
    v_fmac_f32 v179, v170, v156
    v_fmac_f32 v180, v171, v156
    v_fmac_f32 v181, v172, v156
    v_fmac_f32 v182, v173, v156
    v_fmac_f32 v183, v174, v156
    v_fmac_f32 v184, v175, v156
    v_cvt_pk_bf16_f32 v196, v177, v178
    v_lshlrev_b32 v177, 16, v196
    v_and_b32 v178, 0xffff0000, v196
    v_cvt_pk_bf16_f32 v196, v179, v180
    v_lshlrev_b32 v179, 16, v196
    v_and_b32 v180, 0xffff0000, v196
    v_cvt_pk_bf16_f32 v196, v181, v182
    v_lshlrev_b32 v181, 16, v196
    v_and_b32 v182, 0xffff0000, v196
    v_cvt_pk_bf16_f32 v196, v183, v184
    v_lshlrev_b32 v183, 16, v196
    v_and_b32 v184, 0xffff0000, v196
    v_and_b32 v198, 0xffff0000, v135
    v_mul_f32 v177, v177, v198
    v_and_b32 v197, 0xffff0000, v136
    v_mul_f32 v178, v178, v197
    v_and_b32 v198, 0xffff0000, v137
    v_mul_f32 v179, v179, v198
    v_and_b32 v197, 0xffff0000, v138
    v_mul_f32 v180, v180, v197
    v_and_b32 v198, 0xffff0000, v139
    v_mul_f32 v181, v181, v198
    v_and_b32 v197, 0xffff0000, v140
    v_mul_f32 v182, v182, v197
    v_and_b32 v198, 0xffff0000, v141
    v_mul_f32 v183, v183, v198
    v_and_b32 v197, 0xffff0000, v142
    v_mul_f32 v184, v184, v197
    v_cvt_pk_bf16_f32 v192, v184, v183
    v_cvt_pk_bf16_f32 v193, v182, v181
    v_cvt_pk_bf16_f32 v194, v180, v179
    v_cvt_pk_bf16_f32 v195, v178, v177
    ds_write_b128 v5, v[192:195] offset:0
    s_waitcnt lgkmcnt(0)
    ds_read_b128 v[200:203], v6 offset:0
    ds_read_b128 v[204:207], v6 offset:1152
    ds_read_b128 v[208:211], v6 offset:2304
    ds_read_b128 v[212:215], v6 offset:3456
    ds_read_b128 v[216:219], v6 offset:4608
    ds_read_b128 v[220:223], v6 offset:5760
    ds_read_b128 v[224:227], v6 offset:6912
    ds_read_b128 v[228:231], v6 offset:8064
    s_waitcnt lgkmcnt(7)
    s_mov_b32 s47, 4096
    buffer_store_dwordx4 v[200:203], v7, s[60:63], s47 offen sc1
    s_waitcnt lgkmcnt(6)
    s_mov_b32 s47, 69632
    buffer_store_dwordx4 v[204:207], v7, s[60:63], s47 offen sc1
    s_waitcnt lgkmcnt(5)
    s_mov_b32 s47, 135168
    buffer_store_dwordx4 v[208:211], v7, s[60:63], s47 offen sc1
    s_waitcnt lgkmcnt(4)
    s_mov_b32 s47, 200704
    buffer_store_dwordx4 v[212:215], v7, s[60:63], s47 offen sc1
    s_waitcnt lgkmcnt(3)
    s_mov_b32 s47, 266240
    buffer_store_dwordx4 v[216:219], v7, s[60:63], s47 offen sc1
    s_waitcnt lgkmcnt(2)
    s_mov_b32 s47, 331776
    buffer_store_dwordx4 v[220:223], v7, s[60:63], s47 offen sc1
    s_waitcnt lgkmcnt(1)
    s_mov_b32 s47, 397312
    buffer_store_dwordx4 v[224:227], v7, s[60:63], s47 offen sc1
    s_waitcnt lgkmcnt(0)
    s_mov_b32 s47, 462848
    buffer_store_dwordx4 v[228:231], v7, s[60:63], s47 offen sc1
    s_nop 1
    s_mov_b32 s16, s84
    s_mov_b32 s17, s85
    s_mov_b32 s18, 7340032
    s_mov_b32 s19, 0x00020000
    s_add_u32 s24, s38, 58720256
    s_addc_u32 s25, s39, 0
    s_mov_b32 s26, 7340032
    s_mov_b32 s27, 0x00020000
    v_lshlrev_b32 v9, 4, v2
    v_lshrrev_b32 v10, 3, v2
    s_mov_b32 s46, 458752
    v_mul_lo_u32 v10, v10, s46
    v_and_b32 v11, 7, v2
    v_lshlrev_b32 v11, 4, v11
    v_add_u32 v10, v10, v11
    s_mul_i32 s34, s41, 56
    s_mul_i32 s35, s40, 7
    s_add_u32 s34, s34, s35
    s_waitcnt vmcnt(0)
    s_barrier
    s_cmp_lg_u32 s40, 0
    s_cbranch_scc1 G1_nofpV
    s_lshl_b32 s46, s41, 2
    v_mov_b32 v4, 1
    v_mov_b32 v5, 0
    s_mov_b64 exec, 1
    buffer_store_dword v4, v5, s[72:75], s46 offen sc1
    s_mov_b64 exec, -1
G1_nofpV:
    v_lshlrev_b32 v9, 5, v2
    buffer_load_dwordx4 v[152:155], v9, s[64:67], 0 offen
    buffer_load_dwordx4 v[156:159], v9, s[64:67], 0 offen offset:16
    s_lshl_b32 s45, s41, 6
    s_lshl_b32 s47, s40, 3
    s_add_u32 s45, s45, s47
    s_lshl_b32 s44, s45, 11
    s_add_u32 s47, s44, 0
    buffer_load_dwordx4 v[176:179], v9, s[8:11], s47 offen
    buffer_load_dwordx4 v[180:183], v9, s[8:11], s47 offen offset:16
    s_add_u32 s47, s44, 2048
    buffer_load_dwordx4 v[184:187], v9, s[8:11], s47 offen
    buffer_load_dwordx4 v[188:191], v9, s[8:11], s47 offen offset:16
    s_add_u32 s47, s44, 4096
    buffer_load_dwordx4 v[192:195], v9, s[8:11], s47 offen
    buffer_load_dwordx4 v[196:199], v9, s[8:11], s47 offen offset:16
    s_add_u32 s47, s44, 6144
    buffer_load_dwordx4 v[200:203], v9, s[8:11], s47 offen
    buffer_load_dwordx4 v[204:207], v9, s[8:11], s47 offen offset:16
    s_add_u32 s47, s44, 8192
    buffer_load_dwordx4 v[208:211], v9, s[8:11], s47 offen
    buffer_load_dwordx4 v[212:215], v9, s[8:11], s47 offen offset:16
    s_add_u32 s47, s44, 10240
    buffer_load_dwordx4 v[216:219], v9, s[8:11], s47 offen
    buffer_load_dwordx4 v[220:223], v9, s[8:11], s47 offen offset:16
    s_add_u32 s47, s44, 12288
    buffer_load_dwordx4 v[224:227], v9, s[8:11], s47 offen
    buffer_load_dwordx4 v[228:231], v9, s[8:11], s47 offen offset:16
    s_add_u32 s47, s44, 14336
    buffer_load_dwordx4 v[232:235], v9, s[8:11], s47 offen
    buffer_load_dwordx4 v[236:239], v9, s[8:11], s47 offen offset:16
    s_mov_b32 s16, s84
    s_mov_b32 s17, s85
    s_mov_b32 s18, 7340032
    s_mov_b32 s19, 0x00020000
    s_add_u32 s24, s38, 58720256
    s_addc_u32 s25, s39, 0
    s_mov_b32 s26, 1147904
    s_mov_b32 s27, 0x00020000
    s_lshl_b32 s42, s41, 3
    s_add_u32 s42, s42, s40
    v_lshrrev_b32 v248, 3, v2
    v_and_b32 v249, 7, v2
    v_lshlrev_b32 v249, 4, v249
    v_lshl_add_u32 v250, v248, 11, v249
    s_lshl_b32 s43, s42, 15
    s_add_u32 s44, s43, 0
    buffer_load_dwordx4 v[16:19], v250, s[16:19], s44 offen offset:384
    s_add_u32 s44, s43, 16384
    buffer_load_dwordx4 v[20:23], v250, s[16:19], s44 offen offset:384
    s_add_u32 s44, s43, 0
    buffer_load_dwordx4 v[24:27], v250, s[16:19], s44 offen offset:1408
    s_add_u32 s44, s43, 16384
    buffer_load_dwordx4 v[28:31], v250, s[16:19], s44 offen offset:1408
    s_and_b32 s43, s42, 1
    s_lshl_b32 s43, s43, 4
    s_lshr_b32 s44, s42, 1
    s_mul_i32 s44, s44, 10240
    s_add_u32 s44, s44, 1024
    v_add_u32 v251, s43, v248
    v_add_u32 v253, 4, v251
    v_mul_u32_u24 v253, 37, v253
    v_lshrrev_b32 v253, 8, v253
    v_add_u32 v251, v251, v253
    v_lshlrev_b32 v251, 7, v251
    v_add3_u32 v251, v251, v249, s44
    s_add_u32 s43, s43, 8
    v_add_u32 v252, s43, v248
    v_add_u32 v253, 4, v252
    v_mul_u32_u24 v253, 37, v253
    v_lshrrev_b32 v253, 8, v253
    v_add_u32 v252, v252, v253
    v_lshlrev_b32 v252, 7, v252
    v_add3_u32 v252, v252, v249, s44
    s_waitcnt vmcnt(4)
    v_lshlrev_b32 v160, 16, v152
    v_and_b32 v161, 0xffff0000, v152
    v_lshlrev_b32 v162, 16, v153
    v_and_b32 v163, 0xffff0000, v153
    v_lshlrev_b32 v164, 16, v154
    v_and_b32 v165, 0xffff0000, v154
    v_lshlrev_b32 v166, 16, v155
    v_and_b32 v167, 0xffff0000, v155
    v_lshlrev_b32 v168, 16, v156
    v_and_b32 v169, 0xffff0000, v156
    v_lshlrev_b32 v170, 16, v157
    v_and_b32 v171, 0xffff0000, v157
    v_lshlrev_b32 v172, 16, v158
    v_and_b32 v173, 0xffff0000, v158
    v_lshlrev_b32 v174, 16, v159
    v_and_b32 v175, 0xffff0000, v159
    v_mov_b32 v130, 0
    v_lshlrev_b32 v5, 16, v176
    v_and_b32 v6, 0xffff0000, v176
    v_fmac_f32 v130, v5, v160
    v_fmac_f32 v130, v6, v161
    v_lshlrev_b32 v5, 16, v177
    v_and_b32 v6, 0xffff0000, v177
    v_fmac_f32 v130, v5, v162
    v_fmac_f32 v130, v6, v163
    v_lshlrev_b32 v5, 16, v178
    v_and_b32 v6, 0xffff0000, v178
    v_fmac_f32 v130, v5, v164
    v_fmac_f32 v130, v6, v165
    v_lshlrev_b32 v5, 16, v179
    v_and_b32 v6, 0xffff0000, v179
    v_fmac_f32 v130, v5, v166
    v_fmac_f32 v130, v6, v167
    v_lshlrev_b32 v5, 16, v180
    v_and_b32 v6, 0xffff0000, v180
    v_fmac_f32 v130, v5, v168
    v_fmac_f32 v130, v6, v169
    v_lshlrev_b32 v5, 16, v181
    v_and_b32 v6, 0xffff0000, v181
    v_fmac_f32 v130, v5, v170
    v_fmac_f32 v130, v6, v171
    v_lshlrev_b32 v5, 16, v182
    v_and_b32 v6, 0xffff0000, v182
    v_fmac_f32 v130, v5, v172
    v_fmac_f32 v130, v6, v173
    v_lshlrev_b32 v5, 16, v183
    v_and_b32 v6, 0xffff0000, v183
    v_fmac_f32 v130, v5, v174
    v_fmac_f32 v130, v6, v175
    v_mov_b32 v131, 0
    v_lshlrev_b32 v5, 16, v184
    v_and_b32 v6, 0xffff0000, v184
    v_fmac_f32 v131, v5, v160
    v_fmac_f32 v131, v6, v161
    v_lshlrev_b32 v5, 16, v185
    v_and_b32 v6, 0xffff0000, v185
    v_fmac_f32 v131, v5, v162
    v_fmac_f32 v131, v6, v163
    v_lshlrev_b32 v5, 16, v186
    v_and_b32 v6, 0xffff0000, v186
    v_fmac_f32 v131, v5, v164
    v_fmac_f32 v131, v6, v165
    v_lshlrev_b32 v5, 16, v187
    v_and_b32 v6, 0xffff0000, v187
    v_fmac_f32 v131, v5, v166
    v_fmac_f32 v131, v6, v167
    v_lshlrev_b32 v5, 16, v188
    v_and_b32 v6, 0xffff0000, v188
    v_fmac_f32 v131, v5, v168
    v_fmac_f32 v131, v6, v169
    v_lshlrev_b32 v5, 16, v189
    v_and_b32 v6, 0xffff0000, v189
    v_fmac_f32 v131, v5, v170
    v_fmac_f32 v131, v6, v171
    v_lshlrev_b32 v5, 16, v190
    v_and_b32 v6, 0xffff0000, v190
    v_fmac_f32 v131, v5, v172
    v_fmac_f32 v131, v6, v173
    v_lshlrev_b32 v5, 16, v191
    v_and_b32 v6, 0xffff0000, v191
    v_fmac_f32 v131, v5, v174
    v_fmac_f32 v131, v6, v175
    v_mov_b32 v132, 0
    v_lshlrev_b32 v5, 16, v192
    v_and_b32 v6, 0xffff0000, v192
    v_fmac_f32 v132, v5, v160
    v_fmac_f32 v132, v6, v161
    v_lshlrev_b32 v5, 16, v193
    v_and_b32 v6, 0xffff0000, v193
    v_fmac_f32 v132, v5, v162
    v_fmac_f32 v132, v6, v163
    v_lshlrev_b32 v5, 16, v194
    v_and_b32 v6, 0xffff0000, v194
    v_fmac_f32 v132, v5, v164
    v_fmac_f32 v132, v6, v165
    v_lshlrev_b32 v5, 16, v195
    v_and_b32 v6, 0xffff0000, v195
    v_fmac_f32 v132, v5, v166
    v_fmac_f32 v132, v6, v167
    v_lshlrev_b32 v5, 16, v196
    v_and_b32 v6, 0xffff0000, v196
    v_fmac_f32 v132, v5, v168
    v_fmac_f32 v132, v6, v169
    v_lshlrev_b32 v5, 16, v197
    v_and_b32 v6, 0xffff0000, v197
    v_fmac_f32 v132, v5, v170
    v_fmac_f32 v132, v6, v171
    v_lshlrev_b32 v5, 16, v198
    v_and_b32 v6, 0xffff0000, v198
    v_fmac_f32 v132, v5, v172
    v_fmac_f32 v132, v6, v173
    v_lshlrev_b32 v5, 16, v199
    v_and_b32 v6, 0xffff0000, v199
    v_fmac_f32 v132, v5, v174
    v_fmac_f32 v132, v6, v175
    v_mov_b32 v133, 0
    v_lshlrev_b32 v5, 16, v200
    v_and_b32 v6, 0xffff0000, v200
    v_fmac_f32 v133, v5, v160
    v_fmac_f32 v133, v6, v161
    v_lshlrev_b32 v5, 16, v201
    v_and_b32 v6, 0xffff0000, v201
    v_fmac_f32 v133, v5, v162
    v_fmac_f32 v133, v6, v163
    v_lshlrev_b32 v5, 16, v202
    v_and_b32 v6, 0xffff0000, v202
    v_fmac_f32 v133, v5, v164
    v_fmac_f32 v133, v6, v165
    v_lshlrev_b32 v5, 16, v203
    v_and_b32 v6, 0xffff0000, v203
    v_fmac_f32 v133, v5, v166
    v_fmac_f32 v133, v6, v167
    v_lshlrev_b32 v5, 16, v204
    v_and_b32 v6, 0xffff0000, v204
    v_fmac_f32 v133, v5, v168
    v_fmac_f32 v133, v6, v169
    v_lshlrev_b32 v5, 16, v205
    v_and_b32 v6, 0xffff0000, v205
    v_fmac_f32 v133, v5, v170
    v_fmac_f32 v133, v6, v171
    v_lshlrev_b32 v5, 16, v206
    v_and_b32 v6, 0xffff0000, v206
    v_fmac_f32 v133, v5, v172
    v_fmac_f32 v133, v6, v173
    v_lshlrev_b32 v5, 16, v207
    v_and_b32 v6, 0xffff0000, v207
    v_fmac_f32 v133, v5, v174
    v_fmac_f32 v133, v6, v175
    v_mov_b32 v134, 0
    v_lshlrev_b32 v5, 16, v208
    v_and_b32 v6, 0xffff0000, v208
    v_fmac_f32 v134, v5, v160
    v_fmac_f32 v134, v6, v161
    v_lshlrev_b32 v5, 16, v209
    v_and_b32 v6, 0xffff0000, v209
    v_fmac_f32 v134, v5, v162
    v_fmac_f32 v134, v6, v163
    v_lshlrev_b32 v5, 16, v210
    v_and_b32 v6, 0xffff0000, v210
    v_fmac_f32 v134, v5, v164
    v_fmac_f32 v134, v6, v165
    v_lshlrev_b32 v5, 16, v211
    v_and_b32 v6, 0xffff0000, v211
    v_fmac_f32 v134, v5, v166
    v_fmac_f32 v134, v6, v167
    v_lshlrev_b32 v5, 16, v212
    v_and_b32 v6, 0xffff0000, v212
    v_fmac_f32 v134, v5, v168
    v_fmac_f32 v134, v6, v169
    v_lshlrev_b32 v5, 16, v213
    v_and_b32 v6, 0xffff0000, v213
    v_fmac_f32 v134, v5, v170
    v_fmac_f32 v134, v6, v171
    v_lshlrev_b32 v5, 16, v214
    v_and_b32 v6, 0xffff0000, v214
    v_fmac_f32 v134, v5, v172
    v_fmac_f32 v134, v6, v173
    v_lshlrev_b32 v5, 16, v215
    v_and_b32 v6, 0xffff0000, v215
    v_fmac_f32 v134, v5, v174
    v_fmac_f32 v134, v6, v175
    v_mov_b32 v135, 0
    v_lshlrev_b32 v5, 16, v216
    v_and_b32 v6, 0xffff0000, v216
    v_fmac_f32 v135, v5, v160
    v_fmac_f32 v135, v6, v161
    v_lshlrev_b32 v5, 16, v217
    v_and_b32 v6, 0xffff0000, v217
    v_fmac_f32 v135, v5, v162
    v_fmac_f32 v135, v6, v163
    v_lshlrev_b32 v5, 16, v218
    v_and_b32 v6, 0xffff0000, v218
    v_fmac_f32 v135, v5, v164
    v_fmac_f32 v135, v6, v165
    v_lshlrev_b32 v5, 16, v219
    v_and_b32 v6, 0xffff0000, v219
    v_fmac_f32 v135, v5, v166
    v_fmac_f32 v135, v6, v167
    v_lshlrev_b32 v5, 16, v220
    v_and_b32 v6, 0xffff0000, v220
    v_fmac_f32 v135, v5, v168
    v_fmac_f32 v135, v6, v169
    v_lshlrev_b32 v5, 16, v221
    v_and_b32 v6, 0xffff0000, v221
    v_fmac_f32 v135, v5, v170
    v_fmac_f32 v135, v6, v171
    v_lshlrev_b32 v5, 16, v222
    v_and_b32 v6, 0xffff0000, v222
    v_fmac_f32 v135, v5, v172
    v_fmac_f32 v135, v6, v173
    v_lshlrev_b32 v5, 16, v223
    v_and_b32 v6, 0xffff0000, v223
    v_fmac_f32 v135, v5, v174
    v_fmac_f32 v135, v6, v175
    v_mov_b32 v136, 0
    v_lshlrev_b32 v5, 16, v224
    v_and_b32 v6, 0xffff0000, v224
    v_fmac_f32 v136, v5, v160
    v_fmac_f32 v136, v6, v161
    v_lshlrev_b32 v5, 16, v225
    v_and_b32 v6, 0xffff0000, v225
    v_fmac_f32 v136, v5, v162
    v_fmac_f32 v136, v6, v163
    v_lshlrev_b32 v5, 16, v226
    v_and_b32 v6, 0xffff0000, v226
    v_fmac_f32 v136, v5, v164
    v_fmac_f32 v136, v6, v165
    v_lshlrev_b32 v5, 16, v227
    v_and_b32 v6, 0xffff0000, v227
    v_fmac_f32 v136, v5, v166
    v_fmac_f32 v136, v6, v167
    v_lshlrev_b32 v5, 16, v228
    v_and_b32 v6, 0xffff0000, v228
    v_fmac_f32 v136, v5, v168
    v_fmac_f32 v136, v6, v169
    v_lshlrev_b32 v5, 16, v229
    v_and_b32 v6, 0xffff0000, v229
    v_fmac_f32 v136, v5, v170
    v_fmac_f32 v136, v6, v171
    v_lshlrev_b32 v5, 16, v230
    v_and_b32 v6, 0xffff0000, v230
    v_fmac_f32 v136, v5, v172
    v_fmac_f32 v136, v6, v173
    v_lshlrev_b32 v5, 16, v231
    v_and_b32 v6, 0xffff0000, v231
    v_fmac_f32 v136, v5, v174
    v_fmac_f32 v136, v6, v175
    v_mov_b32 v137, 0
    v_lshlrev_b32 v5, 16, v232
    v_and_b32 v6, 0xffff0000, v232
    v_fmac_f32 v137, v5, v160
    v_fmac_f32 v137, v6, v161
    v_lshlrev_b32 v5, 16, v233
    v_and_b32 v6, 0xffff0000, v233
    v_fmac_f32 v137, v5, v162
    v_fmac_f32 v137, v6, v163
    v_lshlrev_b32 v5, 16, v234
    v_and_b32 v6, 0xffff0000, v234
    v_fmac_f32 v137, v5, v164
    v_fmac_f32 v137, v6, v165
    v_lshlrev_b32 v5, 16, v235
    v_and_b32 v6, 0xffff0000, v235
    v_fmac_f32 v137, v5, v166
    v_fmac_f32 v137, v6, v167
    v_lshlrev_b32 v5, 16, v236
    v_and_b32 v6, 0xffff0000, v236
    v_fmac_f32 v137, v5, v168
    v_fmac_f32 v137, v6, v169
    v_lshlrev_b32 v5, 16, v237
    v_and_b32 v6, 0xffff0000, v237
    v_fmac_f32 v137, v5, v170
    v_fmac_f32 v137, v6, v171
    v_lshlrev_b32 v5, 16, v238
    v_and_b32 v6, 0xffff0000, v238
    v_fmac_f32 v137, v5, v172
    v_fmac_f32 v137, v6, v173
    v_lshlrev_b32 v5, 16, v239
    v_and_b32 v6, 0xffff0000, v239
    v_fmac_f32 v137, v5, v174
    v_fmac_f32 v137, v6, v175
    ds_swizzle_b32 v138, v130 offset:1055
    ds_swizzle_b32 v139, v131 offset:1055
    ds_swizzle_b32 v140, v132 offset:1055
    ds_swizzle_b32 v141, v133 offset:1055
    ds_swizzle_b32 v142, v134 offset:1055
    ds_swizzle_b32 v143, v135 offset:1055
    ds_swizzle_b32 v144, v136 offset:1055
    ds_swizzle_b32 v145, v137 offset:1055
    s_waitcnt lgkmcnt(0)
    v_add_f32 v130, v130, v138
    v_add_f32 v131, v131, v139
    v_add_f32 v132, v132, v140
    v_add_f32 v133, v133, v141
    v_add_f32 v134, v134, v142
    v_add_f32 v135, v135, v143
    v_add_f32 v136, v136, v144
    v_add_f32 v137, v137, v145
    ds_swizzle_b32 v138, v130 offset:2079
    ds_swizzle_b32 v139, v131 offset:2079
    ds_swizzle_b32 v140, v132 offset:2079
    ds_swizzle_b32 v141, v133 offset:2079
    ds_swizzle_b32 v142, v134 offset:2079
    ds_swizzle_b32 v143, v135 offset:2079
    ds_swizzle_b32 v144, v136 offset:2079
    ds_swizzle_b32 v145, v137 offset:2079
    s_waitcnt lgkmcnt(0)
    v_add_f32 v130, v130, v138
    v_add_f32 v131, v131, v139
    v_add_f32 v132, v132, v140
    v_add_f32 v133, v133, v141
    v_add_f32 v134, v134, v142
    v_add_f32 v135, v135, v143
    v_add_f32 v136, v136, v144
    v_add_f32 v137, v137, v145
    ds_swizzle_b32 v138, v130 offset:4127
    ds_swizzle_b32 v139, v131 offset:4127
    ds_swizzle_b32 v140, v132 offset:4127
    ds_swizzle_b32 v141, v133 offset:4127
    ds_swizzle_b32 v142, v134 offset:4127
    ds_swizzle_b32 v143, v135 offset:4127
    ds_swizzle_b32 v144, v136 offset:4127
    ds_swizzle_b32 v145, v137 offset:4127
    s_waitcnt lgkmcnt(0)
    v_add_f32 v130, v130, v138
    v_add_f32 v131, v131, v139
    v_add_f32 v132, v132, v140
    v_add_f32 v133, v133, v141
    v_add_f32 v134, v134, v142
    v_add_f32 v135, v135, v143
    v_add_f32 v136, v136, v144
    v_add_f32 v137, v137, v145
    ds_swizzle_b32 v138, v130 offset:8223
    ds_swizzle_b32 v139, v131 offset:8223
    ds_swizzle_b32 v140, v132 offset:8223
    ds_swizzle_b32 v141, v133 offset:8223
    ds_swizzle_b32 v142, v134 offset:8223
    ds_swizzle_b32 v143, v135 offset:8223
    ds_swizzle_b32 v144, v136 offset:8223
    ds_swizzle_b32 v145, v137 offset:8223
    s_waitcnt lgkmcnt(0)
    v_add_f32 v130, v130, v138
    v_add_f32 v131, v131, v139
    v_add_f32 v132, v132, v140
    v_add_f32 v133, v133, v141
    v_add_f32 v134, v134, v142
    v_add_f32 v135, v135, v143
    v_add_f32 v136, v136, v144
    v_add_f32 v137, v137, v145
    ds_swizzle_b32 v138, v130 offset:16415
    ds_swizzle_b32 v139, v131 offset:16415
    ds_swizzle_b32 v140, v132 offset:16415
    ds_swizzle_b32 v141, v133 offset:16415
    ds_swizzle_b32 v142, v134 offset:16415
    ds_swizzle_b32 v143, v135 offset:16415
    ds_swizzle_b32 v144, v136 offset:16415
    ds_swizzle_b32 v145, v137 offset:16415
    s_waitcnt lgkmcnt(0)
    v_add_f32 v130, v130, v138
    v_add_f32 v131, v131, v139
    v_add_f32 v132, v132, v140
    v_add_f32 v133, v133, v141
    v_add_f32 v134, v134, v142
    v_add_f32 v135, v135, v143
    v_add_f32 v136, v136, v144
    v_add_f32 v137, v137, v145
    v_mov_b32 v4, 0
    v_readlane_b32 s47, v130, 0
    v_readlane_b32 s44, v130, 32
    s_nop 1
    v_mov_b32 v5, s47
    v_add_f32 v5, s44, v5
    v_cmp_eq_u32 vcc, 0, v2
    s_nop 1
    v_cndmask_b32 v4, v4, v5, vcc
    v_readlane_b32 s47, v131, 0
    v_readlane_b32 s44, v131, 32
    s_nop 1
    v_mov_b32 v5, s47
    v_add_f32 v5, s44, v5
    v_cmp_eq_u32 vcc, 1, v2
    s_nop 1
    v_cndmask_b32 v4, v4, v5, vcc
    v_readlane_b32 s47, v132, 0
    v_readlane_b32 s44, v132, 32
    s_nop 1
    v_mov_b32 v5, s47
    v_add_f32 v5, s44, v5
    v_cmp_eq_u32 vcc, 2, v2
    s_nop 1
    v_cndmask_b32 v4, v4, v5, vcc
    v_readlane_b32 s47, v133, 0
    v_readlane_b32 s44, v133, 32
    s_nop 1
    v_mov_b32 v5, s47
    v_add_f32 v5, s44, v5
    v_cmp_eq_u32 vcc, 3, v2
    s_nop 1
    v_cndmask_b32 v4, v4, v5, vcc
    v_readlane_b32 s47, v134, 0
    v_readlane_b32 s44, v134, 32
    s_nop 1
    v_mov_b32 v5, s47
    v_add_f32 v5, s44, v5
    v_cmp_eq_u32 vcc, 4, v2
    s_nop 1
    v_cndmask_b32 v4, v4, v5, vcc
    v_readlane_b32 s47, v135, 0
    v_readlane_b32 s44, v135, 32
    s_nop 1
    v_mov_b32 v5, s47
    v_add_f32 v5, s44, v5
    v_cmp_eq_u32 vcc, 5, v2
    s_nop 1
    v_cndmask_b32 v4, v4, v5, vcc
    v_readlane_b32 s47, v136, 0
    v_readlane_b32 s44, v136, 32
    s_nop 1
    v_mov_b32 v5, s47
    v_add_f32 v5, s44, v5
    v_cmp_eq_u32 vcc, 6, v2
    s_nop 1
    v_cndmask_b32 v4, v4, v5, vcc
    v_readlane_b32 s47, v137, 0
    v_readlane_b32 s44, v137, 32
    s_nop 1
    v_mov_b32 v5, s47
    v_add_f32 v5, s44, v5
    v_cmp_eq_u32 vcc, 7, v2
    s_nop 1
    v_cndmask_b32 v4, v4, v5, vcc
    v_cvt_pk_bf16_f32 v4, v4, v4
    v_lshlrev_b32 v4, 16, v4
    v_mul_f32 v4, 0xbfb8aa3b, v4
    v_exp_f32 v4, v4
    s_nop 0
    v_add_f32 v4, 1.0, v4
    v_rcp_f32 v4, v4
    s_nop 0
    v_cvt_pk_bf16_f32 v4, v4, v4
    v_lshlrev_b32 v4, 16, v4
    s_lshl_b32 s46, s45, 2
    v_lshlrev_b32 v5, 2, v2
    s_mov_b64 exec, 0xff
    buffer_store_dword v4, v5, s[68:71], s46 offen sc1
    s_mov_b64 exec, -1
    s_waitcnt vmcnt(1)
    s_mov_b32 s44, 0
    buffer_store_dwordx4 v[16:19], v251, s[24:27], s44 offen sc1
    s_mov_b32 s44, 0
    buffer_store_dwordx4 v[20:23], v252, s[24:27], s44 offen sc1
    s_mov_b32 s44, 5120
    buffer_store_dwordx4 v[24:27], v251, s[24:27], s44 offen sc1
    s_mov_b32 s44, 5120
    buffer_store_dwordx4 v[28:31], v252, s[24:27], s44 offen sc1
    s_load_dwordx4 s[60:63], s[0:1], 32
    s_load_dwordx4 s[64:67], s[0:1], 88
    v_lshlrev_b32 v9, 4, v2
    s_waitcnt vmcnt(0)
    s_barrier
    s_cmp_lg_u32 s40, 0
    s_cbranch_scc1 G1_nofpW
    s_lshl_b32 s46, s41, 7
    s_add_u32 s46, s46, 425984
    v_mov_b32 v4, 1
    v_mov_b32 v5, 0
    s_mov_b64 exec, 1
    buffer_store_dword v4, v5, s[20:23], s46 offen sc1
    s_mov_b64 exec, -1
G1_nofpW:
    s_mov_b32 exec_lo, 0x00ffffff
    s_add_u32 s46, s34, 0
    s_and_b32 s47, s46, 0xffc0
    s_add_u32 s46, s46, s47
    s_lshl_b32 s46, s46, 11
    buffer_load_dwordx4 v[16:19], v9, s[16:19], s46 offen offset:0
    buffer_load_dwordx4 v[20:23], v9, s[16:19], s46 offen offset:1024
    s_add_u32 s46, s34, 1
    s_and_b32 s47, s46, 0xffc0
    s_add_u32 s46, s46, s47
    s_lshl_b32 s46, s46, 11
    buffer_load_dwordx4 v[24:27], v9, s[16:19], s46 offen offset:0
    buffer_load_dwordx4 v[28:31], v9, s[16:19], s46 offen offset:1024
    s_add_u32 s46, s34, 2
    s_and_b32 s47, s46, 0xffc0
    s_add_u32 s46, s46, s47
    s_lshl_b32 s46, s46, 11
    buffer_load_dwordx4 v[32:35], v9, s[16:19], s46 offen offset:0
    buffer_load_dwordx4 v[36:39], v9, s[16:19], s46 offen offset:1024
    s_add_u32 s46, s34, 3
    s_and_b32 s47, s46, 0xffc0
    s_add_u32 s46, s46, s47
    s_lshl_b32 s46, s46, 11
    buffer_load_dwordx4 v[40:43], v9, s[16:19], s46 offen offset:0
    buffer_load_dwordx4 v[44:47], v9, s[16:19], s46 offen offset:1024
    s_add_u32 s46, s34, 4
    s_and_b32 s47, s46, 0xffc0
    s_add_u32 s46, s46, s47
    s_lshl_b32 s46, s46, 11
    buffer_load_dwordx4 v[48:51], v9, s[16:19], s46 offen offset:0
    buffer_load_dwordx4 v[52:55], v9, s[16:19], s46 offen offset:1024
    s_add_u32 s46, s34, 5
    s_and_b32 s47, s46, 0xffc0
    s_add_u32 s46, s46, s47
    s_lshl_b32 s46, s46, 11
    buffer_load_dwordx4 v[56:59], v9, s[16:19], s46 offen offset:0
    buffer_load_dwordx4 v[60:63], v9, s[16:19], s46 offen offset:1024
    s_add_u32 s46, s34, 6
    s_and_b32 s47, s46, 0xffc0
    s_add_u32 s46, s46, s47
    s_lshl_b32 s46, s46, 11
    buffer_load_dwordx4 v[64:67], v9, s[16:19], s46 offen offset:0
    buffer_load_dwordx4 v[68:71], v9, s[16:19], s46 offen offset:1024
    s_add_u32 s46, s34, 0
    s_and_b32 s47, s46, 0xffc0
    s_add_u32 s46, s46, s47
    s_lshl_b32 s46, s46, 11
    s_add_u32 s46, s46, 131072
    buffer_load_dwordx4 v[72:75], v9, s[16:19], s46 offen offset:0
    buffer_load_dwordx4 v[76:79], v9, s[16:19], s46 offen offset:1024
    s_add_u32 s46, s34, 1
    s_and_b32 s47, s46, 0xffc0
    s_add_u32 s46, s46, s47
    s_lshl_b32 s46, s46, 11
    s_add_u32 s46, s46, 131072
    buffer_load_dwordx4 v[80:83], v9, s[16:19], s46 offen offset:0
    buffer_load_dwordx4 v[84:87], v9, s[16:19], s46 offen offset:1024
    s_add_u32 s46, s34, 2
    s_and_b32 s47, s46, 0xffc0
    s_add_u32 s46, s46, s47
    s_lshl_b32 s46, s46, 11
    s_add_u32 s46, s46, 131072
    buffer_load_dwordx4 v[88:91], v9, s[16:19], s46 offen offset:0
    buffer_load_dwordx4 v[92:95], v9, s[16:19], s46 offen offset:1024
    s_add_u32 s46, s34, 3
    s_and_b32 s47, s46, 0xffc0
    s_add_u32 s46, s46, s47
    s_lshl_b32 s46, s46, 11
    s_add_u32 s46, s46, 131072
    buffer_load_dwordx4 v[96:99], v9, s[16:19], s46 offen offset:0
    buffer_load_dwordx4 v[100:103], v9, s[16:19], s46 offen offset:1024
    s_add_u32 s46, s34, 4
    s_and_b32 s47, s46, 0xffc0
    s_add_u32 s46, s46, s47
    s_lshl_b32 s46, s46, 11
    s_add_u32 s46, s46, 131072
    buffer_load_dwordx4 v[104:107], v9, s[16:19], s46 offen offset:0
    buffer_load_dwordx4 v[108:111], v9, s[16:19], s46 offen offset:1024
    s_add_u32 s46, s34, 5
    s_and_b32 s47, s46, 0xffc0
    s_add_u32 s46, s46, s47
    s_lshl_b32 s46, s46, 11
    s_add_u32 s46, s46, 131072
    buffer_load_dwordx4 v[112:115], v9, s[16:19], s46 offen offset:0
    buffer_load_dwordx4 v[116:119], v9, s[16:19], s46 offen offset:1024
    s_add_u32 s46, s34, 6
    s_and_b32 s47, s46, 0xffc0
    s_add_u32 s46, s46, s47
    s_lshl_b32 s46, s46, 11
    s_add_u32 s46, s46, 131072
    buffer_load_dwordx4 v[120:123], v9, s[16:19], s46 offen offset:0
    buffer_load_dwordx4 v[124:127], v9, s[16:19], s46 offen offset:1024
    s_mov_b64 exec, -1
    s_mov_b64 s[36:37], s[84:85]
    s_waitcnt lgkmcnt(0)
    s_and_b32 s75, s2, 7
    s_lshr_b32 s76, s2, 3
    s_and_b32 s68, s75, 1
    s_lshl_b32 s68, s68, 3
    s_and_b32 s69, s75, 2
    s_lshl_b32 s69, s69, 1
    s_add_u32 s68, s68, s69
    s_lshr_b32 s83, s75, 2
    s_and_b32 s70, s76, 3
    s_add_u32 s68, s68, s70
    s_lshr_b32 s69, s76, 2
    s_lshl_b32 s69, s69, 1
    s_add_u32 s69, s69, s83
    s_and_b32 s70, s40, 3
    s_lshr_b32 s75, s70, 1
    s_and_b32 s76, s70, 1
    s_lshl_b32 s71, s68, 2
    s_lshl_b32 s72, s69, 6
    s_add_u32 s71, s71, s72
    s_add_u32 s71, s71, s70
    s_lshl_b32 s72, s71, 12
    s_mul_i32 s73, s70, 17728
    s_add_u32 s73, s73, 40960
    s_lshr_b32 s74, s71, 1
    s_lshl_b32 s74, s74, 2
    s_load_dword s74, s[62:63], s74
    s_lshl_b32 s77, s69, 18
    s_and_b32 s78, s71, 63
    s_lshl_b32 s78, s78, 8
    s_add_u32 s77, s77, s78
    s_add_u32 s48, s38, 16777216
    s_addc_u32 s49, s39, 0
    s_mov_b32 s50, 4194368
    s_mov_b32 s51, 0x00020000
    s_mov_b32 s52, s60
    s_mov_b32 s53, s61
    s_mov_b32 s54, 4194304
    s_mov_b32 s55, 0x00020000
    s_mov_b32 s56, s66
    s_mov_b32 s57, s67
    s_mov_b32 s58, 256
    s_mov_b32 s59, 0x00020000
    s_add_u32 s20, s38, 100663296
    s_addc_u32 s21, s39, 0
    s_mov_b32 s22, 18350080
    s_mov_b32 s23, 0x00020000
    s_add_u32 s44, s38, 100663296
    s_addc_u32 s45, s39, 0
    s_mov_b32 s46, 0
    s_mov_b32 s47, 0x00020000
    s_add_u32 s28, s38, 67108864
    s_addc_u32 s29, s39, 0
    s_mov_b32 s30, 430080
    s_mov_b32 s31, 0x00020000
    s_mov_b32 s79, 0
    v_lshlrev_b32 v4, 4, v2
    v_add_u32 v5, 12, v4
    v_add_u32 v6, 2, v4
    v_mov_b32 v7, 0x7ff00000
    v_lshlrev_b32 v8, 2, v2
    v_cmp_eq_u32 vcc, 0, v2
    v_mov_b32 v9, 4094
    v_cndmask_b32 v9, v7, v9, vcc
    v_and_b32 v12, 1, v2
    v_mul_u32_u24 v12, 4224, v12
    v_bfe_u32 v11, v2, 1, 3
    v_lshlrev_b32 v11, 3, v11
    v_lshrrev_b32 v13, 4, v2
    v_lshlrev_b32 v13, 4, v13
    v_sub_u32 v11, v13, v11
    v_add3_u32 v3, v12, v11, s73
    v_add_u32 v3, 56, v3
    v_bfe_u32 v11, v2, 1, 3
    v_lshlrev_b32 v11, 6, v11
    v_add_u32 v15, v11, v13
    v_sub_u32 v15, 4720, v15
    v_add_u32 v15, s73, v15
    v_and_b32 v12, 1, v2
    v_mul_u32_u24 v12, 4640, v12
    v_sub_u32 v12, 13088, v12
    v_add3_u32 v11, v11, v13, v12
    v_add_u32 v14, s73, v11
    v_and_b32 v12, 1, v2
    v_bfe_u32 v11, v2, 3, 1
    v_lshl_add_u32 v11, v12, 1, v11
    v_lshlrev_b32 v11, 14, v11
    v_bfe_u32 v250, v2, 1, 2
    v_lshlrev_b32 v250, 6, v250
    v_add3_u32 v250, v250, v11, v13
    v_cmp_eq_u32 s[80:81], 1, v12
    s_lshl_b32 s78, s75, 12
    v_add_u32 v251, s78, v4
    v_bfe_u32 v11, v2, 2, 3
    v_lshrrev_b32 v12, 5, v2
    v_lshlrev_b32 v12, 4, v12
    v_or_b32 v12, v11, v12
    v_lshlrev_b32 v12, 7, v12
    v_lshrrev_b32 v11, 1, v11
    s_lshl_b32 s78, s76, 1
    v_xor_b32 v11, s78, v11
    v_lshlrev_b32 v11, 5, v11
    v_and_b32 v13, 3, v2
    v_lshlrev_b32 v13, 3, v13
    v_add3_u32 v11, v11, v12, v13
    v_add_u32 v252, 155648, v11
    v_xor_b32 v253, 32, v252
    v_and_b32 v11, 31, v2
    v_lshlrev_b32 v255, 2, v11
    v_mov_b32 v10, 0
    v_mov_b32 v11, 1
    v_mov_b32 v12, 0
    s_waitcnt vmcnt(0) lgkmcnt(0)
    buffer_load_dword v254, v255, s[56:59], 0 offen sc1
    s_waitcnt vmcnt(0)
FP_chkP:
    v_cmp_ne_u32 vcc, 1, v254
    s_nop 3
    s_cbranch_vccz FP_okP
    s_sleep 8
    buffer_load_dword v254, v255, s[56:59], 0 offen sc1
    s_waitcnt vmcnt(0)
    s_branch FP_chkP
FP_okP:
    s_cmp_ge_u32 s40, 4
    s_cbranch_scc1 P_pre
    s_add_u32 m0, s73, 8896
    s_nop 0
    buffer_load_dwordx4 v4, s[52:55], s72 offen offset:0 lds
    buffer_load_dwordx4 v4, s[52:55], s72 offen offset:1024 lds
    buffer_load_dwordx4 v4, s[52:55], s72 offen offset:2048 lds
    buffer_load_dwordx4 v4, s[52:55], s72 offen offset:3072 lds
    s_add_u32 m0, s73, 8320
    s_bfm_b64 exec, 36, 0
    buffer_load_dwordx4 v7, s[52:55], s72 offen lds
    s_mov_b64 exec, -1
    s_add_u32 m0, s73, 13088
    s_mov_b64 exec, 0x1fffffff
    buffer_load_dwordx4 v7, s[52:55], s72 offen lds
    s_mov_b64 exec, -1
    s_add_u32 m0, s73, 4224
    s_nop 0
    buffer_load_dwordx4 v4, s[48:51], s72 offen offset:0 sc1 lds
    buffer_load_dwordx4 v4, s[48:51], s72 offen offset:1024 sc1 lds
    buffer_load_dwordx4 v4, s[48:51], s72 offen offset:2048 sc1 lds
    buffer_load_dwordx4 v4, s[48:51], s72 offen offset:3072 sc1 lds
    s_add_u32 m0, s73, 13540
    s_mov_b64 exec, 0x7
    buffer_load_dword v8, s[52:55], s72 offen lds
    s_mov_b64 exec, -1
    s_add_u32 m0, s73, 13552
    s_nop 0
    buffer_load_dwordx4 v5, s[52:55], s72 offen offset:0 lds
    buffer_load_dwordx4 v5, s[52:55], s72 offen offset:1024 lds
    buffer_load_dwordx4 v5, s[52:55], s72 offen offset:2048 lds
    buffer_load_dwordx4 v5, s[52:55], s72 offen offset:3072 lds
    s_add_u32 m0, s73, 0
    s_nop 0
    buffer_load_dwordx4 v6, s[48:51], s72 offen offset:0 sc1 lds
    buffer_load_dwordx4 v6, s[48:51], s72 offen offset:1024 sc1 lds
    buffer_load_dwordx4 v6, s[48:51], s72 offen offset:2048 sc1 lds
    buffer_load_dwordx4 v6, s[48:51], s72 offen offset:3072 sc1 lds
    s_add_u32 m0, s73, 4092
    s_mov_b64 exec, 0x1ffff
    buffer_load_ushort v9, s[48:51], s72 offen sc1 lds
    s_mov_b64 exec, -1
    s_waitcnt vmcnt(0)
    s_branch G2_conv
K_end:
    s_endpgm
.section .rodata,"a"
.p2align 6
.amdhsa_kernel gated_mix__ssm_conv_h3__geglu_ffn__prompt_kernel
  .amdhsa_next_free_vgpr 256
  .amdhsa_next_free_sgpr 102
  .amdhsa_accum_offset 256
  .amdhsa_group_segment_fixed_size 0
  .amdhsa_kernarg_size 112
  .amdhsa_user_sgpr_count 2
  .amdhsa_user_sgpr_kernarg_segment_ptr 1
  .amdhsa_system_sgpr_workgroup_id_x 1
.end_amdhsa_kernel
```
